```python
import torch

def _softmax(x, axis=-1):
    return torch.softmax(x, dim=axis)
def _gelu(x):
    return torch.nn.functional.gelu(x, approximate="tanh")
def _silu(x):
    return torch.nn.functional.silu(x)
def _sigmoid(x):
    return torch.sigmoid(x)
def _layernorm(x, axis=-1, eps=1e-5):
    m = x.mean(dim=axis, keepdim=True)
    v = x.var(dim=axis, keepdim=True, unbiased=False)
    return (x - m) / torch.sqrt(v + eps)
def _scatter_add(tgt, idx, src, axis=0):
    return tgt.clone().index_add_(axis, idx, src)
def _segment_sum(src, seg, n):
    out = torch.zeros((n,) + src.shape[1:], dtype=src.dtype)
    return out.index_add_(0, seg, src)
def _pad(x, pw):
    flat = tuple(v for pair in reversed(pw) for v in pair)
    return torch.nn.functional.pad(x, flat)

kernel_name = 'recurrent_scan__sliding_local_dilated__dense_activation_gelu__prompt'

def setup_inputs():

    _w = (lambda a: (lambda t: t.to(torch.bfloat16) if t.is_floating_point() else t)(torch.as_tensor(a)))
    def _A_setup():
        B, S, D = 1, 2048, 640
        return {
            "x": _w((lambda *s: torch.randn(*s, dtype=torch.bfloat16) * 0.05)(B, S, D)),
            "wqkv": _w((lambda *s: torch.randn(*s, dtype=torch.bfloat16) * 0.2)(D, 3 * D)),
            "wo": _w((lambda *s: torch.randn(*s, dtype=torch.bfloat16) * 0.2)(D, D)),
        }
    _A_in = _A_setup()

    def _B_setup():
        B, S, D, F = 1, 2048, 640, 1728
        return {
            "x": _w((lambda *s: torch.randn(*s, dtype=torch.bfloat16) * 0.05)(B, S, D)),
            "w1": _w((lambda *s: torch.randn(*s, dtype=torch.bfloat16) * 1.6)(D, F) * (D ** -0.5)),
            "b1": _w((lambda *s: torch.randn(*s, dtype=torch.bfloat16) * 1.6)(F) * 0.01),
            "w2": _w((lambda *s: torch.randn(*s, dtype=torch.bfloat16) * 0.1)(F, D) * (F ** -0.5)),
            "b2": _w((lambda *s: torch.randn(*s, dtype=torch.bfloat16) * 0.1)(D) * 0.01),
        }
    _B_in = _B_setup()

    return {
        "A_x": _A_in["x"],
        "A_wqkv": _A_in["wqkv"],
        "A_wo": _A_in["wo"],
        "B_x": _B_in["x"],
        "B_w1": _B_in["w1"],
        "B_b1": _B_in["b1"],
        "B_w2": _B_in["w2"],
        "B_b2": _B_in["b2"],
    }

def reference(A_x, A_wqkv, A_wo, B_x, B_w1, B_b1, B_w2, B_b2):
    def _A_ref(x, wqkv, wo):
        B, S, D = x.shape
        H = 32; Dh = D // H
        W, dil = 8, 2
        qkv = (lambda x, *d: x.permute(*d))((x @ wqkv).reshape(B, S, 3, H, Dh), 2, 0, 3, 1, 4)
        q, k, v = qkv[0], qkv[1], qkv[2]
        scale = Dh ** -0.5
        pos = torch.arange(S)
        off = torch.arange(W) * dil
        idx = pos[:, None] - off[None, :]
        mask = idx >= 0
        idx_c = torch.where(mask, idx, 0).reshape(-1)
        kg = k[:, :, idx_c, :].reshape(B, H, S, W, Dh)
        vg = v[:, :, idx_c, :].reshape(B, H, S, W, Dh)
        logits = torch.einsum("bhsd,bhswd->bhsw", q, kg) * scale
        logits = torch.where(mask[None, None, :, :], logits, -1e9)
        attn = _softmax(logits, axis=-1)
        o = torch.einsum("bhsw,bhswd->bhsd", attn, vg)
        return (lambda x, *d: x.permute(*d))(o, 0, 2, 1, 3).reshape(B, S, D) @ wo

    def _B_ref(x, w1, b1, w2, b2):
        h = torch.einsum("bsd,df->bsf", x, w1) + b1
        h = _gelu(h)
        return torch.einsum("bsf,fd->bsd", h, w2) + b2

    x = A_x
    xn = _layernorm(x, axis=-1)
    s = _A_ref(xn, A_wqkv, A_wo)
    g = _silu(_B_ref(xn, B_w1, B_b1, B_w2, B_b2))
    return x + s * g
```

```asm
; @launch grid=(256,1,1) block=(256,1,1) lds=163840
.amdgcn_target "amdgcn-amd-amdhsa--gfx950"
.text
.globl recurrent_scan__sliding_local_dilated__dense_activation_gelu__prompt_kernel
.p2align 8
.type recurrent_scan__sliding_local_dilated__dense_activation_gelu__prompt_kernel,@function
recurrent_scan__sliding_local_dilated__dense_activation_gelu__prompt_kernel:
    s_cmp_ge_u32 s2, 256
    s_cbranch_scc1 L_end
    s_load_dwordx16 s[32:47], s[0:1], 0
    s_load_dwordx4 s[48:51], s[0:1], 64
    s_load_dwordx2 s[52:53], s[0:1], 80
    v_lshrrev_b32 v188, 6, v0
    v_and_b32 v1, 63, v0
    v_readfirstlane_b32 s60, v188
    v_mov_b32 v190, 0
    v_mov_b32 v191, 0
    v_mov_b32 v189, 155648
    ds_write_b64 v189, v[190:191]
    ds_write_b64 v189, v[190:191] offset:8
    s_cmp_lt_u32 s60, 2
    s_cbranch_scc1 L_nocp
    s_getpc_b64 s[78:79]
L_pc:
    s_lshr_b32 s71, s2, 2
    s_and_b32 s71, s71, 6
    s_and_b32 s72, s60, 1
    s_add_u32 s71, s71, s72
    s_lshl_b32 s71, s71, 13
    v_lshl_add_u32 v223, v1, 7, s71
    v_min_u32 v223, L_end-L_pc, v223
    global_load_dword v205, v223, s[78:79]
L_nocp:
    s_and_b32 s68, s2, 7
    s_lshr_b32 s69, s2, 3
    s_and_b32 s61, s68, 1
    s_lshl_b32 s61, s61, 3
    s_and_b32 s70, s69, 7
    s_add_u32 s61, s61, s70
    s_lshr_b32 s70, s69, 3
    s_and_b32 s62, s70, 1
    s_lshr_b32 s70, s70, 1
    s_and_b32 s63, s68, 6
    s_add_u32 s63, s63, s70
    s_lshl_b32 s64, s61, 4
    s_lshl_b32 s70, s62, 3
    s_add_u32 s64, s64, s70
    s_add_u32 s64, s64, s63
    s_cmp_eq_u32 s62, 0
    s_mov_b32 s65, 3456
    s_cselect_b32 s65, 3840, s65
    v_and_b32 v192, 3, v1
    v_lshrrev_b32 v193, 2, v1
    s_lshl_b32 s71, s64, 3
    s_add_u32 s71, s71, s60
    v_lshl_add_u32 v192, v192, 1, s71
    v_mul_u32_u24 v194, 1280, v192
    v_lshl_add_u32 v194, v193, 4, v194
    v_and_b32 v220, 15, v1
    s_cmp_eq_u32 s62, 0
    s_cselect_b32 s71, 8, 6
    s_cselect_b32 s72, 896, 0
    s_mov_b32 s74, 448
    s_cselect_b32 s74, 160, s74
    v_min_u32 v220, s71, v220
    v_mul_u32_u24 v221, 11, v220
    v_lshrrev_b32 v221, 5, v221
    v_mul_u32_u24 v221, s72, v221
    v_lshl_add_u32 v0, v220, 7, v221
    v_lshrrev_b32 v220, 4, v1
    v_mad_u32_u24 v0, v220, s65, v0
    s_and_b32 s71, s63, 6
    s_mul_i32 s74, s74, s71
    v_add_u32 v0, s74, v0
    s_and_b32 s66, s61, 7
    s_lshl_b32 s66, s66, 1
    s_and_b32 s72, s63, 1
    s_add_u32 s66, s66, s72
    s_waitcnt lgkmcnt(0)
    s_barrier
    s_mov_b32 s4, s32
    s_mov_b32 s5, s33
    s_mov_b32 s6, 2621440
    s_mov_b32 s7, 0x00020000
    s_mov_b32 s16, s50
    s_mov_b32 s17, s51
    s_mov_b32 s18, 256
    s_mov_b32 s19, 0x00020000
    s_cmp_ge_u32 s60, 2
    s_cbranch_scc1 L_pf
    buffer_load_dwordx4 v[196:199], v194, s[4:7], 0 offen offset:0
    buffer_load_dwordx4 v[200:203], v194, s[4:7], 0 offen offset:256
    buffer_load_dwordx4 v[204:207], v194, s[4:7], 0 offen offset:512
    buffer_load_dwordx4 v[208:211], v194, s[4:7], 0 offen offset:768
    buffer_load_dwordx4 v[212:215], v194, s[4:7], 0 offen offset:1024
    buffer_load_dword v224, v190, s[16:19], 0 offen sc1
    s_mov_b32 s12, s52
    s_mov_b32 s13, s53
    s_mov_b32 s14, 15482880
    s_mov_b32 s15, 0x00020000
    s_lshl_b32 s3, s64, 6
    v_lshrrev_b32 v191, 4, v192
    v_mul_u32_u24 v191, 20480, v191
    v_lshrrev_b32 v188, 4, v1
    v_lshl_add_u32 v191, v188, 10, v191
    s_and_b32 s72, s64, 1
    s_lshl_b32 s72, s72, 1
    s_add_u32 s72, s72, s60
    s_lshl_b32 s72, s72, 8
    v_add_u32 v191, s72, v191
    v_and_b32 v188, 15, v1
    v_lshl_add_u32 v191, v188, 4, v191
    s_mov_b32 s71, 0xffff0000
    s_waitcnt vmcnt(5)
    v_lshlrev_b32 v16, 16, v196
    v_and_b32 v17, s71, v196
    v_lshlrev_b32 v18, 16, v197
    v_and_b32 v19, s71, v197
    v_pk_add_f32 v[192:193], v[16:17], v[18:19]
    v_lshlrev_b32 v20, 16, v198
    v_and_b32 v21, s71, v198
    v_pk_add_f32 v[192:193], v[192:193], v[20:21]
    v_lshlrev_b32 v22, 16, v199
    v_and_b32 v23, s71, v199
    v_pk_add_f32 v[192:193], v[192:193], v[22:23]
    s_waitcnt vmcnt(4)
    v_lshlrev_b32 v24, 16, v200
    v_and_b32 v25, s71, v200
    v_pk_add_f32 v[192:193], v[192:193], v[24:25]
    v_lshlrev_b32 v26, 16, v201
    v_and_b32 v27, s71, v201
    v_pk_add_f32 v[192:193], v[192:193], v[26:27]
    v_lshlrev_b32 v28, 16, v202
    v_and_b32 v29, s71, v202
    v_pk_add_f32 v[192:193], v[192:193], v[28:29]
    v_lshlrev_b32 v30, 16, v203
    v_and_b32 v31, s71, v203
    v_pk_add_f32 v[192:193], v[192:193], v[30:31]
    s_waitcnt vmcnt(3)
    v_lshlrev_b32 v32, 16, v204
    v_and_b32 v33, s71, v204
    v_pk_add_f32 v[192:193], v[192:193], v[32:33]
    v_lshlrev_b32 v34, 16, v205
    v_and_b32 v35, s71, v205
    v_pk_add_f32 v[192:193], v[192:193], v[34:35]
    v_lshlrev_b32 v36, 16, v206
    v_and_b32 v37, s71, v206
    v_pk_add_f32 v[192:193], v[192:193], v[36:37]
    v_lshlrev_b32 v38, 16, v207
    v_and_b32 v39, s71, v207
    v_pk_add_f32 v[192:193], v[192:193], v[38:39]
    s_waitcnt vmcnt(2)
    v_lshlrev_b32 v40, 16, v208
    v_and_b32 v41, s71, v208
    v_pk_add_f32 v[192:193], v[192:193], v[40:41]
    v_lshlrev_b32 v42, 16, v209
    v_and_b32 v43, s71, v209
    v_pk_add_f32 v[192:193], v[192:193], v[42:43]
    v_lshlrev_b32 v44, 16, v210
    v_and_b32 v45, s71, v210
    v_pk_add_f32 v[192:193], v[192:193], v[44:45]
    v_lshlrev_b32 v46, 16, v211
    v_and_b32 v47, s71, v211
    v_pk_add_f32 v[192:193], v[192:193], v[46:47]
    s_waitcnt vmcnt(1)
    v_lshlrev_b32 v48, 16, v212
    v_and_b32 v49, s71, v212
    v_pk_add_f32 v[192:193], v[192:193], v[48:49]
    v_lshlrev_b32 v50, 16, v213
    v_and_b32 v51, s71, v213
    v_pk_add_f32 v[192:193], v[192:193], v[50:51]
    v_lshlrev_b32 v52, 16, v214
    v_and_b32 v53, s71, v214
    v_pk_add_f32 v[192:193], v[192:193], v[52:53]
    v_lshlrev_b32 v54, 16, v215
    v_and_b32 v55, s71, v215
    v_pk_add_f32 v[192:193], v[192:193], v[54:55]
    v_add_f32 v192, v192, v193
    s_nop 1
    v_add_f32_dpp v192, v192, v192 row_ror:4 row_mask:0xf bank_mask:0xf
    s_nop 1
    v_add_f32_dpp v192, v192, v192 row_ror:8 row_mask:0xf bank_mask:0xf
    v_mov_b32 v193, v192
    s_nop 1
    v_permlane16_swap_b32 v192, v193
    v_add_f32 v192, v192, v193
    v_mov_b32 v193, v192
    s_nop 1
    v_permlane32_swap_b32 v192, v193
    v_add_f32 v192, v192, v193
    v_mul_f32 v194, 0x3acccccd, v192
    v_mov_b32 v195, v194
    v_pk_add_f32 v[216:217], v[16:17], v[194:195] neg_lo:[0,1] neg_hi:[0,1]
    v_pk_mul_f32 v[192:193], v[216:217], v[216:217]
    v_pk_add_f32 v[218:219], v[18:19], v[194:195] neg_lo:[0,1] neg_hi:[0,1]
    v_pk_fma_f32 v[192:193], v[218:219], v[218:219], v[192:193]
    v_pk_add_f32 v[216:217], v[20:21], v[194:195] neg_lo:[0,1] neg_hi:[0,1]
    v_pk_fma_f32 v[192:193], v[216:217], v[216:217], v[192:193]
    v_pk_add_f32 v[218:219], v[22:23], v[194:195] neg_lo:[0,1] neg_hi:[0,1]
    v_pk_fma_f32 v[192:193], v[218:219], v[218:219], v[192:193]
    v_pk_add_f32 v[216:217], v[24:25], v[194:195] neg_lo:[0,1] neg_hi:[0,1]
    v_pk_fma_f32 v[192:193], v[216:217], v[216:217], v[192:193]
    v_pk_add_f32 v[218:219], v[26:27], v[194:195] neg_lo:[0,1] neg_hi:[0,1]
    v_pk_fma_f32 v[192:193], v[218:219], v[218:219], v[192:193]
    v_pk_add_f32 v[216:217], v[28:29], v[194:195] neg_lo:[0,1] neg_hi:[0,1]
    v_pk_fma_f32 v[192:193], v[216:217], v[216:217], v[192:193]
    v_pk_add_f32 v[218:219], v[30:31], v[194:195] neg_lo:[0,1] neg_hi:[0,1]
    v_pk_fma_f32 v[192:193], v[218:219], v[218:219], v[192:193]
    v_pk_add_f32 v[216:217], v[32:33], v[194:195] neg_lo:[0,1] neg_hi:[0,1]
    v_pk_fma_f32 v[192:193], v[216:217], v[216:217], v[192:193]
    v_pk_add_f32 v[218:219], v[34:35], v[194:195] neg_lo:[0,1] neg_hi:[0,1]
    v_pk_fma_f32 v[192:193], v[218:219], v[218:219], v[192:193]
    v_pk_add_f32 v[216:217], v[36:37], v[194:195] neg_lo:[0,1] neg_hi:[0,1]
    v_pk_fma_f32 v[192:193], v[216:217], v[216:217], v[192:193]
    v_pk_add_f32 v[218:219], v[38:39], v[194:195] neg_lo:[0,1] neg_hi:[0,1]
    v_pk_fma_f32 v[192:193], v[218:219], v[218:219], v[192:193]
    v_pk_add_f32 v[216:217], v[40:41], v[194:195] neg_lo:[0,1] neg_hi:[0,1]
    v_pk_fma_f32 v[192:193], v[216:217], v[216:217], v[192:193]
    v_pk_add_f32 v[218:219], v[42:43], v[194:195] neg_lo:[0,1] neg_hi:[0,1]
    v_pk_fma_f32 v[192:193], v[218:219], v[218:219], v[192:193]
    v_pk_add_f32 v[216:217], v[44:45], v[194:195] neg_lo:[0,1] neg_hi:[0,1]
    v_pk_fma_f32 v[192:193], v[216:217], v[216:217], v[192:193]
    v_pk_add_f32 v[218:219], v[46:47], v[194:195] neg_lo:[0,1] neg_hi:[0,1]
    v_pk_fma_f32 v[192:193], v[218:219], v[218:219], v[192:193]
    v_pk_add_f32 v[216:217], v[48:49], v[194:195] neg_lo:[0,1] neg_hi:[0,1]
    v_pk_fma_f32 v[192:193], v[216:217], v[216:217], v[192:193]
    v_pk_add_f32 v[218:219], v[50:51], v[194:195] neg_lo:[0,1] neg_hi:[0,1]
    v_pk_fma_f32 v[192:193], v[218:219], v[218:219], v[192:193]
    v_pk_add_f32 v[216:217], v[52:53], v[194:195] neg_lo:[0,1] neg_hi:[0,1]
    v_pk_fma_f32 v[192:193], v[216:217], v[216:217], v[192:193]
    v_pk_add_f32 v[218:219], v[54:55], v[194:195] neg_lo:[0,1] neg_hi:[0,1]
    v_pk_fma_f32 v[192:193], v[218:219], v[218:219], v[192:193]
    v_add_f32 v192, v192, v193
    s_nop 1
    v_add_f32_dpp v192, v192, v192 row_ror:4 row_mask:0xf bank_mask:0xf
    s_nop 1
    v_add_f32_dpp v192, v192, v192 row_ror:8 row_mask:0xf bank_mask:0xf
    v_mov_b32 v193, v192
    s_nop 1
    v_permlane16_swap_b32 v192, v193
    v_add_f32 v192, v192, v193
    v_mov_b32 v193, v192
    s_nop 1
    v_permlane32_swap_b32 v192, v193
    v_add_f32 v192, v192, v193
    v_mul_f32 v192, 0x3acccccd, v192
    v_cvt_pk_bf16_f32 v192, v192, v192
    v_lshlrev_b32 v192, 16, v192
    v_add_f32 v192, 0x37280000, v192
    v_cvt_pk_bf16_f32 v192, v192, v192
    v_lshlrev_b32 v192, 16, v192
    v_sqrt_f32 v192, v192
    v_cvt_pk_bf16_f32 v194, v194, v194
    v_lshlrev_b32 v194, 16, v194
    v_cvt_pk_bf16_f32 v192, v192, v192
    v_lshlrev_b32 v192, 16, v192
    v_rcp_f32 v193, v192
    v_mov_b32 v195, v194
    v_fma_f32 v192, -v192, v193, 1.0
    v_fma_f32 v192, v192, v193, v193
    v_mov_b32 v193, v192
    v_pk_add_f32 v[16:17], v[16:17], v[194:195] neg_lo:[0,1] neg_hi:[0,1]
    v_cvt_pk_bf16_f32 v196, v16, v17
    v_lshlrev_b32 v16, 16, v196
    v_and_b32 v17, s71, v196
    v_pk_mul_f32 v[16:17], v[16:17], v[192:193]
    v_cvt_pk_bf16_f32 v196, v16, v17
    v_pk_add_f32 v[18:19], v[18:19], v[194:195] neg_lo:[0,1] neg_hi:[0,1]
    v_cvt_pk_bf16_f32 v197, v18, v19
    v_lshlrev_b32 v18, 16, v197
    v_and_b32 v19, s71, v197
    v_pk_mul_f32 v[18:19], v[18:19], v[192:193]
    v_cvt_pk_bf16_f32 v197, v18, v19
    v_pk_add_f32 v[20:21], v[20:21], v[194:195] neg_lo:[0,1] neg_hi:[0,1]
    v_cvt_pk_bf16_f32 v198, v20, v21
    v_lshlrev_b32 v20, 16, v198
    v_and_b32 v21, s71, v198
    v_pk_mul_f32 v[20:21], v[20:21], v[192:193]
    v_cvt_pk_bf16_f32 v198, v20, v21
    v_pk_add_f32 v[22:23], v[22:23], v[194:195] neg_lo:[0,1] neg_hi:[0,1]
    v_cvt_pk_bf16_f32 v199, v22, v23
    v_lshlrev_b32 v22, 16, v199
    v_and_b32 v23, s71, v199
    v_pk_mul_f32 v[22:23], v[22:23], v[192:193]
    v_cvt_pk_bf16_f32 v199, v22, v23
    s_mov_b32 s72, 0
    buffer_store_dwordx4 v[196:199], v191, s[12:15], s72 offen sc1
    v_pk_add_f32 v[24:25], v[24:25], v[194:195] neg_lo:[0,1] neg_hi:[0,1]
    v_cvt_pk_bf16_f32 v200, v24, v25
    v_lshlrev_b32 v24, 16, v200
    v_and_b32 v25, s71, v200
    v_pk_mul_f32 v[24:25], v[24:25], v[192:193]
    v_cvt_pk_bf16_f32 v200, v24, v25
    v_pk_add_f32 v[26:27], v[26:27], v[194:195] neg_lo:[0,1] neg_hi:[0,1]
    v_cvt_pk_bf16_f32 v201, v26, v27
    v_lshlrev_b32 v26, 16, v201
    v_and_b32 v27, s71, v201
    v_pk_mul_f32 v[26:27], v[26:27], v[192:193]
    v_cvt_pk_bf16_f32 v201, v26, v27
    v_pk_add_f32 v[28:29], v[28:29], v[194:195] neg_lo:[0,1] neg_hi:[0,1]
    v_cvt_pk_bf16_f32 v202, v28, v29
    v_lshlrev_b32 v28, 16, v202
    v_and_b32 v29, s71, v202
    v_pk_mul_f32 v[28:29], v[28:29], v[192:193]
    v_cvt_pk_bf16_f32 v202, v28, v29
    v_pk_add_f32 v[30:31], v[30:31], v[194:195] neg_lo:[0,1] neg_hi:[0,1]
    v_cvt_pk_bf16_f32 v203, v30, v31
    v_lshlrev_b32 v30, 16, v203
    v_and_b32 v31, s71, v203
    v_pk_mul_f32 v[30:31], v[30:31], v[192:193]
    v_cvt_pk_bf16_f32 v203, v30, v31
    s_mov_b32 s72, 4096
    buffer_store_dwordx4 v[200:203], v191, s[12:15], s72 offen sc1
    v_pk_add_f32 v[32:33], v[32:33], v[194:195] neg_lo:[0,1] neg_hi:[0,1]
    v_cvt_pk_bf16_f32 v204, v32, v33
    v_lshlrev_b32 v32, 16, v204
    v_and_b32 v33, s71, v204
    v_pk_mul_f32 v[32:33], v[32:33], v[192:193]
    v_cvt_pk_bf16_f32 v204, v32, v33
    v_pk_add_f32 v[34:35], v[34:35], v[194:195] neg_lo:[0,1] neg_hi:[0,1]
    v_cvt_pk_bf16_f32 v205, v34, v35
    v_lshlrev_b32 v34, 16, v205
    v_and_b32 v35, s71, v205
    v_pk_mul_f32 v[34:35], v[34:35], v[192:193]
    v_cvt_pk_bf16_f32 v205, v34, v35
    v_pk_add_f32 v[36:37], v[36:37], v[194:195] neg_lo:[0,1] neg_hi:[0,1]
    v_cvt_pk_bf16_f32 v206, v36, v37
    v_lshlrev_b32 v36, 16, v206
    v_and_b32 v37, s71, v206
    v_pk_mul_f32 v[36:37], v[36:37], v[192:193]
    v_cvt_pk_bf16_f32 v206, v36, v37
    v_pk_add_f32 v[38:39], v[38:39], v[194:195] neg_lo:[0,1] neg_hi:[0,1]
    v_cvt_pk_bf16_f32 v207, v38, v39
    v_lshlrev_b32 v38, 16, v207
    v_and_b32 v39, s71, v207
    v_pk_mul_f32 v[38:39], v[38:39], v[192:193]
    v_cvt_pk_bf16_f32 v207, v38, v39
    s_mov_b32 s72, 8192
    buffer_store_dwordx4 v[204:207], v191, s[12:15], s72 offen sc1
    v_pk_add_f32 v[40:41], v[40:41], v[194:195] neg_lo:[0,1] neg_hi:[0,1]
    v_cvt_pk_bf16_f32 v208, v40, v41
    v_lshlrev_b32 v40, 16, v208
    v_and_b32 v41, s71, v208
    v_pk_mul_f32 v[40:41], v[40:41], v[192:193]
    v_cvt_pk_bf16_f32 v208, v40, v41
    v_pk_add_f32 v[42:43], v[42:43], v[194:195] neg_lo:[0,1] neg_hi:[0,1]
    v_cvt_pk_bf16_f32 v209, v42, v43
    v_lshlrev_b32 v42, 16, v209
    v_and_b32 v43, s71, v209
    v_pk_mul_f32 v[42:43], v[42:43], v[192:193]
    v_cvt_pk_bf16_f32 v209, v42, v43
    v_pk_add_f32 v[44:45], v[44:45], v[194:195] neg_lo:[0,1] neg_hi:[0,1]
    v_cvt_pk_bf16_f32 v210, v44, v45
    v_lshlrev_b32 v44, 16, v210
    v_and_b32 v45, s71, v210
    v_pk_mul_f32 v[44:45], v[44:45], v[192:193]
    v_cvt_pk_bf16_f32 v210, v44, v45
    v_pk_add_f32 v[46:47], v[46:47], v[194:195] neg_lo:[0,1] neg_hi:[0,1]
    v_cvt_pk_bf16_f32 v211, v46, v47
    v_lshlrev_b32 v46, 16, v211
    v_and_b32 v47, s71, v211
    v_pk_mul_f32 v[46:47], v[46:47], v[192:193]
    v_cvt_pk_bf16_f32 v211, v46, v47
    s_mov_b32 s72, 12288
    buffer_store_dwordx4 v[208:211], v191, s[12:15], s72 offen sc1
    v_pk_add_f32 v[48:49], v[48:49], v[194:195] neg_lo:[0,1] neg_hi:[0,1]
    v_cvt_pk_bf16_f32 v212, v48, v49
    v_lshlrev_b32 v48, 16, v212
    v_and_b32 v49, s71, v212
    v_pk_mul_f32 v[48:49], v[48:49], v[192:193]
    v_cvt_pk_bf16_f32 v212, v48, v49
    v_pk_add_f32 v[50:51], v[50:51], v[194:195] neg_lo:[0,1] neg_hi:[0,1]
    v_cvt_pk_bf16_f32 v213, v50, v51
    v_lshlrev_b32 v50, 16, v213
    v_and_b32 v51, s71, v213
    v_pk_mul_f32 v[50:51], v[50:51], v[192:193]
    v_cvt_pk_bf16_f32 v213, v50, v51
    v_pk_add_f32 v[52:53], v[52:53], v[194:195] neg_lo:[0,1] neg_hi:[0,1]
    v_cvt_pk_bf16_f32 v214, v52, v53
    v_lshlrev_b32 v52, 16, v214
    v_and_b32 v53, s71, v214
    v_pk_mul_f32 v[52:53], v[52:53], v[192:193]
    v_cvt_pk_bf16_f32 v214, v52, v53
    v_pk_add_f32 v[54:55], v[54:55], v[194:195] neg_lo:[0,1] neg_hi:[0,1]
    v_cvt_pk_bf16_f32 v215, v54, v55
    v_lshlrev_b32 v54, 16, v215
    v_and_b32 v55, s71, v215
    v_pk_mul_f32 v[54:55], v[54:55], v[192:193]
    v_cvt_pk_bf16_f32 v215, v54, v55
    s_mov_b32 s72, 16384
    buffer_store_dwordx4 v[212:215], v191, s[12:15], s72 offen sc1
    s_waitcnt vmcnt(5)
    v_readfirstlane_b32 s79, v224
    v_mov_b32 v189, 0
    s_mov_b32 s78, 0
    s_cmp_lg_u32 s79, 0
    s_cbranch_scc1 L_tagok
L_tagpoll:
    buffer_load_dword v224, v189, s[16:19], 0 offen sc1
    s_waitcnt vmcnt(0) lgkmcnt(0)
    v_readfirstlane_b32 s79, v224
    s_add_u32 s78, s78, 1
    s_cmp_lg_u32 s79, 0
    s_cbranch_scc1 L_tagok
    s_cmp_lt_u32 s78, 0x40000
    s_cbranch_scc1 L_tagpoll
L_tagok:
    v_mov_b32 v189, 155648
    ds_write_b32 v189, v224 offset:4
    v_mov_b32 v188, 1
    s_waitcnt vmcnt(0) lgkmcnt(0)
    s_mov_b64 exec, 1
    ds_add_rtn_u32 v190, v189, v188
    s_mov_b64 exec, -1
    s_waitcnt lgkmcnt(0)
    v_readfirstlane_b32 s71, v190
    s_nop 0
    s_cmp_eq_u32 s71, 1
    s_cbranch_scc0 L_common
    v_mov_b32 v188, s79
    v_mov_b32 v189, 15351808
    s_mov_b64 exec, 1
    buffer_store_dword v188, v189, s[12:15], s3 offen sc1
    s_mov_b64 exec, -1
    s_branch L_common
L_pf:
    s_cmp_lt_u32 s2, 8
    s_cbranch_scc0 L_notag
    s_cmp_eq_u32 s60, 2
    s_cbranch_scc0 L_notag
    s_memrealtime s[72:73]
    s_waitcnt lgkmcnt(0)
    s_or_b32 s72, s72, 1
    v_mov_b32 v190, s72
    s_mov_b64 exec, 1
    buffer_atomic_cmpswap v[190:191], v191, s[16:19], 0 offen sc1
    s_mov_b64 exec, -1
L_notag:
    s_cmp_eq_u32 s62, 0
    s_cselect_b32 s8, s34, s40
    s_cselect_b32 s9, s35, s41
    s_mov_b32 s10, 2211840
    s_cselect_b32 s10, 2457600, s10
    s_mov_b32 s11, 0x00020000
    s_lshl_b32 s71, s66, 1
    s_and_b32 s72, s60, 1
    s_add_u32 s71, s71, s72
    s_lshl_b32 s72, s65, 2
    s_mul_i32 s75, s71, s72
    s_lshl_b32 s72, s65, 7
    buffer_load_dword v200, v0, s[8:11], s75 offen
    s_add_u32 s75, s75, s72
    buffer_load_dword v201, v0, s[8:11], s75 offen
    s_add_u32 s75, s75, s72
    buffer_load_dword v202, v0, s[8:11], s75 offen
    s_lshl_b32 s28, s2, 1
    s_and_b32 s71, s60, 1
    s_add_u32 s28, s28, s71
    s_mul_i32 s55, s71, 8448
    s_add_u32 s55, s55, 118272
    s_mul_i32 s29, s28, 13108
    s_lshr_b32 s29, s29, 16
    s_mul_i32 s30, s29, 5
    s_sub_u32 s30, s28, s30
    s_cmp_lt_u32 s29, 20
    s_cselect_b32 s24, s36, s44
    s_cselect_b32 s25, s37, s45
    s_mov_b32 s26, 2211840
    s_cselect_b32 s26, 819200, s26
    s_mov_b32 s27, 0x00020000
    s_mov_b32 s31, 5120
    s_cselect_b32 s31, 10240, s31
    s_mov_b32 s56, 20480
    s_cselect_b32 s56, 5120, s56
    s_cselect_b32 s57, 0, 20
    s_sub_u32 s57, s29, s57
    s_mul_i32 s57, s57, 40960
    s_lshl_b32 s71, s30, 8
    s_add_u32 s57, s57, s71
    v_lshrrev_b32 v196, 4, v1
    v_mul_u32_u24 v196, 1280, v196
    v_and_b32 v188, 15, v1
    v_lshl_add_u32 v196, v188, 4, v196
    s_mov_b32 s71, s57
    s_add_u32 m0, s55, 0
    s_nop 0
    buffer_load_dwordx4 v196, s[24:27], s71 offen lds
    s_add_u32 s71, s71, s31
    s_add_u32 m0, s55, 1024
    s_nop 0
    buffer_load_dwordx4 v196, s[24:27], s71 offen lds
    s_add_u32 s71, s71, s31
    s_add_u32 m0, s55, 2048
    s_nop 0
    buffer_load_dwordx4 v196, s[24:27], s71 offen lds
    s_add_u32 s71, s71, s31
    s_add_u32 m0, s55, 3072
    s_nop 0
    buffer_load_dwordx4 v196, s[24:27], s71 offen lds
    s_add_u32 s71, s57, s56
    s_add_u32 m0, s55, 4096
    s_nop 0
    buffer_load_dwordx4 v196, s[24:27], s71 offen lds
    s_add_u32 s71, s71, s31
    s_add_u32 m0, s55, 5120
    s_nop 0
    buffer_load_dwordx4 v196, s[24:27], s71 offen lds
    s_add_u32 s71, s71, s31
    s_add_u32 m0, s55, 6144
    s_nop 0
    buffer_load_dwordx4 v196, s[24:27], s71 offen lds
    s_add_u32 s71, s71, s31
    s_add_u32 m0, s55, 7168
    s_nop 0
    buffer_load_dwordx4 v196, s[24:27], s71 offen lds
    s_mul_i32 s54, s29, 40960
    s_lshl_b32 s72, s30, 13
    s_add_u32 s54, s54, s72
    s_add_u32 s54, s54, 12320768
    s_cmp_lt_u32 s29, 74
    s_cselect_b32 s54, s54, 1073741824
L_common:
    s_nop 4
    s_lshl_b32 s3, s64, 6
    s_lshl_b32 s76, s68, 2
    s_and_b32 s70, s69, 3
    s_add_u32 s76, s76, s70
    s_lshr_b32 s77, s69, 2
    s_mul_i32 s67, s63, 7
    s_min_u32 s67, s67, 47
    s_lshl_b32 s71, s66, 2
    s_add_u32 s71, s71, s60
    s_add_u32 s71, s71, 64
    s_lshl_b32 s72, s65, 2
    s_mul_i32 s71, s71, s72
    v_add_u32 v0, s71, v0
    s_lshl_b32 s66, s65, 5
    v_lshlrev_b32 v10, 4, v1
    v_add_u32 v11, 4096, v10
    s_mov_b32 s28, s42
    s_mov_b32 s29, s43
    s_mov_b32 s30, 3456
    s_mov_b32 s31, 0x00020000
    v_lshlrev_b32 v195, 3, v1
    s_lshl_b32 s73, s67, 6
    buffer_load_dwordx2 v[226:227], v195, s[28:31], s73 offen
    s_mov_b32 s12, s52
    s_mov_b32 s13, s53
    s_mov_b32 s14, 15482880
    s_mov_b32 s15, 0x00020000
    s_mov_b32 s20, s48
    s_mov_b32 s21, s49
    s_mov_b32 s22, 2621440
    s_mov_b32 s23, 0x00020000
    s_mov_b32 s56, s46
    s_mov_b32 s57, s47
    s_mov_b32 s58, 1280
    s_mov_b32 s59, 0x00020000
    s_cmp_eq_u32 s62, 0
    s_cselect_b32 s8, s34, s40
    s_cselect_b32 s9, s35, s41
    s_mov_b32 s10, 2211840
    s_cselect_b32 s10, 2457600, s10
    s_mov_b32 s11, 0x00020000
    v_and_b32 v188, 31, v1
    v_lshrrev_b32 v189, 5, v1
    s_cmp_eq_u32 s62, 0
    s_cselect_b32 s71, 29, 27
    s_cselect_b32 s72, 1120, 0
    s_mul_i32 s34, s63, 160
    s_lshl_b32 s73, s67, 6
    s_cmp_eq_u32 s62, 0
    s_cselect_b32 s34, s34, s73
    v_min_u32 v188, s71, v188
    v_mul_u32_u24 v190, 205, v188
    v_lshrrev_b32 v190, 11, v190
    v_mul_u32_u24 v190, s72, v190
    v_lshl_add_u32 v190, v188, 4, v190
    v_add_u32 v190, s34, v190
    s_lshl_b32 s71, s65, 2
    v_mad_u32_u24 v2, v189, s71, v190
    s_sub_u32 s71, s65, 1056
    v_add_u32 v3, s71, v2
    v_add_u32 v4, s71, v3
    v_add_u32 v5, s71, v4
    s_mul_i32 s74, s60, 4224
    s_lshl_b32 s71, s65, 3
    s_mul_i32 s75, s60, s71
    s_mul_i32 s71, s66, 4
    s_add_u32 s75, s75, s71
    v_lshrrev_b32 v193, 2, v1
    v_mul_u32_u24 v6, 1056, v193
    v_and_b32 v188, 3, v1
    v_lshl_add_u32 v6, v188, 3, v6
    v_add_u32 v7, 67584, v6
    s_mul_i32 s32, s60, 3
    s_min_u32 s32, s32, 7
    s_add_u32 s32, s32, 5
    s_lshl_b32 s71, s32, 5
    v_add_u32 v8, s71, v6
    v_add_u32 v9, s71, v7
    v_add_u32 v14, 135168, v10
    v_bfe_u32 v188, v1, 2, 2
    v_lshlrev_b32 v250, 8, v188
    v_lshrrev_b32 v188, 4, v1
    v_lshl_add_u32 v250, v188, 6, v250
    v_and_b32 v188, 3, v1
    v_lshl_add_u32 v250, v188, 4, v250
    v_add_u32 v251, 4096, v250
    s_lshl_b32 s33, s61, 3
    s_lshl_b32 s71, s60, 1
    s_add_u32 s33, s33, s71
    s_mul_i32 s36, s33, 20480
    s_add_u32 s37, s36, 4096
    s_add_u32 s38, s36, 8192
    s_add_u32 s39, s36, 12288
    s_add_u32 s40, s36, 16384
    s_add_u32 s41, s36, 20480
    s_add_u32 s42, s36, 24576
    s_add_u32 s43, s36, 28672
    s_add_u32 s44, s36, 32768
    s_add_u32 s45, s36, 36864
    v_and_b32 v188, 15, v1
    s_lshl_b32 s71, s61, 10
    s_add_u32 s71, s71, 15351808
    v_lshl_add_u32 v12, v188, 6, s71
    s_cmp_eq_u32 s62, 0
    s_cselect_b32 s71, 128, 0
    s_cmp_eq_u32 s61, 0
    s_cselect_b32 s71, 0, s71
    v_subrev_u32 v189, s71, v12
    v_lshrrev_b32 v188, 1, v1
    v_cmp_eq_u32 vcc, 8, v188
    s_nop 1
    v_cndmask_b32 v12, v12, v189, vcc
    s_mul_i32 s71, s60, 14
    s_add_u32 s72, s71, 7
    s_min_u32 s72, s72, 47
    s_mul_i32 s73, s77, 5120
    s_add_u32 s73, s73, 13139968
    s_mul_i32 s100, s71, 40960
    s_add_u32 s100, s100, s73
    s_mul_i32 s101, s72, 40960
    s_add_u32 s101, s101, s73
    s_lshr_b32 s71, s76, 1
    s_lshl_b32 s71, s71, 10
    s_lshl_b32 s72, s60, 7
    s_add_u32 s71, s71, s72
    s_add_u32 s71, s71, 15385088
    v_and_b32 v188, 1, v1
    v_lshl_add_u32 v15, v188, 6, s71
    s_cmp_lt_u32 s60, 2
    s_cbranch_scc1 L_pro_join
    s_and_b32 s71, s60, 1
    s_mul_i32 s50, s71, 8448
    s_add_u32 s51, s50, 4224
    s_lshl_b32 s72, s65, 4
    s_mul_i32 s52, s71, s72
    s_lshl_b32 s72, s65, 3
    s_add_u32 s53, s52, s72
    v_lshlrev_b32 v197, 8, v193
    v_and_b32 v188, 3, v1
    v_lshl_add_u32 v197, v188, 3, v197
    v_add_u32 v197, s55, v197
    s_waitcnt vmcnt(0)
    v_mov_b32 v189, 155648
L_gate:
    ds_read_b32 v188, v189 offset:0
    s_waitcnt lgkmcnt(0)
    v_readfirstlane_b32 s72, v188
    s_nop 0
    s_cmp_ge_u32 s72, 2
    s_cbranch_scc0 L_gate
    s_add_u32 m0, s50, 0
    s_nop 0
    buffer_load_dwordx4 v2, s[8:11], s52 offen offset:0 lds
    buffer_load_dwordx4 v3, s[8:11], s52 offen offset:1056 lds
    buffer_load_dwordx4 v4, s[8:11], s52 offen offset:2112 lds
    buffer_load_dwordx4 v5, s[8:11], s52 offen offset:3168 lds
    s_add_u32 s52, s52, s66
    s_add_u32 m0, s51, 0
    s_nop 0
    buffer_load_dwordx4 v2, s[8:11], s53 offen offset:0 lds
    buffer_load_dwordx4 v3, s[8:11], s53 offen offset:1056 lds
    buffer_load_dwordx4 v4, s[8:11], s53 offen offset:2112 lds
    buffer_load_dwordx4 v5, s[8:11], s53 offen offset:3168 lds
    s_add_u32 s53, s53, s66
    s_add_u32 m0, s50, 16896
    s_nop 0
    buffer_load_dwordx4 v2, s[8:11], s52 offen offset:0 lds
    buffer_load_dwordx4 v3, s[8:11], s52 offen offset:1056 lds
    buffer_load_dwordx4 v4, s[8:11], s52 offen offset:2112 lds
    buffer_load_dwordx4 v5, s[8:11], s52 offen offset:3168 lds
    s_add_u32 s52, s52, s66
    s_add_u32 m0, s51, 16896
    s_nop 0
    buffer_load_dwordx4 v2, s[8:11], s53 offen offset:0 lds
    buffer_load_dwordx4 v3, s[8:11], s53 offen offset:1056 lds
    buffer_load_dwordx4 v4, s[8:11], s53 offen offset:2112 lds
    buffer_load_dwordx4 v5, s[8:11], s53 offen offset:3168 lds
    s_add_u32 s53, s53, s66
    s_waitcnt vmcnt(8)
    ds_read_b64_tr_b16 v[16:17], v197 offset:0
    ds_read_b64_tr_b16 v[18:19], v197 offset:4096
    ds_read_b64_tr_b16 v[20:21], v197 offset:32
    ds_read_b64_tr_b16 v[22:23], v197 offset:4128
    ds_read_b64_tr_b16 v[24:25], v197 offset:64
    ds_read_b64_tr_b16 v[26:27], v197 offset:4160
    ds_read_b64_tr_b16 v[28:29], v197 offset:96
    ds_read_b64_tr_b16 v[30:31], v197 offset:4192
    ds_read_b64_tr_b16 v[32:33], v197 offset:128
    ds_read_b64_tr_b16 v[34:35], v197 offset:4224
    ds_read_b64_tr_b16 v[36:37], v197 offset:160
    ds_read_b64_tr_b16 v[38:39], v197 offset:4256
    ds_read_b64_tr_b16 v[40:41], v197 offset:192
    ds_read_b64_tr_b16 v[42:43], v197 offset:4288
    ds_read_b64_tr_b16 v[44:45], v197 offset:224
    ds_read_b64_tr_b16 v[46:47], v197 offset:4320
    s_add_u32 m0, s50, 33792
    s_nop 0
    buffer_load_dwordx4 v2, s[8:11], s52 offen offset:0 lds
    buffer_load_dwordx4 v3, s[8:11], s52 offen offset:1056 lds
    buffer_load_dwordx4 v4, s[8:11], s52 offen offset:2112 lds
    buffer_load_dwordx4 v5, s[8:11], s52 offen offset:3168 lds
    s_add_u32 s52, s52, s66
    s_add_u32 m0, s51, 33792
    s_nop 0
    buffer_load_dwordx4 v2, s[8:11], s53 offen offset:0 lds
    buffer_load_dwordx4 v3, s[8:11], s53 offen offset:1056 lds
    buffer_load_dwordx4 v4, s[8:11], s53 offen offset:2112 lds
    buffer_load_dwordx4 v5, s[8:11], s53 offen offset:3168 lds
    s_add_u32 s53, s53, s66
    s_waitcnt vmcnt(8)
    s_add_u32 m0, s50, 50688
    s_nop 0
    buffer_load_dwordx4 v2, s[8:11], s52 offen offset:0 lds
    buffer_load_dwordx4 v3, s[8:11], s52 offen offset:1056 lds
    buffer_load_dwordx4 v4, s[8:11], s52 offen offset:2112 lds
    buffer_load_dwordx4 v5, s[8:11], s52 offen offset:3168 lds
    s_add_u32 s52, s52, s66
    s_add_u32 m0, s51, 50688
    s_nop 0
    buffer_load_dwordx4 v2, s[8:11], s53 offen offset:0 lds
    buffer_load_dwordx4 v3, s[8:11], s53 offen offset:1056 lds
    buffer_load_dwordx4 v4, s[8:11], s53 offen offset:2112 lds
    buffer_load_dwordx4 v5, s[8:11], s53 offen offset:3168 lds
    s_add_u32 s53, s53, s66
    s_waitcnt vmcnt(8)
    s_waitcnt lgkmcnt(14)
    buffer_store_dwordx4 v[16:19], v10, s[12:15], s54 offen offset:0 sc1
    s_waitcnt lgkmcnt(12)
    buffer_store_dwordx4 v[20:23], v10, s[12:15], s54 offen offset:1024 sc1
    s_waitcnt lgkmcnt(10)
    buffer_store_dwordx4 v[24:27], v10, s[12:15], s54 offen offset:2048 sc1
    s_waitcnt lgkmcnt(8)
    buffer_store_dwordx4 v[28:31], v10, s[12:15], s54 offen offset:3072 sc1
    s_waitcnt lgkmcnt(6)
    buffer_store_dwordx4 v[32:35], v11, s[12:15], s54 offen offset:0 sc1
    s_waitcnt lgkmcnt(4)
    buffer_store_dwordx4 v[36:39], v11, s[12:15], s54 offen offset:1024 sc1
    s_waitcnt lgkmcnt(2)
    buffer_store_dwordx4 v[40:43], v11, s[12:15], s54 offen offset:2048 sc1
    s_waitcnt lgkmcnt(0)
    buffer_store_dwordx4 v[44:47], v11, s[12:15], s54 offen offset:3072 sc1
    s_waitcnt vmcnt(8)
    s_waitcnt lgkmcnt(0)
L_pro_join:
    s_nop 4
    s_mul_i32 s16, s60, 40960
    s_mul_i32 s71, s77, 5120
    s_add_u32 s16, s16, s71
    s_add_u32 s16, s16, 12320768
    s_mul_i32 s17, s60, 5120
    s_cmp_eq_u32 s60, 3
    s_cselect_b32 s18, 1073741824, 0
    s_cmp_eq_u32 s62, 1
    s_cbranch_scc1 L_ffn
    s_lshl_b32 s71, s61, 3
    s_sub_u32 s71, s71, 1
    s_mul_i32 s71, s71, 20480
    s_mul_i32 s72, s60, 5120
    s_add_u32 s71, s71, s72
    s_cmp_eq_u32 s61, 0
    s_cselect_b32 s73, 1073741824, s71
    v_add_u32 v190, s72, v14
    v_and_b32 v192, 8, v1
    v_bfe_u32 v193, v1, 2, 1
    v_add_u32 v192, v192, v193
    v_and_b32 v193, 3, v1
    v_lshl_add_u32 v192, v193, 1, v192
    v_mul_u32_u24 v217, 496, v192
    v_lshrrev_b32 v193, 4, v1
    v_lshl_add_u32 v217, v193, 3, v217
    s_mul_i32 s71, s60, 15872
    s_add_u32 s71, s71, 75520
    v_add_u32 v216, s71, v217
    s_lshl_b32 s71, s32, 5
    s_add_u32 s71, s71, 67584
    v_add_u32 v217, s71, v217
    s_lshr_b32 s71, s60, 1
    s_mul_i32 s71, s71, 80
    s_and_b32 s68, s60, 1
    s_mul_i32 s68, s68, 31744
    s_add_u32 s71, s71, s68
    s_add_u32 s71, s71, 67584
    v_and_b32 v192, 56, v1
    v_bfe_u32 v193, v1, 2, 1
    v_add_u32 v192, v192, v193
    v_and_b32 v193, 3, v1
    v_lshl_add_u32 v192, v193, 1, v192
    v_mul_u32_u24 v218, 496, v192
    v_add_u32 v218, s71, v218
    v_and_b32 v219, 0x30, v1
    v_bfe_u32 v193, v1, 1, 1
    v_lshl_add_u32 v219, v193, 3, v219
    v_and_b32 v193, 1, v1
    v_add_u32 v219, v219, v193
    v_bfe_u32 v193, v1, 2, 2
    v_lshl_add_u32 v219, v193, 1, v219
    v_mul_u32_u24 v219, 496, v219
    v_add_u32 v219, s71, v219
    v_lshrrev_b32 v193, 4, v1
    v_mul_u32_u24 v220, 75776, v193
    v_and_b32 v193, 15, v1
    v_lshl_add_u32 v220, v193, 4, v220
    v_and_b32 v193, 3, v1
    v_mov_b32 v192, 0xffff
    v_cmp_le_u32 vcc, 1, v193
    s_nop 1
    v_cndmask_b32 v221, v192, -1, vcc
    v_cmp_le_u32 vcc, 2, v193
    s_nop 1
    v_cndmask_b32 v222, 0, v192, vcc
    v_cmp_le_u32 vcc, 3, v193
    s_nop 1
    v_cndmask_b32 v222, v222, -1, vcc
    s_lshl_b32 s35, s61, 1
    s_and_b32 s68, s60, 1
    s_add_u32 s35, s35, s68
    s_mul_i32 s35, s35, 303104
    s_add_u32 s35, s35, 2621440
    s_mul_i32 s71, s63, 2560
    s_add_u32 s35, s35, s71
    s_lshr_b32 s71, s60, 1
    s_mul_i32 s71, s71, 1280
    s_add_u32 s35, s35, s71
    s_mov_b32 s70, s73
    s_mul_i32 s71, s76, 303104
    s_add_u32 s71, s71, 2641920
    s_mul_i32 s72, s60, 14
    s_add_u32 s73, s72, 7
    s_min_u32 s73, s73, 47
    s_lshl_b32 s72, s72, 10
    s_add_u32 s72, s71, s72
    s_lshl_b32 s73, s73, 10
    s_add_u32 s73, s71, s73
    s_add_u32 s71, s60, 1
    s_and_b32 s71, s71, 3
    s_mul_i32 s71, s71, 75776
    s_add_u32 s24, s72, s71
    s_add_u32 s28, s73, s71
    s_add_u32 s71, s60, 2
    s_and_b32 s71, s71, 3
    s_mul_i32 s71, s71, 75776
    s_add_u32 s25, s72, s71
    s_add_u32 s29, s73, s71
    s_add_u32 s71, s60, 3
    s_and_b32 s71, s71, 3
    s_mul_i32 s71, s71, 75776
    s_add_u32 s26, s72, s71
    s_add_u32 s30, s73, s71
    s_add_u32 s71, s60, 4
    s_and_b32 s71, s71, 3
    s_mul_i32 s71, s71, 75776
    s_add_u32 s27, s72, s71
    s_add_u32 s31, s73, s71
    s_cmp_eq_u32 s60, 0
    s_cbranch_scc0 L_lnw_1
    buffer_load_dword v13, v12, s[12:15], 0 offen sc1
    s_waitcnt vmcnt(0)
    v_cmp_ne_u32 vcc, s79, v13
    s_mov_b32 s78, 0
    s_nop 3
    s_cbranch_vccz L_polled_ln_3
L_poll_ln_2:
    s_sleep 1
    buffer_load_dword v13, v12, s[12:15], 0 offen sc1
    s_waitcnt vmcnt(0)
    v_cmp_ne_u32 vcc, s79, v13
    s_add_u32 s78, s78, 1
    s_nop 3
    s_cbranch_vccz L_polled_ln_3
    s_cmp_lt_u32 s78, 0x40000
    s_cbranch_scc1 L_poll_ln_2
L_polled_ln_3:
L_lnw_1:
    s_waitcnt lgkmcnt(0)
    s_barrier
    buffer_load_dwordx4 v[196:199], v250, s[12:15], s70 offen offset:0 sc1
    buffer_load_dwordx4 v[200:203], v250, s[12:15], s70 offen offset:1024 sc1
    buffer_load_dwordx4 v[204:207], v250, s[12:15], s70 offen offset:2048 sc1
    buffer_load_dwordx4 v[208:211], v250, s[12:15], s70 offen offset:3072 sc1
    buffer_load_dwordx4 v[212:215], v251, s[12:15], s70 offen offset:0 sc1
    buffer_load_dwordx4 a[112:115], v250, s[12:15], s36 offen offset:0 sc1
    buffer_load_dwordx4 a[116:119], v250, s[12:15], s41 offen offset:0 sc1
    buffer_load_dwordx4 a[120:123], v250, s[12:15], s36 offen offset:1024 sc1
    buffer_load_dwordx4 a[124:127], v250, s[12:15], s41 offen offset:1024 sc1
    buffer_load_dwordx4 a[128:131], v250, s[12:15], s36 offen offset:2048 sc1
    buffer_load_dwordx4 a[132:135], v250, s[12:15], s41 offen offset:2048 sc1
    buffer_load_dwordx4 a[136:139], v250, s[12:15], s36 offen offset:3072 sc1
    buffer_load_dwordx4 a[140:143], v250, s[12:15], s41 offen offset:3072 sc1
    v_mov_b32 v189, 155648
    ds_read_b32 v188, v189 offset:4
    s_waitcnt lgkmcnt(0)
    v_readfirstlane_b32 s79, v188
    s_waitcnt vmcnt(12)
    ds_write_b128 v190, v[196:199] offset:0
    s_waitcnt vmcnt(11)
    ds_write_b128 v190, v[200:203] offset:1024
    s_waitcnt vmcnt(10)
    ds_write_b128 v190, v[204:207] offset:2048
    s_waitcnt vmcnt(9)
    ds_write_b128 v190, v[208:211] offset:3072
    s_waitcnt vmcnt(8)
    ds_write_b128 v190, v[212:215] offset:4096
    s_waitcnt lgkmcnt(0)
    s_barrier
    ds_read_b128 v[180:183], v14 offset:0
    ds_read_b64_tr_b16 v[148:149], v6 offset:0
    ds_read_b64_tr_b16 v[150:151], v6 offset:512
    ds_read_b64_tr_b16 v[152:153], v6 offset:32
    ds_read_b64_tr_b16 v[154:155], v6 offset:544
    ds_read_b64_tr_b16 v[156:157], v6 offset:64
    ds_read_b64_tr_b16 v[158:159], v6 offset:576
    ds_read_b64_tr_b16 v[160:161], v6 offset:96
    ds_read_b64_tr_b16 v[162:163], v6 offset:608
    ds_read_b64_tr_b16 v[164:165], v6 offset:128
    ds_read_b64_tr_b16 v[166:167], v6 offset:640
    ds_read_b64_tr_b16 v[168:169], v8 offset:0
    ds_read_b64_tr_b16 v[170:171], v8 offset:512
    ds_read_b64_tr_b16 v[172:173], v6 offset:160
    ds_read_b64_tr_b16 v[174:175], v6 offset:672
    s_cmp_eq_u32 s60, 0
    s_mov_b32 s71, 1073741824
    s_cselect_b32 s71, 15400960, s71
    v_lshl_add_u32 v12, v1, 6, s71
    s_waitcnt vmcnt(6) lgkmcnt(10)
    v_mfma_f32_16x16x32_bf16 v[16:19], v[148:151], a[112:115], 0
    ds_read_b64_tr_b16 v[176:177], v6 offset:192
    ds_read_b64_tr_b16 v[178:179], v6 offset:704
    v_mfma_f32_16x16x32_bf16 v[20:23], v[148:151], a[116:119], 0
    buffer_load_dwordx4 a[144:147], v250, s[12:15], s37 offen offset:0 sc1
    v_mfma_f32_16x16x32_bf16 v[24:27], v[152:155], a[112:115], 0
    ds_read_b64_tr_b16 v[148:149], v6 offset:224
    ds_read_b64_tr_b16 v[150:151], v6 offset:736
    v_mfma_f32_16x16x32_bf16 v[28:31], v[152:155], a[116:119], 0
    s_waitcnt lgkmcnt(10)
    s_add_u32 m0, s74, 67584
    v_mfma_f32_16x16x32_bf16 v[32:35], v[156:159], a[112:115], 0
    ds_read_b64_tr_b16 v[152:153], v6 offset:256
    ds_read_b64_tr_b16 v[154:155], v6 offset:768
    v_mfma_f32_16x16x32_bf16 v[36:39], v[156:159], a[116:119], 0
    ds_read_b128 v[184:187], v14 offset:1024
    v_mfma_f32_16x16x32_bf16 v[40:43], v[160:163], a[112:115], 0
    ds_read_b64_tr_b16 v[156:157], v6 offset:288
    ds_read_b64_tr_b16 v[158:159], v6 offset:800
    v_mfma_f32_16x16x32_bf16 v[44:47], v[160:163], a[116:119], 0
    s_waitcnt lgkmcnt(9)
    v_mfma_f32_16x16x32_bf16 v[48:51], v[164:167], a[112:115], 0
    ds_read_b64_tr_b16 v[160:161], v8 offset:32
    ds_read_b64_tr_b16 v[162:163], v8 offset:544
    v_mfma_f32_16x16x32_bf16 v[52:55], v[164:167], a[116:119], 0
    buffer_load_dwordx4 v2, s[8:11], s75 offen offset:0 lds
    v_mfma_f32_16x16x32_bf16 v[136:139], v[168:171], v[180:183], 0
    ds_read_b64_tr_b16 v[164:165], v6 offset:320
    ds_read_b64_tr_b16 v[166:167], v6 offset:832
    v_mfma_f32_16x16x32_bf16 v[56:59], v[172:175], a[112:115], 0
    ds_read_b64_tr_b16 v[168:169], v6 offset:352
    ds_read_b64_tr_b16 v[170:171], v6 offset:864
    v_mfma_f32_16x16x32_bf16 v[60:63], v[172:175], a[116:119], 0
    s_waitcnt lgkmcnt(11)
    v_mfma_f32_16x16x32_bf16 v[64:67], v[176:179], a[112:115], 0
    ds_read_b64_tr_b16 v[172:173], v6 offset:384
    ds_read_b64_tr_b16 v[174:175], v6 offset:896
    v_mfma_f32_16x16x32_bf16 v[68:71], v[176:179], a[116:119], 0
    buffer_load_dwordx4 v3, s[8:11], s75 offen offset:1056 lds
    v_mfma_f32_16x16x32_bf16 v[72:75], v[148:151], a[112:115], 0
    ds_read_b64_tr_b16 v[176:177], v6 offset:416
    ds_read_b64_tr_b16 v[178:179], v6 offset:928
    v_mfma_f32_16x16x32_bf16 v[76:79], v[148:151], a[116:119], 0
    s_waitcnt lgkmcnt(10)
    v_mfma_f32_16x16x32_bf16 v[80:83], v[152:155], a[112:115], 0
    ds_read_b64_tr_b16 v[148:149], v8 offset:64
    ds_read_b64_tr_b16 v[150:151], v8 offset:576
    v_mfma_f32_16x16x32_bf16 v[84:87], v[152:155], a[116:119], 0
    buffer_load_dwordx4 a[148:151], v250, s[12:15], s42 offen offset:0 sc1
    v_mfma_f32_16x16x32_bf16 v[88:91], v[156:159], a[112:115], 0
    ds_read_b64_tr_b16 v[152:153], v6 offset:448
    ds_read_b64_tr_b16 v[154:155], v6 offset:960
    v_mfma_f32_16x16x32_bf16 v[92:95], v[156:159], a[116:119], 0
    s_waitcnt lgkmcnt(10)
    v_mfma_f32_16x16x32_bf16 v[140:143], v[160:163], v[180:183], 0
    ds_read_b64_tr_b16 v[156:157], v6 offset:16896
    ds_read_b64_tr_b16 v[158:159], v6 offset:17408
    v_mfma_f32_16x16x32_bf16 v[96:99], v[164:167], a[112:115], 0
    ds_read_b64_tr_b16 v[160:161], v6 offset:16928
    ds_read_b64_tr_b16 v[162:163], v6 offset:17440
    v_mfma_f32_16x16x32_bf16 v[100:103], v[164:167], a[116:119], 0
    s_waitcnt lgkmcnt(10)
    v_mfma_f32_16x16x32_bf16 v[104:107], v[168:171], a[112:115], 0
    ds_read_b64_tr_b16 v[164:165], v6 offset:16960
    ds_read_b64_tr_b16 v[166:167], v6 offset:17472
    v_mfma_f32_16x16x32_bf16 v[108:111], v[168:171], a[116:119], 0
    buffer_load_dwordx4 v4, s[8:11], s75 offen offset:2112 lds
    v_mfma_f32_16x16x32_bf16 v[112:115], v[172:175], a[112:115], 0
    ds_read_b64_tr_b16 v[168:169], v6 offset:16992
    ds_read_b64_tr_b16 v[170:171], v6 offset:17504
    v_mfma_f32_16x16x32_bf16 v[116:119], v[172:175], a[116:119], 0
    s_waitcnt lgkmcnt(8)
    v_mfma_f32_16x16x32_bf16 v[120:123], v[176:179], a[112:115], 0
    ds_read_b64_tr_b16 v[172:173], v6 offset:17024
    ds_read_b64_tr_b16 v[174:175], v6 offset:17536
    v_mfma_f32_16x16x32_bf16 v[124:127], v[176:179], a[116:119], 0
    buffer_load_dwordx4 v5, s[8:11], s75 offen offset:3168 lds
    v_mfma_f32_16x16x32_bf16 v[144:147], v[148:151], v[180:183], 0
    ds_read_b64_tr_b16 v[176:177], v8 offset:16896
    ds_read_b64_tr_b16 v[178:179], v8 offset:17408
    s_add_u32 s75, s75, s66
    buffer_load_dword v191, v0, s[8:11], 0 offen
    v_mfma_f32_16x16x32_bf16 v[128:131], v[152:155], a[112:115], 0
    ds_read_b64_tr_b16 v[148:149], v6 offset:17056
    ds_read_b64_tr_b16 v[150:151], v6 offset:17568
    v_mfma_f32_16x16x32_bf16 v[132:135], v[152:155], a[116:119], 0
    s_waitcnt vmcnt(11) lgkmcnt(10)
    v_mfma_f32_16x16x32_bf16 v[16:19], v[156:159], a[120:123], v[16:19]
    ds_read_b64_tr_b16 v[152:153], v6 offset:17088
    ds_read_b64_tr_b16 v[154:155], v6 offset:17600
    v_mfma_f32_16x16x32_bf16 v[20:23], v[156:159], a[124:127], v[20:23]
    buffer_load_dwordx4 a[152:155], v250, s[12:15], s37 offen offset:1024 sc1
    v_mfma_f32_16x16x32_bf16 v[24:27], v[160:163], a[120:123], v[24:27]
    ds_read_b64_tr_b16 v[156:157], v6 offset:17120
    ds_read_b64_tr_b16 v[158:159], v6 offset:17632
    v_mfma_f32_16x16x32_bf16 v[28:31], v[160:163], a[124:127], v[28:31]
    s_waitcnt lgkmcnt(10)
    s_add_u32 m0, s74, 84480
    v_mfma_f32_16x16x32_bf16 v[32:35], v[164:167], a[120:123], v[32:35]
    ds_read_b64_tr_b16 v[160:161], v6 offset:17152
    ds_read_b64_tr_b16 v[162:163], v6 offset:17664
    v_mfma_f32_16x16x32_bf16 v[36:39], v[164:167], a[124:127], v[36:39]
    ds_read_b128 v[180:183], v14 offset:2048
    v_mfma_f32_16x16x32_bf16 v[40:43], v[168:171], a[120:123], v[40:43]
    ds_read_b64_tr_b16 v[164:165], v6 offset:17184
    ds_read_b64_tr_b16 v[166:167], v6 offset:17696
    v_mfma_f32_16x16x32_bf16 v[44:47], v[168:171], a[124:127], v[44:47]
    s_waitcnt lgkmcnt(9)
    v_mfma_f32_16x16x32_bf16 v[48:51], v[172:175], a[120:123], v[48:51]
    ds_read_b64_tr_b16 v[168:169], v8 offset:16928
    ds_read_b64_tr_b16 v[170:171], v8 offset:17440
    v_mfma_f32_16x16x32_bf16 v[52:55], v[172:175], a[124:127], v[52:55]
    buffer_load_dwordx4 v2, s[8:11], s75 offen offset:0 lds
    v_mfma_f32_16x16x32_bf16 v[136:139], v[176:179], v[184:187], v[136:139]
    ds_read_b64_tr_b16 v[172:173], v6 offset:17216
    ds_read_b64_tr_b16 v[174:175], v6 offset:17728
    v_mfma_f32_16x16x32_bf16 v[56:59], v[148:151], a[120:123], v[56:59]
    ds_read_b64_tr_b16 v[176:177], v6 offset:17248
    ds_read_b64_tr_b16 v[178:179], v6 offset:17760
    v_mfma_f32_16x16x32_bf16 v[60:63], v[148:151], a[124:127], v[60:63]
    s_waitcnt lgkmcnt(11)
    v_mfma_f32_16x16x32_bf16 v[64:67], v[152:155], a[120:123], v[64:67]
    ds_read_b64_tr_b16 v[148:149], v6 offset:17280
    ds_read_b64_tr_b16 v[150:151], v6 offset:17792
    v_mfma_f32_16x16x32_bf16 v[68:71], v[152:155], a[124:127], v[68:71]
    buffer_load_dwordx4 v3, s[8:11], s75 offen offset:1056 lds
    v_mfma_f32_16x16x32_bf16 v[72:75], v[156:159], a[120:123], v[72:75]
    ds_read_b64_tr_b16 v[152:153], v6 offset:17312
    ds_read_b64_tr_b16 v[154:155], v6 offset:17824
    v_mfma_f32_16x16x32_bf16 v[76:79], v[156:159], a[124:127], v[76:79]
    s_waitcnt lgkmcnt(10)
    v_mfma_f32_16x16x32_bf16 v[80:83], v[160:163], a[120:123], v[80:83]
    ds_read_b64_tr_b16 v[156:157], v8 offset:16960
    ds_read_b64_tr_b16 v[158:159], v8 offset:17472
    v_mfma_f32_16x16x32_bf16 v[84:87], v[160:163], a[124:127], v[84:87]
    buffer_load_dwordx4 a[156:159], v250, s[12:15], s42 offen offset:1024 sc1
    v_mfma_f32_16x16x32_bf16 v[88:91], v[164:167], a[120:123], v[88:91]
    ds_read_b64_tr_b16 v[160:161], v6 offset:17344
    ds_read_b64_tr_b16 v[162:163], v6 offset:17856
    v_mfma_f32_16x16x32_bf16 v[92:95], v[164:167], a[124:127], v[92:95]
    s_barrier
    s_waitcnt lgkmcnt(10)
    v_mfma_f32_16x16x32_bf16 v[140:143], v[168:171], v[184:187], v[140:143]
    ds_read_b64_tr_b16 v[164:165], v6 offset:33792
    ds_read_b64_tr_b16 v[166:167], v6 offset:34304
    v_mfma_f32_16x16x32_bf16 v[96:99], v[172:175], a[120:123], v[96:99]
    ds_read_b64_tr_b16 v[168:169], v6 offset:33824
    ds_read_b64_tr_b16 v[170:171], v6 offset:34336
    v_mfma_f32_16x16x32_bf16 v[100:103], v[172:175], a[124:127], v[100:103]
    s_waitcnt lgkmcnt(10)
    v_mfma_f32_16x16x32_bf16 v[104:107], v[176:179], a[120:123], v[104:107]
    ds_read_b64_tr_b16 v[172:173], v6 offset:33856
    ds_read_b64_tr_b16 v[174:175], v6 offset:34368
    v_mfma_f32_16x16x32_bf16 v[108:111], v[176:179], a[124:127], v[108:111]
    buffer_load_dwordx4 v4, s[8:11], s75 offen offset:2112 lds
    v_mfma_f32_16x16x32_bf16 v[112:115], v[148:151], a[120:123], v[112:115]
    ds_read_b64_tr_b16 v[176:177], v6 offset:33888
    ds_read_b64_tr_b16 v[178:179], v6 offset:34400
    v_mfma_f32_16x16x32_bf16 v[116:119], v[148:151], a[124:127], v[116:119]
    s_waitcnt lgkmcnt(8)
    v_mfma_f32_16x16x32_bf16 v[120:123], v[152:155], a[120:123], v[120:123]
    ds_read_b64_tr_b16 v[148:149], v6 offset:33920
    ds_read_b64_tr_b16 v[150:151], v6 offset:34432
    v_mfma_f32_16x16x32_bf16 v[124:127], v[152:155], a[124:127], v[124:127]
    buffer_load_dwordx4 v5, s[8:11], s75 offen offset:3168 lds
    v_mfma_f32_16x16x32_bf16 v[144:147], v[156:159], v[184:187], v[144:147]
    ds_read_b64_tr_b16 v[152:153], v8 offset:33792
    ds_read_b64_tr_b16 v[154:155], v8 offset:34304
    s_add_u32 s75, s75, s66
    s_lshl_b32 s71, s65, 8
    buffer_load_dword v190, v0, s[8:11], s71 offen
    v_mfma_f32_16x16x32_bf16 v[128:131], v[160:163], a[120:123], v[128:131]
    ds_read_b64_tr_b16 v[156:157], v6 offset:33952
    ds_read_b64_tr_b16 v[158:159], v6 offset:34464
    v_mfma_f32_16x16x32_bf16 v[132:135], v[160:163], a[124:127], v[132:135]
    s_waitcnt vmcnt(16) lgkmcnt(10)
    s_lshr_b32 s71, s2, 2
    s_lshl_b32 s71, s71, 6
    v_mfma_f32_16x16x32_bf16 v[16:19], v[164:167], a[128:131], v[16:19]
    ds_read_b64_tr_b16 v[160:161], v6 offset:33984
    ds_read_b64_tr_b16 v[162:163], v6 offset:34496
    v_mfma_f32_16x16x32_bf16 v[20:23], v[164:167], a[132:135], v[20:23]
    ds_read_b128 v[184:187], v14 offset:3072
    s_and_b32 s72, s2, 3
    s_lshl_b32 s72, s72, 2
    v_mfma_f32_16x16x32_bf16 v[24:27], v[168:171], a[128:131], v[24:27]
    ds_read_b64_tr_b16 v[164:165], v6 offset:34016
    ds_read_b64_tr_b16 v[166:167], v6 offset:34528
    v_mfma_f32_16x16x32_bf16 v[28:31], v[168:171], a[132:135], v[28:31]
    s_waitcnt lgkmcnt(11)
    s_add_u32 s71, s71, s72
    s_add_u32 s71, s71, 15400960
    v_mfma_f32_16x16x32_bf16 v[32:35], v[172:175], a[128:131], v[32:35]
    ds_read_b64_tr_b16 v[168:169], v6 offset:34048
    ds_read_b64_tr_b16 v[170:171], v6 offset:34560
    v_mfma_f32_16x16x32_bf16 v[36:39], v[172:175], a[132:135], v[36:39]
    s_cmp_eq_u32 s60, 1
    s_cselect_b32 s71, s71, 1073741824
    v_mov_b32 v188, s79
    v_mfma_f32_16x16x32_bf16 v[40:43], v[176:179], a[128:131], v[40:43]
    ds_read_b64_tr_b16 v[172:173], v6 offset:34080
    ds_read_b64_tr_b16 v[174:175], v6 offset:34592
    v_mfma_f32_16x16x32_bf16 v[44:47], v[176:179], a[132:135], v[44:47]
    s_waitcnt lgkmcnt(9)
    v_lshlrev_b32 v189, 24, v1
    v_mfma_f32_16x16x32_bf16 v[48:51], v[148:151], a[128:131], v[48:51]
    ds_read_b64_tr_b16 v[176:177], v8 offset:33824
    ds_read_b64_tr_b16 v[178:179], v8 offset:34336
    v_mfma_f32_16x16x32_bf16 v[52:55], v[148:151], a[132:135], v[52:55]
    buffer_store_dword v188, v189, s[12:15], s71 offen sc1
    v_mfma_f32_16x16x32_bf16 v[136:139], v[152:155], v[180:183], v[136:139]
    ds_read_b64_tr_b16 v[148:149], v6 offset:34112
    ds_read_b64_tr_b16 v[150:151], v6 offset:34624
    v_mfma_f32_16x16x32_bf16 v[56:59], v[156:159], a[128:131], v[56:59]
    ds_read_b64_tr_b16 v[152:153], v6 offset:34144
    ds_read_b64_tr_b16 v[154:155], v6 offset:34656
    v_mfma_f32_16x16x32_bf16 v[60:63], v[156:159], a[132:135], v[60:63]
    s_waitcnt lgkmcnt(10)
    buffer_load_dwordx4 a[112:115], v250, s[12:15], s37 offen offset:2048 sc1
    v_mfma_f32_16x16x32_bf16 v[64:67], v[160:163], a[128:131], v[64:67]
    ds_read_b64_tr_b16 v[156:157], v6 offset:34176
    ds_read_b64_tr_b16 v[158:159], v6 offset:34688
    v_mfma_f32_16x16x32_bf16 v[68:71], v[160:163], a[132:135], v[68:71]
    s_add_u32 m0, s74, 101376
    s_nop 0
    buffer_load_dwordx4 v2, s[8:11], s75 offen offset:0 lds
    v_mfma_f32_16x16x32_bf16 v[72:75], v[164:167], a[128:131], v[72:75]
    ds_read_b64_tr_b16 v[160:161], v6 offset:34208
    ds_read_b64_tr_b16 v[162:163], v6 offset:34720
    v_mfma_f32_16x16x32_bf16 v[76:79], v[164:167], a[132:135], v[76:79]
    s_waitcnt lgkmcnt(10)
    buffer_load_dwordx4 v3, s[8:11], s75 offen offset:1056 lds
    v_mfma_f32_16x16x32_bf16 v[80:83], v[168:171], a[128:131], v[80:83]
    ds_read_b64_tr_b16 v[164:165], v8 offset:33856
    ds_read_b64_tr_b16 v[166:167], v8 offset:34368
    v_mfma_f32_16x16x32_bf16 v[84:87], v[168:171], a[132:135], v[84:87]
    buffer_load_dwordx4 a[116:119], v250, s[12:15], s42 offen offset:2048 sc1
    v_mfma_f32_16x16x32_bf16 v[88:91], v[172:175], a[128:131], v[88:91]
    ds_read_b64_tr_b16 v[168:169], v6 offset:34240
    ds_read_b64_tr_b16 v[170:171], v6 offset:34752
    v_mfma_f32_16x16x32_bf16 v[92:95], v[172:175], a[132:135], v[92:95]
    s_waitcnt lgkmcnt(10)
    buffer_load_dwordx4 v4, s[8:11], s75 offen offset:2112 lds
    v_mfma_f32_16x16x32_bf16 v[140:143], v[176:179], v[180:183], v[140:143]
    ds_read_b64_tr_b16 v[172:173], v6 offset:50688
    ds_read_b64_tr_b16 v[174:175], v6 offset:51200
    v_mfma_f32_16x16x32_bf16 v[96:99], v[148:151], a[128:131], v[96:99]
    ds_read_b64_tr_b16 v[176:177], v6 offset:50720
    ds_read_b64_tr_b16 v[178:179], v6 offset:51232
    v_mfma_f32_16x16x32_bf16 v[100:103], v[148:151], a[132:135], v[100:103]
    s_waitcnt lgkmcnt(10)
    buffer_load_dwordx4 v5, s[8:11], s75 offen offset:3168 lds
    v_mfma_f32_16x16x32_bf16 v[104:107], v[152:155], a[128:131], v[104:107]
    ds_read_b64_tr_b16 v[148:149], v6 offset:50752
    ds_read_b64_tr_b16 v[150:151], v6 offset:51264
    v_mfma_f32_16x16x32_bf16 v[108:111], v[152:155], a[132:135], v[108:111]
    s_add_u32 s75, s75, s66
    v_mfma_f32_16x16x32_bf16 v[112:115], v[156:159], a[128:131], v[112:115]
    ds_read_b64_tr_b16 v[152:153], v6 offset:50784
    ds_read_b64_tr_b16 v[154:155], v6 offset:51296
    v_mfma_f32_16x16x32_bf16 v[116:119], v[156:159], a[132:135], v[116:119]
    s_waitcnt lgkmcnt(8)
    v_mfma_f32_16x16x32_bf16 v[120:123], v[160:163], a[128:131], v[120:123]
    ds_read_b64_tr_b16 v[156:157], v6 offset:50816
    ds_read_b64_tr_b16 v[158:159], v6 offset:51328
    v_mfma_f32_16x16x32_bf16 v[124:127], v[160:163], a[132:135], v[124:127]
    v_mfma_f32_16x16x32_bf16 v[144:147], v[164:167], v[180:183], v[144:147]
    ds_read_b64_tr_b16 v[160:161], v8 offset:50688
    ds_read_b64_tr_b16 v[162:163], v8 offset:51200
    v_mfma_f32_16x16x32_bf16 v[128:131], v[168:171], a[128:131], v[128:131]
    ds_read_b64_tr_b16 v[164:165], v6 offset:50848
    ds_read_b64_tr_b16 v[166:167], v6 offset:51360
    v_mfma_f32_16x16x32_bf16 v[132:135], v[168:171], a[132:135], v[132:135]
    s_waitcnt vmcnt(21) lgkmcnt(10)
    v_mfma_f32_16x16x32_bf16 v[16:19], v[172:175], a[136:139], v[16:19]
    ds_read_b64_tr_b16 v[168:169], v6 offset:50880
    ds_read_b64_tr_b16 v[170:171], v6 offset:51392
    v_mfma_f32_16x16x32_bf16 v[20:23], v[172:175], a[140:143], v[20:23]
    buffer_load_dwordx4 a[120:123], v250, s[12:15], s37 offen offset:3072 sc1
    v_mfma_f32_16x16x32_bf16 v[24:27], v[176:179], a[136:139], v[24:27]
    ds_read_b64_tr_b16 v[172:173], v6 offset:50912
    ds_read_b64_tr_b16 v[174:175], v6 offset:51424
    v_mfma_f32_16x16x32_bf16 v[28:31], v[176:179], a[140:143], v[28:31]
    s_waitcnt lgkmcnt(10)
    s_add_u32 m0, s74, 118272
    v_mfma_f32_16x16x32_bf16 v[32:35], v[148:151], a[136:139], v[32:35]
    ds_read_b64_tr_b16 v[176:177], v6 offset:50944
    ds_read_b64_tr_b16 v[178:179], v6 offset:51456
    v_mfma_f32_16x16x32_bf16 v[36:39], v[148:151], a[140:143], v[36:39]
    ds_read_b128 v[180:183], v14 offset:4096
    v_mfma_f32_16x16x32_bf16 v[40:43], v[152:155], a[136:139], v[40:43]
    ds_read_b64_tr_b16 v[148:149], v6 offset:50976
    ds_read_b64_tr_b16 v[150:151], v6 offset:51488
    v_mfma_f32_16x16x32_bf16 v[44:47], v[152:155], a[140:143], v[44:47]
    s_waitcnt lgkmcnt(9)
    v_mfma_f32_16x16x32_bf16 v[48:51], v[156:159], a[136:139], v[48:51]
    ds_read_b64_tr_b16 v[152:153], v8 offset:50720
    ds_read_b64_tr_b16 v[154:155], v8 offset:51232
    v_mfma_f32_16x16x32_bf16 v[52:55], v[156:159], a[140:143], v[52:55]
    buffer_load_dwordx4 v2, s[8:11], s75 offen offset:0 lds
    v_mfma_f32_16x16x32_bf16 v[136:139], v[160:163], v[184:187], v[136:139]
    ds_read_b64_tr_b16 v[156:157], v6 offset:51008
    ds_read_b64_tr_b16 v[158:159], v6 offset:51520
    v_mfma_f32_16x16x32_bf16 v[56:59], v[164:167], a[136:139], v[56:59]
    ds_read_b64_tr_b16 v[160:161], v6 offset:51040
    ds_read_b64_tr_b16 v[162:163], v6 offset:51552
    v_mfma_f32_16x16x32_bf16 v[60:63], v[164:167], a[140:143], v[60:63]
    s_waitcnt lgkmcnt(11)
    v_mfma_f32_16x16x32_bf16 v[64:67], v[168:171], a[136:139], v[64:67]
    ds_read_b64_tr_b16 v[164:165], v6 offset:51072
    ds_read_b64_tr_b16 v[166:167], v6 offset:51584
    v_mfma_f32_16x16x32_bf16 v[68:71], v[168:171], a[140:143], v[68:71]
    buffer_load_dwordx4 v3, s[8:11], s75 offen offset:1056 lds
    v_mfma_f32_16x16x32_bf16 v[72:75], v[172:175], a[136:139], v[72:75]
    ds_read_b64_tr_b16 v[168:169], v6 offset:51104
    ds_read_b64_tr_b16 v[170:171], v6 offset:51616
    v_mfma_f32_16x16x32_bf16 v[76:79], v[172:175], a[140:143], v[76:79]
    s_waitcnt lgkmcnt(10)
    v_mfma_f32_16x16x32_bf16 v[80:83], v[176:179], a[136:139], v[80:83]
    ds_read_b64_tr_b16 v[172:173], v8 offset:50752
    ds_read_b64_tr_b16 v[174:175], v8 offset:51264
    v_mfma_f32_16x16x32_bf16 v[84:87], v[176:179], a[140:143], v[84:87]
    buffer_load_dwordx4 a[124:127], v250, s[12:15], s42 offen offset:3072 sc1
    v_mfma_f32_16x16x32_bf16 v[88:91], v[148:151], a[136:139], v[88:91]
    ds_read_b64_tr_b16 v[176:177], v6 offset:51136
    ds_read_b64_tr_b16 v[178:179], v6 offset:51648
    v_mfma_f32_16x16x32_bf16 v[92:95], v[148:151], a[140:143], v[92:95]
    s_waitcnt vmcnt(12)
    s_barrier
    s_waitcnt lgkmcnt(10)
    v_mfma_f32_16x16x32_bf16 v[140:143], v[152:155], v[184:187], v[140:143]
    ds_read_b64_tr_b16 v[148:149], v7 offset:0
    ds_read_b64_tr_b16 v[150:151], v7 offset:512
    v_mfma_f32_16x16x32_bf16 v[96:99], v[156:159], a[136:139], v[96:99]
    ds_read_b64_tr_b16 v[152:153], v7 offset:32
    ds_read_b64_tr_b16 v[154:155], v7 offset:544
    v_mfma_f32_16x16x32_bf16 v[100:103], v[156:159], a[140:143], v[100:103]
    s_waitcnt lgkmcnt(10)
    v_mfma_f32_16x16x32_bf16 v[104:107], v[160:163], a[136:139], v[104:107]
    ds_read_b64_tr_b16 v[156:157], v7 offset:64
    ds_read_b64_tr_b16 v[158:159], v7 offset:576
    v_mfma_f32_16x16x32_bf16 v[108:111], v[160:163], a[140:143], v[108:111]
    buffer_load_dwordx4 v4, s[8:11], s75 offen offset:2112 lds
    v_mfma_f32_16x16x32_bf16 v[112:115], v[164:167], a[136:139], v[112:115]
    ds_read_b64_tr_b16 v[160:161], v7 offset:96
    ds_read_b64_tr_b16 v[162:163], v7 offset:608
    v_mfma_f32_16x16x32_bf16 v[116:119], v[164:167], a[140:143], v[116:119]
    s_waitcnt lgkmcnt(8)
    v_mfma_f32_16x16x32_bf16 v[120:123], v[168:171], a[136:139], v[120:123]
    ds_read_b64_tr_b16 v[164:165], v7 offset:128
    ds_read_b64_tr_b16 v[166:167], v7 offset:640
    v_mfma_f32_16x16x32_bf16 v[124:127], v[168:171], a[140:143], v[124:127]
    buffer_load_dwordx4 v5, s[8:11], s75 offen offset:3168 lds
    v_mfma_f32_16x16x32_bf16 v[144:147], v[172:175], v[184:187], v[144:147]
    ds_read_b64_tr_b16 v[168:169], v9 offset:0
    ds_read_b64_tr_b16 v[170:171], v9 offset:512
    s_add_u32 s75, s75, s66
    v_mfma_f32_16x16x32_bf16 v[128:131], v[176:179], a[136:139], v[128:131]
    ds_read_b64_tr_b16 v[172:173], v7 offset:160
    ds_read_b64_tr_b16 v[174:175], v7 offset:672
    v_mfma_f32_16x16x32_bf16 v[132:135], v[176:179], a[140:143], v[132:135]
    s_waitcnt lgkmcnt(10)
    v_mfma_f32_16x16x32_bf16 v[16:19], v[148:151], a[144:147], v[16:19]
    ds_read_b64_tr_b16 v[176:177], v7 offset:192
    ds_read_b64_tr_b16 v[178:179], v7 offset:704
    v_mfma_f32_16x16x32_bf16 v[20:23], v[148:151], a[148:151], v[20:23]
    buffer_load_dwordx4 a[128:131], v250, s[12:15], s38 offen offset:0 sc1
    v_mfma_f32_16x16x32_bf16 v[24:27], v[152:155], a[144:147], v[24:27]
    ds_read_b64_tr_b16 v[148:149], v7 offset:224
    ds_read_b64_tr_b16 v[150:151], v7 offset:736
    v_mfma_f32_16x16x32_bf16 v[28:31], v[152:155], a[148:151], v[28:31]
    s_waitcnt lgkmcnt(10)
    s_add_u32 m0, s74, 0
    v_mfma_f32_16x16x32_bf16 v[32:35], v[156:159], a[144:147], v[32:35]
    ds_read_b64_tr_b16 v[152:153], v7 offset:256
    ds_read_b64_tr_b16 v[154:155], v7 offset:768
    v_mfma_f32_16x16x32_bf16 v[36:39], v[156:159], a[148:151], v[36:39]
    ds_read_b128 v[184:187], v14 offset:5120
    v_mfma_f32_16x16x32_bf16 v[40:43], v[160:163], a[144:147], v[40:43]
    ds_read_b64_tr_b16 v[156:157], v7 offset:288
    ds_read_b64_tr_b16 v[158:159], v7 offset:800
    v_mfma_f32_16x16x32_bf16 v[44:47], v[160:163], a[148:151], v[44:47]
    s_waitcnt lgkmcnt(9)
    v_mfma_f32_16x16x32_bf16 v[48:51], v[164:167], a[144:147], v[48:51]
    ds_read_b64_tr_b16 v[160:161], v9 offset:32
    ds_read_b64_tr_b16 v[162:163], v9 offset:544
    v_mfma_f32_16x16x32_bf16 v[52:55], v[164:167], a[148:151], v[52:55]
    buffer_load_dwordx4 v2, s[8:11], s75 offen offset:0 lds
    v_mfma_f32_16x16x32_bf16 v[136:139], v[168:171], v[180:183], v[136:139]
    ds_read_b64_tr_b16 v[164:165], v7 offset:320
    ds_read_b64_tr_b16 v[166:167], v7 offset:832
    v_mfma_f32_16x16x32_bf16 v[56:59], v[172:175], a[144:147], v[56:59]
    ds_read_b64_tr_b16 v[168:169], v7 offset:352
    ds_read_b64_tr_b16 v[170:171], v7 offset:864
    v_mfma_f32_16x16x32_bf16 v[60:63], v[172:175], a[148:151], v[60:63]
    s_waitcnt lgkmcnt(11)
    v_mfma_f32_16x16x32_bf16 v[64:67], v[176:179], a[144:147], v[64:67]
    ds_read_b64_tr_b16 v[172:173], v7 offset:384
    ds_read_b64_tr_b16 v[174:175], v7 offset:896
    v_mfma_f32_16x16x32_bf16 v[68:71], v[176:179], a[148:151], v[68:71]
    buffer_load_dwordx4 v3, s[8:11], s75 offen offset:1056 lds
    v_mfma_f32_16x16x32_bf16 v[72:75], v[148:151], a[144:147], v[72:75]
    ds_read_b64_tr_b16 v[176:177], v7 offset:416
    ds_read_b64_tr_b16 v[178:179], v7 offset:928
    v_mfma_f32_16x16x32_bf16 v[76:79], v[148:151], a[148:151], v[76:79]
    s_waitcnt lgkmcnt(10)
    v_mfma_f32_16x16x32_bf16 v[80:83], v[152:155], a[144:147], v[80:83]
    ds_read_b64_tr_b16 v[148:149], v9 offset:64
    ds_read_b64_tr_b16 v[150:151], v9 offset:576
    v_mfma_f32_16x16x32_bf16 v[84:87], v[152:155], a[148:151], v[84:87]
    buffer_load_dwordx4 a[132:135], v250, s[12:15], s43 offen offset:0 sc1
    v_mfma_f32_16x16x32_bf16 v[88:91], v[156:159], a[144:147], v[88:91]
    ds_read_b64_tr_b16 v[152:153], v7 offset:448
    ds_read_b64_tr_b16 v[154:155], v7 offset:960
    v_mfma_f32_16x16x32_bf16 v[92:95], v[156:159], a[148:151], v[92:95]
    s_waitcnt lgkmcnt(10)
    v_mfma_f32_16x16x32_bf16 v[140:143], v[160:163], v[180:183], v[140:143]
    ds_read_b64_tr_b16 v[156:157], v7 offset:16896
    ds_read_b64_tr_b16 v[158:159], v7 offset:17408
    v_mfma_f32_16x16x32_bf16 v[96:99], v[164:167], a[144:147], v[96:99]
    ds_read_b64_tr_b16 v[160:161], v7 offset:16928
    ds_read_b64_tr_b16 v[162:163], v7 offset:17440
    v_mfma_f32_16x16x32_bf16 v[100:103], v[164:167], a[148:151], v[100:103]
    s_waitcnt lgkmcnt(10)
    v_mfma_f32_16x16x32_bf16 v[104:107], v[168:171], a[144:147], v[104:107]
    ds_read_b64_tr_b16 v[164:165], v7 offset:16960
    ds_read_b64_tr_b16 v[166:167], v7 offset:17472
    v_mfma_f32_16x16x32_bf16 v[108:111], v[168:171], a[148:151], v[108:111]
    buffer_load_dwordx4 v4, s[8:11], s75 offen offset:2112 lds
    v_mfma_f32_16x16x32_bf16 v[112:115], v[172:175], a[144:147], v[112:115]
    ds_read_b64_tr_b16 v[168:169], v7 offset:16992
    ds_read_b64_tr_b16 v[170:171], v7 offset:17504
    v_mfma_f32_16x16x32_bf16 v[116:119], v[172:175], a[148:151], v[116:119]
    s_waitcnt lgkmcnt(8)
    v_mfma_f32_16x16x32_bf16 v[120:123], v[176:179], a[144:147], v[120:123]
    ds_read_b64_tr_b16 v[172:173], v7 offset:17024
    ds_read_b64_tr_b16 v[174:175], v7 offset:17536
    v_mfma_f32_16x16x32_bf16 v[124:127], v[176:179], a[148:151], v[124:127]
    buffer_load_dwordx4 v5, s[8:11], s75 offen offset:3168 lds
    v_mfma_f32_16x16x32_bf16 v[144:147], v[148:151], v[180:183], v[144:147]
    ds_read_b64_tr_b16 v[176:177], v9 offset:16896
    ds_read_b64_tr_b16 v[178:179], v9 offset:17408
    s_add_u32 s75, s75, s66
    v_mfma_f32_16x16x32_bf16 v[128:131], v[152:155], a[144:147], v[128:131]
    ds_read_b64_tr_b16 v[148:149], v7 offset:17056
    ds_read_b64_tr_b16 v[150:151], v7 offset:17568
    v_mfma_f32_16x16x32_bf16 v[132:135], v[152:155], a[148:151], v[132:135]
    s_waitcnt lgkmcnt(10)
    v_mfma_f32_16x16x32_bf16 v[16:19], v[156:159], a[152:155], v[16:19]
    ds_read_b64_tr_b16 v[152:153], v7 offset:17088
    ds_read_b64_tr_b16 v[154:155], v7 offset:17600
    v_mfma_f32_16x16x32_bf16 v[20:23], v[156:159], a[156:159], v[20:23]
    buffer_load_dwordx4 a[136:139], v250, s[12:15], s38 offen offset:1024 sc1
    v_mfma_f32_16x16x32_bf16 v[24:27], v[160:163], a[152:155], v[24:27]
    ds_read_b64_tr_b16 v[156:157], v7 offset:17120
    ds_read_b64_tr_b16 v[158:159], v7 offset:17632
    v_mfma_f32_16x16x32_bf16 v[28:31], v[160:163], a[156:159], v[28:31]
    s_waitcnt lgkmcnt(10)
    s_add_u32 m0, s74, 16896
    v_mfma_f32_16x16x32_bf16 v[32:35], v[164:167], a[152:155], v[32:35]
    ds_read_b64_tr_b16 v[160:161], v7 offset:17152
    ds_read_b64_tr_b16 v[162:163], v7 offset:17664
    v_mfma_f32_16x16x32_bf16 v[36:39], v[164:167], a[156:159], v[36:39]
    ds_read_b128 v[180:183], v14 offset:6144
    v_mfma_f32_16x16x32_bf16 v[40:43], v[168:171], a[152:155], v[40:43]
    ds_read_b64_tr_b16 v[164:165], v7 offset:17184
    ds_read_b64_tr_b16 v[166:167], v7 offset:17696
    v_mfma_f32_16x16x32_bf16 v[44:47], v[168:171], a[156:159], v[44:47]
    s_waitcnt lgkmcnt(9)
    v_mfma_f32_16x16x32_bf16 v[48:51], v[172:175], a[152:155], v[48:51]
    ds_read_b64_tr_b16 v[168:169], v9 offset:16928
    ds_read_b64_tr_b16 v[170:171], v9 offset:17440
    v_mfma_f32_16x16x32_bf16 v[52:55], v[172:175], a[156:159], v[52:55]
    buffer_load_dwordx4 v2, s[8:11], s75 offen offset:0 lds
    v_mfma_f32_16x16x32_bf16 v[136:139], v[176:179], v[184:187], v[136:139]
    ds_read_b64_tr_b16 v[172:173], v7 offset:17216
    ds_read_b64_tr_b16 v[174:175], v7 offset:17728
    v_mfma_f32_16x16x32_bf16 v[56:59], v[148:151], a[152:155], v[56:59]
    ds_read_b64_tr_b16 v[176:177], v7 offset:17248
    ds_read_b64_tr_b16 v[178:179], v7 offset:17760
    v_mfma_f32_16x16x32_bf16 v[60:63], v[148:151], a[156:159], v[60:63]
    s_waitcnt lgkmcnt(11)
    v_mfma_f32_16x16x32_bf16 v[64:67], v[152:155], a[152:155], v[64:67]
    ds_read_b64_tr_b16 v[148:149], v7 offset:17280
    ds_read_b64_tr_b16 v[150:151], v7 offset:17792
    v_mfma_f32_16x16x32_bf16 v[68:71], v[152:155], a[156:159], v[68:71]
    buffer_load_dwordx4 v3, s[8:11], s75 offen offset:1056 lds
    v_mfma_f32_16x16x32_bf16 v[72:75], v[156:159], a[152:155], v[72:75]
    ds_read_b64_tr_b16 v[152:153], v7 offset:17312
    ds_read_b64_tr_b16 v[154:155], v7 offset:17824
    v_mfma_f32_16x16x32_bf16 v[76:79], v[156:159], a[156:159], v[76:79]
    s_waitcnt lgkmcnt(10)
    v_mfma_f32_16x16x32_bf16 v[80:83], v[160:163], a[152:155], v[80:83]
    ds_read_b64_tr_b16 v[156:157], v9 offset:16960
    ds_read_b64_tr_b16 v[158:159], v9 offset:17472
    v_mfma_f32_16x16x32_bf16 v[84:87], v[160:163], a[156:159], v[84:87]
    buffer_load_dwordx4 a[140:143], v250, s[12:15], s43 offen offset:1024 sc1
    v_mfma_f32_16x16x32_bf16 v[88:91], v[164:167], a[152:155], v[88:91]
    ds_read_b64_tr_b16 v[160:161], v7 offset:17344
    ds_read_b64_tr_b16 v[162:163], v7 offset:17856
    v_mfma_f32_16x16x32_bf16 v[92:95], v[164:167], a[156:159], v[92:95]
    s_waitcnt vmcnt(10)
    s_barrier
    s_waitcnt lgkmcnt(10)
    v_mfma_f32_16x16x32_bf16 v[140:143], v[168:171], v[184:187], v[140:143]
    ds_read_b64_tr_b16 v[164:165], v7 offset:33792
    ds_read_b64_tr_b16 v[166:167], v7 offset:34304
    v_mfma_f32_16x16x32_bf16 v[96:99], v[172:175], a[152:155], v[96:99]
    ds_read_b64_tr_b16 v[168:169], v7 offset:33824
    ds_read_b64_tr_b16 v[170:171], v7 offset:34336
    v_mfma_f32_16x16x32_bf16 v[100:103], v[172:175], a[156:159], v[100:103]
    s_waitcnt lgkmcnt(10)
    v_mfma_f32_16x16x32_bf16 v[104:107], v[176:179], a[152:155], v[104:107]
    ds_read_b64_tr_b16 v[172:173], v7 offset:33856
    ds_read_b64_tr_b16 v[174:175], v7 offset:34368
    v_mfma_f32_16x16x32_bf16 v[108:111], v[176:179], a[156:159], v[108:111]
    buffer_load_dwordx4 v4, s[8:11], s75 offen offset:2112 lds
    v_mfma_f32_16x16x32_bf16 v[112:115], v[148:151], a[152:155], v[112:115]
    ds_read_b64_tr_b16 v[176:177], v7 offset:33888
    ds_read_b64_tr_b16 v[178:179], v7 offset:34400
    v_mfma_f32_16x16x32_bf16 v[116:119], v[148:151], a[156:159], v[116:119]
    s_waitcnt lgkmcnt(8)
    v_mfma_f32_16x16x32_bf16 v[120:123], v[152:155], a[152:155], v[120:123]
    ds_read_b64_tr_b16 v[148:149], v7 offset:33920
    ds_read_b64_tr_b16 v[150:151], v7 offset:34432
    v_mfma_f32_16x16x32_bf16 v[124:127], v[152:155], a[156:159], v[124:127]
    buffer_load_dwordx4 v5, s[8:11], s75 offen offset:3168 lds
    v_mfma_f32_16x16x32_bf16 v[144:147], v[156:159], v[184:187], v[144:147]
    ds_read_b64_tr_b16 v[152:153], v9 offset:33792
    ds_read_b64_tr_b16 v[154:155], v9 offset:34304
    s_add_u32 s75, s75, s66
    v_mfma_f32_16x16x32_bf16 v[128:131], v[160:163], a[152:155], v[128:131]
    ds_read_b64_tr_b16 v[156:157], v7 offset:33952
    ds_read_b64_tr_b16 v[158:159], v7 offset:34464
    v_mfma_f32_16x16x32_bf16 v[132:135], v[160:163], a[156:159], v[132:135]
    s_waitcnt lgkmcnt(10)
    v_mfma_f32_16x16x32_bf16 v[16:19], v[164:167], a[112:115], v[16:19]
    ds_read_b64_tr_b16 v[160:161], v7 offset:33984
    ds_read_b64_tr_b16 v[162:163], v7 offset:34496
    v_mfma_f32_16x16x32_bf16 v[20:23], v[164:167], a[116:119], v[20:23]
    buffer_load_dwordx4 a[144:147], v250, s[12:15], s38 offen offset:2048 sc1
    v_mfma_f32_16x16x32_bf16 v[24:27], v[168:171], a[112:115], v[24:27]
    ds_read_b64_tr_b16 v[164:165], v7 offset:34016
    ds_read_b64_tr_b16 v[166:167], v7 offset:34528
    v_mfma_f32_16x16x32_bf16 v[28:31], v[168:171], a[116:119], v[28:31]
    s_waitcnt lgkmcnt(10)
    s_add_u32 m0, s74, 33792
    v_mfma_f32_16x16x32_bf16 v[32:35], v[172:175], a[112:115], v[32:35]
    ds_read_b64_tr_b16 v[168:169], v7 offset:34048
    ds_read_b64_tr_b16 v[170:171], v7 offset:34560
    v_mfma_f32_16x16x32_bf16 v[36:39], v[172:175], a[116:119], v[36:39]
    ds_read_b128 v[184:187], v14 offset:7168
    v_mfma_f32_16x16x32_bf16 v[40:43], v[176:179], a[112:115], v[40:43]
    ds_read_b64_tr_b16 v[172:173], v7 offset:34080
    ds_read_b64_tr_b16 v[174:175], v7 offset:34592
    v_mfma_f32_16x16x32_bf16 v[44:47], v[176:179], a[116:119], v[44:47]
    s_waitcnt lgkmcnt(9)
    v_mfma_f32_16x16x32_bf16 v[48:51], v[148:151], a[112:115], v[48:51]
    ds_read_b64_tr_b16 v[176:177], v9 offset:33824
    ds_read_b64_tr_b16 v[178:179], v9 offset:34336
    v_mfma_f32_16x16x32_bf16 v[52:55], v[148:151], a[116:119], v[52:55]
    buffer_load_dwordx4 v2, s[8:11], s75 offen offset:0 lds
    v_mfma_f32_16x16x32_bf16 v[136:139], v[152:155], v[180:183], v[136:139]
    ds_read_b64_tr_b16 v[148:149], v7 offset:34112
    ds_read_b64_tr_b16 v[150:151], v7 offset:34624
    v_mfma_f32_16x16x32_bf16 v[56:59], v[156:159], a[112:115], v[56:59]
    ds_read_b64_tr_b16 v[152:153], v7 offset:34144
    ds_read_b64_tr_b16 v[154:155], v7 offset:34656
    v_mfma_f32_16x16x32_bf16 v[60:63], v[156:159], a[116:119], v[60:63]
    s_waitcnt lgkmcnt(11)
    v_mfma_f32_16x16x32_bf16 v[64:67], v[160:163], a[112:115], v[64:67]
    ds_read_b64_tr_b16 v[156:157], v7 offset:34176
    ds_read_b64_tr_b16 v[158:159], v7 offset:34688
    v_mfma_f32_16x16x32_bf16 v[68:71], v[160:163], a[116:119], v[68:71]
    buffer_load_dwordx4 v3, s[8:11], s75 offen offset:1056 lds
    v_mfma_f32_16x16x32_bf16 v[72:75], v[164:167], a[112:115], v[72:75]
    ds_read_b64_tr_b16 v[160:161], v7 offset:34208
    ds_read_b64_tr_b16 v[162:163], v7 offset:34720
    v_mfma_f32_16x16x32_bf16 v[76:79], v[164:167], a[116:119], v[76:79]
    s_waitcnt lgkmcnt(10)
    v_mfma_f32_16x16x32_bf16 v[80:83], v[168:171], a[112:115], v[80:83]
    ds_read_b64_tr_b16 v[164:165], v9 offset:33856
    ds_read_b64_tr_b16 v[166:167], v9 offset:34368
    v_mfma_f32_16x16x32_bf16 v[84:87], v[168:171], a[116:119], v[84:87]
    buffer_load_dwordx4 a[148:151], v250, s[12:15], s43 offen offset:2048 sc1
    v_mfma_f32_16x16x32_bf16 v[88:91], v[172:175], a[112:115], v[88:91]
    ds_read_b64_tr_b16 v[168:169], v7 offset:34240
    ds_read_b64_tr_b16 v[170:171], v7 offset:34752
    v_mfma_f32_16x16x32_bf16 v[92:95], v[172:175], a[116:119], v[92:95]
    s_waitcnt lgkmcnt(10)
    v_mfma_f32_16x16x32_bf16 v[140:143], v[176:179], v[180:183], v[140:143]
    ds_read_b64_tr_b16 v[172:173], v7 offset:50688
    ds_read_b64_tr_b16 v[174:175], v7 offset:51200
    v_mfma_f32_16x16x32_bf16 v[96:99], v[148:151], a[112:115], v[96:99]
    ds_read_b64_tr_b16 v[176:177], v7 offset:50720
    ds_read_b64_tr_b16 v[178:179], v7 offset:51232
    v_mfma_f32_16x16x32_bf16 v[100:103], v[148:151], a[116:119], v[100:103]
    s_waitcnt lgkmcnt(10)
    v_mfma_f32_16x16x32_bf16 v[104:107], v[152:155], a[112:115], v[104:107]
    ds_read_b64_tr_b16 v[148:149], v7 offset:50752
    ds_read_b64_tr_b16 v[150:151], v7 offset:51264
    v_mfma_f32_16x16x32_bf16 v[108:111], v[152:155], a[116:119], v[108:111]
    buffer_load_dwordx4 v4, s[8:11], s75 offen offset:2112 lds
    v_mfma_f32_16x16x32_bf16 v[112:115], v[156:159], a[112:115], v[112:115]
    ds_read_b64_tr_b16 v[152:153], v7 offset:50784
    ds_read_b64_tr_b16 v[154:155], v7 offset:51296
    v_mfma_f32_16x16x32_bf16 v[116:119], v[156:159], a[116:119], v[116:119]
    s_waitcnt lgkmcnt(8)
    v_mfma_f32_16x16x32_bf16 v[120:123], v[160:163], a[112:115], v[120:123]
    ds_read_b64_tr_b16 v[156:157], v7 offset:50816
    ds_read_b64_tr_b16 v[158:159], v7 offset:51328
    v_mfma_f32_16x16x32_bf16 v[124:127], v[160:163], a[116:119], v[124:127]
    buffer_load_dwordx4 v5, s[8:11], s75 offen offset:3168 lds
    v_mfma_f32_16x16x32_bf16 v[144:147], v[164:167], v[180:183], v[144:147]
    ds_read_b64_tr_b16 v[160:161], v9 offset:50688
    ds_read_b64_tr_b16 v[162:163], v9 offset:51200
    s_add_u32 s75, s75, s66
    v_mfma_f32_16x16x32_bf16 v[128:131], v[168:171], a[112:115], v[128:131]
    ds_read_b64_tr_b16 v[164:165], v7 offset:50848
    ds_read_b64_tr_b16 v[166:167], v7 offset:51360
    v_mfma_f32_16x16x32_bf16 v[132:135], v[168:171], a[116:119], v[132:135]
    s_waitcnt lgkmcnt(10)
    v_mfma_f32_16x16x32_bf16 v[16:19], v[172:175], a[120:123], v[16:19]
    ds_read_b64_tr_b16 v[168:169], v7 offset:50880
    ds_read_b64_tr_b16 v[170:171], v7 offset:51392
    v_mfma_f32_16x16x32_bf16 v[20:23], v[172:175], a[124:127], v[20:23]
    buffer_load_dwordx4 a[152:155], v250, s[12:15], s38 offen offset:3072 sc1
    v_mfma_f32_16x16x32_bf16 v[24:27], v[176:179], a[120:123], v[24:27]
    ds_read_b64_tr_b16 v[172:173], v7 offset:50912
    ds_read_b64_tr_b16 v[174:175], v7 offset:51424
    v_mfma_f32_16x16x32_bf16 v[28:31], v[176:179], a[124:127], v[28:31]
    s_waitcnt lgkmcnt(10)
    s_add_u32 m0, s74, 50688
    v_mfma_f32_16x16x32_bf16 v[32:35], v[148:151], a[120:123], v[32:35]
    ds_read_b64_tr_b16 v[176:177], v7 offset:50944
    ds_read_b64_tr_b16 v[178:179], v7 offset:51456
    v_mfma_f32_16x16x32_bf16 v[36:39], v[148:151], a[124:127], v[36:39]
    ds_read_b128 v[180:183], v14 offset:8192
    v_mfma_f32_16x16x32_bf16 v[40:43], v[152:155], a[120:123], v[40:43]
    ds_read_b64_tr_b16 v[148:149], v7 offset:50976
    ds_read_b64_tr_b16 v[150:151], v7 offset:51488
    v_mfma_f32_16x16x32_bf16 v[44:47], v[152:155], a[124:127], v[44:47]
    s_waitcnt lgkmcnt(9)
    v_mfma_f32_16x16x32_bf16 v[48:51], v[156:159], a[120:123], v[48:51]
    ds_read_b64_tr_b16 v[152:153], v9 offset:50720
    ds_read_b64_tr_b16 v[154:155], v9 offset:51232
    v_mfma_f32_16x16x32_bf16 v[52:55], v[156:159], a[124:127], v[52:55]
    buffer_load_dwordx4 v2, s[8:11], s75 offen offset:0 lds
    v_mfma_f32_16x16x32_bf16 v[136:139], v[160:163], v[184:187], v[136:139]
    ds_read_b64_tr_b16 v[156:157], v7 offset:51008
    ds_read_b64_tr_b16 v[158:159], v7 offset:51520
    v_mfma_f32_16x16x32_bf16 v[56:59], v[164:167], a[120:123], v[56:59]
    ds_read_b64_tr_b16 v[160:161], v7 offset:51040
    ds_read_b64_tr_b16 v[162:163], v7 offset:51552
    v_mfma_f32_16x16x32_bf16 v[60:63], v[164:167], a[124:127], v[60:63]
    s_waitcnt lgkmcnt(11)
    v_mfma_f32_16x16x32_bf16 v[64:67], v[168:171], a[120:123], v[64:67]
    ds_read_b64_tr_b16 v[164:165], v7 offset:51072
    ds_read_b64_tr_b16 v[166:167], v7 offset:51584
    v_mfma_f32_16x16x32_bf16 v[68:71], v[168:171], a[124:127], v[68:71]
    buffer_load_dwordx4 v3, s[8:11], s75 offen offset:1056 lds
    v_mfma_f32_16x16x32_bf16 v[72:75], v[172:175], a[120:123], v[72:75]
    ds_read_b64_tr_b16 v[168:169], v7 offset:51104
    ds_read_b64_tr_b16 v[170:171], v7 offset:51616
    v_mfma_f32_16x16x32_bf16 v[76:79], v[172:175], a[124:127], v[76:79]
    s_waitcnt lgkmcnt(10)
    v_mfma_f32_16x16x32_bf16 v[80:83], v[176:179], a[120:123], v[80:83]
    ds_read_b64_tr_b16 v[172:173], v9 offset:50752
    ds_read_b64_tr_b16 v[174:175], v9 offset:51264
    v_mfma_f32_16x16x32_bf16 v[84:87], v[176:179], a[124:127], v[84:87]
    buffer_load_dwordx4 a[156:159], v250, s[12:15], s43 offen offset:3072 sc1
    v_mfma_f32_16x16x32_bf16 v[88:91], v[148:151], a[120:123], v[88:91]
    ds_read_b64_tr_b16 v[176:177], v7 offset:51136
    ds_read_b64_tr_b16 v[178:179], v7 offset:51648
    v_mfma_f32_16x16x32_bf16 v[92:95], v[148:151], a[124:127], v[92:95]
    s_waitcnt vmcnt(10)
    s_barrier
    s_waitcnt lgkmcnt(10)
    v_mfma_f32_16x16x32_bf16 v[140:143], v[152:155], v[184:187], v[140:143]
    ds_read_b64_tr_b16 v[148:149], v6 offset:0
    ds_read_b64_tr_b16 v[150:151], v6 offset:512
    v_mfma_f32_16x16x32_bf16 v[96:99], v[156:159], a[120:123], v[96:99]
    ds_read_b64_tr_b16 v[152:153], v6 offset:32
    ds_read_b64_tr_b16 v[154:155], v6 offset:544
    v_mfma_f32_16x16x32_bf16 v[100:103], v[156:159], a[124:127], v[100:103]
    s_waitcnt lgkmcnt(10)
    v_mfma_f32_16x16x32_bf16 v[104:107], v[160:163], a[120:123], v[104:107]
    ds_read_b64_tr_b16 v[156:157], v6 offset:64
    ds_read_b64_tr_b16 v[158:159], v6 offset:576
    v_mfma_f32_16x16x32_bf16 v[108:111], v[160:163], a[124:127], v[108:111]
    buffer_load_dwordx4 v4, s[8:11], s75 offen offset:2112 lds
    v_mfma_f32_16x16x32_bf16 v[112:115], v[164:167], a[120:123], v[112:115]
    ds_read_b64_tr_b16 v[160:161], v6 offset:96
    ds_read_b64_tr_b16 v[162:163], v6 offset:608
    v_mfma_f32_16x16x32_bf16 v[116:119], v[164:167], a[124:127], v[116:119]
    s_waitcnt lgkmcnt(8)
    v_mfma_f32_16x16x32_bf16 v[120:123], v[168:171], a[120:123], v[120:123]
    ds_read_b64_tr_b16 v[164:165], v6 offset:128
    ds_read_b64_tr_b16 v[166:167], v6 offset:640
    v_mfma_f32_16x16x32_bf16 v[124:127], v[168:171], a[124:127], v[124:127]
    buffer_load_dwordx4 v5, s[8:11], s75 offen offset:3168 lds
    v_mfma_f32_16x16x32_bf16 v[144:147], v[172:175], v[184:187], v[144:147]
    ds_read_b64_tr_b16 v[168:169], v8 offset:0
    ds_read_b64_tr_b16 v[170:171], v8 offset:512
    s_add_u32 s75, s75, s66
    buffer_load_dwordx4 v[252:255], v12, s[12:15], 0 offen sc1
    v_mfma_f32_16x16x32_bf16 v[128:131], v[176:179], a[120:123], v[128:131]
    ds_read_b64_tr_b16 v[172:173], v6 offset:160
    ds_read_b64_tr_b16 v[174:175], v6 offset:672
    v_mfma_f32_16x16x32_bf16 v[132:135], v[176:179], a[124:127], v[132:135]
    s_waitcnt lgkmcnt(10)
    v_mfma_f32_16x16x32_bf16 v[16:19], v[148:151], a[128:131], v[16:19]
    ds_read_b64_tr_b16 v[176:177], v6 offset:192
    ds_read_b64_tr_b16 v[178:179], v6 offset:704
    v_mfma_f32_16x16x32_bf16 v[20:23], v[148:151], a[132:135], v[20:23]
    buffer_load_dwordx4 a[112:115], v250, s[12:15], s39 offen offset:0 sc1
    v_mfma_f32_16x16x32_bf16 v[24:27], v[152:155], a[128:131], v[24:27]
    ds_read_b64_tr_b16 v[148:149], v6 offset:224
    ds_read_b64_tr_b16 v[150:151], v6 offset:736
    v_mfma_f32_16x16x32_bf16 v[28:31], v[152:155], a[132:135], v[28:31]
    s_waitcnt lgkmcnt(10)
    s_add_u32 m0, s74, 67584
    v_mfma_f32_16x16x32_bf16 v[32:35], v[156:159], a[128:131], v[32:35]
    ds_read_b64_tr_b16 v[152:153], v6 offset:256
    ds_read_b64_tr_b16 v[154:155], v6 offset:768
    v_mfma_f32_16x16x32_bf16 v[36:39], v[156:159], a[132:135], v[36:39]
    ds_read_b128 v[184:187], v14 offset:9216
    v_mfma_f32_16x16x32_bf16 v[40:43], v[160:163], a[128:131], v[40:43]
    ds_read_b64_tr_b16 v[156:157], v6 offset:288
    ds_read_b64_tr_b16 v[158:159], v6 offset:800
    v_mfma_f32_16x16x32_bf16 v[44:47], v[160:163], a[132:135], v[44:47]
    s_waitcnt lgkmcnt(9)
    v_mfma_f32_16x16x32_bf16 v[48:51], v[164:167], a[128:131], v[48:51]
    ds_read_b64_tr_b16 v[160:161], v8 offset:32
    ds_read_b64_tr_b16 v[162:163], v8 offset:544
    v_mfma_f32_16x16x32_bf16 v[52:55], v[164:167], a[132:135], v[52:55]
    buffer_load_dwordx4 v2, s[8:11], s75 offen offset:0 lds
    v_mfma_f32_16x16x32_bf16 v[136:139], v[168:171], v[180:183], v[136:139]
    ds_read_b64_tr_b16 v[164:165], v6 offset:320
    ds_read_b64_tr_b16 v[166:167], v6 offset:832
    v_mfma_f32_16x16x32_bf16 v[56:59], v[172:175], a[128:131], v[56:59]
    ds_read_b64_tr_b16 v[168:169], v6 offset:352
    ds_read_b64_tr_b16 v[170:171], v6 offset:864
    v_mfma_f32_16x16x32_bf16 v[60:63], v[172:175], a[132:135], v[60:63]
    s_waitcnt lgkmcnt(11)
    v_mfma_f32_16x16x32_bf16 v[64:67], v[176:179], a[128:131], v[64:67]
    ds_read_b64_tr_b16 v[172:173], v6 offset:384
    ds_read_b64_tr_b16 v[174:175], v6 offset:896
    v_mfma_f32_16x16x32_bf16 v[68:71], v[176:179], a[132:135], v[68:71]
    buffer_load_dwordx4 v3, s[8:11], s75 offen offset:1056 lds
    v_mfma_f32_16x16x32_bf16 v[72:75], v[148:151], a[128:131], v[72:75]
    ds_read_b64_tr_b16 v[176:177], v6 offset:416
    ds_read_b64_tr_b16 v[178:179], v6 offset:928
    v_mfma_f32_16x16x32_bf16 v[76:79], v[148:151], a[132:135], v[76:79]
    s_waitcnt lgkmcnt(10)
    v_mfma_f32_16x16x32_bf16 v[80:83], v[152:155], a[128:131], v[80:83]
    ds_read_b64_tr_b16 v[148:149], v8 offset:64
    ds_read_b64_tr_b16 v[150:151], v8 offset:576
    v_mfma_f32_16x16x32_bf16 v[84:87], v[152:155], a[132:135], v[84:87]
    buffer_load_dwordx4 a[116:119], v250, s[12:15], s44 offen offset:0 sc1
    v_mfma_f32_16x16x32_bf16 v[88:91], v[156:159], a[128:131], v[88:91]
    ds_read_b64_tr_b16 v[152:153], v6 offset:448
    ds_read_b64_tr_b16 v[154:155], v6 offset:960
    v_mfma_f32_16x16x32_bf16 v[92:95], v[156:159], a[132:135], v[92:95]
    s_waitcnt lgkmcnt(10)
    v_mfma_f32_16x16x32_bf16 v[140:143], v[160:163], v[180:183], v[140:143]
    ds_read_b64_tr_b16 v[156:157], v6 offset:16896
    ds_read_b64_tr_b16 v[158:159], v6 offset:17408
    v_mfma_f32_16x16x32_bf16 v[96:99], v[164:167], a[128:131], v[96:99]
    ds_read_b64_tr_b16 v[160:161], v6 offset:16928
    ds_read_b64_tr_b16 v[162:163], v6 offset:17440
    v_mfma_f32_16x16x32_bf16 v[100:103], v[164:167], a[132:135], v[100:103]
    s_waitcnt lgkmcnt(10)
    v_mfma_f32_16x16x32_bf16 v[104:107], v[168:171], a[128:131], v[104:107]
    ds_read_b64_tr_b16 v[164:165], v6 offset:16960
    ds_read_b64_tr_b16 v[166:167], v6 offset:17472
    v_mfma_f32_16x16x32_bf16 v[108:111], v[168:171], a[132:135], v[108:111]
    buffer_load_dwordx4 v4, s[8:11], s75 offen offset:2112 lds
    v_mfma_f32_16x16x32_bf16 v[112:115], v[172:175], a[128:131], v[112:115]
    ds_read_b64_tr_b16 v[168:169], v6 offset:16992
    ds_read_b64_tr_b16 v[170:171], v6 offset:17504
    v_mfma_f32_16x16x32_bf16 v[116:119], v[172:175], a[132:135], v[116:119]
    s_waitcnt lgkmcnt(8)
    v_mfma_f32_16x16x32_bf16 v[120:123], v[176:179], a[128:131], v[120:123]
    ds_read_b64_tr_b16 v[172:173], v6 offset:17024
    ds_read_b64_tr_b16 v[174:175], v6 offset:17536
    v_mfma_f32_16x16x32_bf16 v[124:127], v[176:179], a[132:135], v[124:127]
    buffer_load_dwordx4 v5, s[8:11], s75 offen offset:3168 lds
    v_mfma_f32_16x16x32_bf16 v[144:147], v[148:151], v[180:183], v[144:147]
    ds_read_b64_tr_b16 v[176:177], v8 offset:16896
    ds_read_b64_tr_b16 v[178:179], v8 offset:17408
    s_add_u32 s75, s75, s66
    v_mfma_f32_16x16x32_bf16 v[128:131], v[152:155], a[128:131], v[128:131]
    ds_read_b64_tr_b16 v[148:149], v6 offset:17056
    ds_read_b64_tr_b16 v[150:151], v6 offset:17568
    v_mfma_f32_16x16x32_bf16 v[132:135], v[152:155], a[132:135], v[132:135]
    s_waitcnt lgkmcnt(10)
    v_mfma_f32_16x16x32_bf16 v[16:19], v[156:159], a[136:139], v[16:19]
    ds_read_b64_tr_b16 v[152:153], v6 offset:17088
    ds_read_b64_tr_b16 v[154:155], v6 offset:17600
    v_mfma_f32_16x16x32_bf16 v[20:23], v[156:159], a[140:143], v[20:23]
    buffer_load_dwordx4 a[120:123], v250, s[12:15], s39 offen offset:1024 sc1
    v_mfma_f32_16x16x32_bf16 v[24:27], v[160:163], a[136:139], v[24:27]
    ds_read_b64_tr_b16 v[156:157], v6 offset:17120
    ds_read_b64_tr_b16 v[158:159], v6 offset:17632
    v_mfma_f32_16x16x32_bf16 v[28:31], v[160:163], a[140:143], v[28:31]
    s_waitcnt lgkmcnt(10)
    s_add_u32 m0, s74, 84480
    v_mfma_f32_16x16x32_bf16 v[32:35], v[164:167], a[136:139], v[32:35]
    ds_read_b64_tr_b16 v[160:161], v6 offset:17152
    ds_read_b64_tr_b16 v[162:163], v6 offset:17664
    v_mfma_f32_16x16x32_bf16 v[36:39], v[164:167], a[140:143], v[36:39]
    ds_read_b128 v[180:183], v14 offset:10240
    v_mfma_f32_16x16x32_bf16 v[40:43], v[168:171], a[136:139], v[40:43]
    ds_read_b64_tr_b16 v[164:165], v6 offset:17184
    ds_read_b64_tr_b16 v[166:167], v6 offset:17696
    v_mfma_f32_16x16x32_bf16 v[44:47], v[168:171], a[140:143], v[44:47]
    s_waitcnt lgkmcnt(9)
    v_mfma_f32_16x16x32_bf16 v[48:51], v[172:175], a[136:139], v[48:51]
    ds_read_b64_tr_b16 v[168:169], v8 offset:16928
    ds_read_b64_tr_b16 v[170:171], v8 offset:17440
    v_mfma_f32_16x16x32_bf16 v[52:55], v[172:175], a[140:143], v[52:55]
    buffer_load_dwordx4 v2, s[8:11], s75 offen offset:0 lds
    v_mfma_f32_16x16x32_bf16 v[136:139], v[176:179], v[184:187], v[136:139]
    ds_read_b64_tr_b16 v[172:173], v6 offset:17216
    ds_read_b64_tr_b16 v[174:175], v6 offset:17728
    v_mfma_f32_16x16x32_bf16 v[56:59], v[148:151], a[136:139], v[56:59]
    ds_read_b64_tr_b16 v[176:177], v6 offset:17248
    ds_read_b64_tr_b16 v[178:179], v6 offset:17760
    v_mfma_f32_16x16x32_bf16 v[60:63], v[148:151], a[140:143], v[60:63]
    s_waitcnt lgkmcnt(11)
    v_mfma_f32_16x16x32_bf16 v[64:67], v[152:155], a[136:139], v[64:67]
    ds_read_b64_tr_b16 v[148:149], v6 offset:17280
    ds_read_b64_tr_b16 v[150:151], v6 offset:17792
    v_mfma_f32_16x16x32_bf16 v[68:71], v[152:155], a[140:143], v[68:71]
    buffer_load_dwordx4 v3, s[8:11], s75 offen offset:1056 lds
    v_mfma_f32_16x16x32_bf16 v[72:75], v[156:159], a[136:139], v[72:75]
    ds_read_b64_tr_b16 v[152:153], v6 offset:17312
    ds_read_b64_tr_b16 v[154:155], v6 offset:17824
    v_mfma_f32_16x16x32_bf16 v[76:79], v[156:159], a[140:143], v[76:79]
    s_waitcnt lgkmcnt(10)
    v_mfma_f32_16x16x32_bf16 v[80:83], v[160:163], a[136:139], v[80:83]
    ds_read_b64_tr_b16 v[156:157], v8 offset:16960
    ds_read_b64_tr_b16 v[158:159], v8 offset:17472
    v_mfma_f32_16x16x32_bf16 v[84:87], v[160:163], a[140:143], v[84:87]
    buffer_load_dwordx4 a[124:127], v250, s[12:15], s44 offen offset:1024 sc1
    v_mfma_f32_16x16x32_bf16 v[88:91], v[164:167], a[136:139], v[88:91]
    ds_read_b64_tr_b16 v[160:161], v6 offset:17344
    ds_read_b64_tr_b16 v[162:163], v6 offset:17856
    v_mfma_f32_16x16x32_bf16 v[92:95], v[164:167], a[140:143], v[92:95]
    s_waitcnt vmcnt(11)
    s_waitcnt vmcnt(10)
    s_cmp_eq_u32 s60, 0
    s_cbranch_scc0 L_wtw_4
    v_xor_b32 v252, s79, v252
    v_xor_b32 v253, s79, v253
    v_xor_b32 v254, s79, v254
    v_xor_b32 v255, s79, v255
    v_or3_b32 v252, v252, v253, v254
    v_or_b32 v252, v252, v255
    v_cmp_ne_u32 vcc, 0, v252
    s_mov_b32 s78, 0
    s_nop 3
    s_cbranch_vccz L_polled_wt_6
L_poll_wt_5:
    s_sleep 8
    buffer_load_dwordx4 v[252:255], v12, s[12:15], 0 offen sc1
    s_waitcnt vmcnt(0)
    v_xor_b32 v252, s79, v252
    v_xor_b32 v253, s79, v253
    v_xor_b32 v254, s79, v254
    v_xor_b32 v255, s79, v255
    v_or3_b32 v252, v252, v253, v254
    v_or_b32 v252, v252, v255
    v_cmp_ne_u32 vcc, 0, v252
    s_add_u32 s78, s78, 1
    s_nop 3
    s_cbranch_vccz L_polled_wt_6
    s_cmp_lt_u32 s78, 0x40000
    s_cbranch_scc1 L_poll_wt_5
L_polled_wt_6:
L_wtw_4:
    s_barrier
    s_waitcnt lgkmcnt(10)
    v_mfma_f32_16x16x32_bf16 v[140:143], v[168:171], v[184:187], v[140:143]
    ds_read_b64_tr_b16 v[164:165], v6 offset:33792
    ds_read_b64_tr_b16 v[166:167], v6 offset:34304
    v_mfma_f32_16x16x32_bf16 v[96:99], v[172:175], a[136:139], v[96:99]
    ds_read_b64_tr_b16 v[168:169], v6 offset:33824
    ds_read_b64_tr_b16 v[170:171], v6 offset:34336
    v_mfma_f32_16x16x32_bf16 v[100:103], v[172:175], a[140:143], v[100:103]
    s_waitcnt lgkmcnt(10)
    v_mfma_f32_16x16x32_bf16 v[104:107], v[176:179], a[136:139], v[104:107]
    ds_read_b64_tr_b16 v[172:173], v6 offset:33856
    ds_read_b64_tr_b16 v[174:175], v6 offset:34368
    v_mfma_f32_16x16x32_bf16 v[108:111], v[176:179], a[140:143], v[108:111]
    buffer_load_dwordx4 v4, s[8:11], s75 offen offset:2112 lds
    v_mfma_f32_16x16x32_bf16 v[112:115], v[148:151], a[136:139], v[112:115]
    ds_read_b64_tr_b16 v[176:177], v6 offset:33888
    ds_read_b64_tr_b16 v[178:179], v6 offset:34400
    v_mfma_f32_16x16x32_bf16 v[116:119], v[148:151], a[140:143], v[116:119]
    s_waitcnt lgkmcnt(8)
    v_mfma_f32_16x16x32_bf16 v[120:123], v[152:155], a[136:139], v[120:123]
    ds_read_b64_tr_b16 v[148:149], v6 offset:33920
    ds_read_b64_tr_b16 v[150:151], v6 offset:34432
    v_mfma_f32_16x16x32_bf16 v[124:127], v[152:155], a[140:143], v[124:127]
    buffer_load_dwordx4 v5, s[8:11], s75 offen offset:3168 lds
    v_mfma_f32_16x16x32_bf16 v[144:147], v[156:159], v[184:187], v[144:147]
    ds_read_b64_tr_b16 v[152:153], v8 offset:33792
    ds_read_b64_tr_b16 v[154:155], v8 offset:34304
    s_add_u32 s75, s75, s66
    v_mfma_f32_16x16x32_bf16 v[128:131], v[160:163], a[136:139], v[128:131]
    ds_read_b64_tr_b16 v[156:157], v6 offset:33952
    ds_read_b64_tr_b16 v[158:159], v6 offset:34464
    v_mfma_f32_16x16x32_bf16 v[132:135], v[160:163], a[140:143], v[132:135]
    s_waitcnt lgkmcnt(10)
    v_mfma_f32_16x16x32_bf16 v[16:19], v[164:167], a[144:147], v[16:19]
    ds_read_b64_tr_b16 v[160:161], v6 offset:33984
    ds_read_b64_tr_b16 v[162:163], v6 offset:34496
    v_mfma_f32_16x16x32_bf16 v[20:23], v[164:167], a[148:151], v[20:23]
    buffer_load_dwordx4 a[128:131], v250, s[12:15], s39 offen offset:2048 sc1
    v_mfma_f32_16x16x32_bf16 v[24:27], v[168:171], a[144:147], v[24:27]
    ds_read_b64_tr_b16 v[164:165], v6 offset:34016
    ds_read_b64_tr_b16 v[166:167], v6 offset:34528
    v_mfma_f32_16x16x32_bf16 v[28:31], v[168:171], a[148:151], v[28:31]
    s_waitcnt lgkmcnt(10)
    s_add_u32 m0, s74, 101376
    v_mfma_f32_16x16x32_bf16 v[32:35], v[172:175], a[144:147], v[32:35]
    ds_read_b64_tr_b16 v[168:169], v6 offset:34048
    ds_read_b64_tr_b16 v[170:171], v6 offset:34560
    v_mfma_f32_16x16x32_bf16 v[36:39], v[172:175], a[148:151], v[36:39]
    ds_read_b128 v[184:187], v14 offset:11264
    v_mfma_f32_16x16x32_bf16 v[40:43], v[176:179], a[144:147], v[40:43]
    ds_read_b64_tr_b16 v[172:173], v6 offset:34080
    ds_read_b64_tr_b16 v[174:175], v6 offset:34592
    v_mfma_f32_16x16x32_bf16 v[44:47], v[176:179], a[148:151], v[44:47]
    s_waitcnt lgkmcnt(9)
    v_mfma_f32_16x16x32_bf16 v[48:51], v[148:151], a[144:147], v[48:51]
    ds_read_b64_tr_b16 v[176:177], v8 offset:33824
    ds_read_b64_tr_b16 v[178:179], v8 offset:34336
    v_mfma_f32_16x16x32_bf16 v[52:55], v[148:151], a[148:151], v[52:55]
    buffer_load_dwordx4 v2, s[8:11], s75 offen offset:0 lds
    v_mfma_f32_16x16x32_bf16 v[136:139], v[152:155], v[180:183], v[136:139]
    ds_read_b64_tr_b16 v[148:149], v6 offset:34112
    ds_read_b64_tr_b16 v[150:151], v6 offset:34624
    v_mfma_f32_16x16x32_bf16 v[56:59], v[156:159], a[144:147], v[56:59]
    ds_read_b64_tr_b16 v[152:153], v6 offset:34144
    ds_read_b64_tr_b16 v[154:155], v6 offset:34656
    v_mfma_f32_16x16x32_bf16 v[60:63], v[156:159], a[148:151], v[60:63]
    s_waitcnt lgkmcnt(11)
    v_mfma_f32_16x16x32_bf16 v[64:67], v[160:163], a[144:147], v[64:67]
    ds_read_b64_tr_b16 v[156:157], v6 offset:34176
    ds_read_b64_tr_b16 v[158:159], v6 offset:34688
    v_mfma_f32_16x16x32_bf16 v[68:71], v[160:163], a[148:151], v[68:71]
    buffer_load_dwordx4 v3, s[8:11], s75 offen offset:1056 lds
    v_mfma_f32_16x16x32_bf16 v[72:75], v[164:167], a[144:147], v[72:75]
    ds_read_b64_tr_b16 v[160:161], v6 offset:34208
    ds_read_b64_tr_b16 v[162:163], v6 offset:34720
    v_mfma_f32_16x16x32_bf16 v[76:79], v[164:167], a[148:151], v[76:79]
    s_waitcnt lgkmcnt(10)
    v_mfma_f32_16x16x32_bf16 v[80:83], v[168:171], a[144:147], v[80:83]
    ds_read_b64_tr_b16 v[164:165], v8 offset:33856
    ds_read_b64_tr_b16 v[166:167], v8 offset:34368
    v_mfma_f32_16x16x32_bf16 v[84:87], v[168:171], a[148:151], v[84:87]
    buffer_load_dwordx4 a[132:135], v250, s[12:15], s44 offen offset:2048 sc1
    v_mfma_f32_16x16x32_bf16 v[88:91], v[172:175], a[144:147], v[88:91]
    ds_read_b64_tr_b16 v[168:169], v6 offset:34240
    ds_read_b64_tr_b16 v[170:171], v6 offset:34752
    v_mfma_f32_16x16x32_bf16 v[92:95], v[172:175], a[148:151], v[92:95]
    s_waitcnt lgkmcnt(10)
    v_mfma_f32_16x16x32_bf16 v[140:143], v[176:179], v[180:183], v[140:143]
    ds_read_b64_tr_b16 v[172:173], v6 offset:50688
    ds_read_b64_tr_b16 v[174:175], v6 offset:51200
    v_mfma_f32_16x16x32_bf16 v[96:99], v[148:151], a[144:147], v[96:99]
    ds_read_b64_tr_b16 v[176:177], v6 offset:50720
    ds_read_b64_tr_b16 v[178:179], v6 offset:51232
    v_mfma_f32_16x16x32_bf16 v[100:103], v[148:151], a[148:151], v[100:103]
    s_waitcnt lgkmcnt(10)
    v_mfma_f32_16x16x32_bf16 v[104:107], v[152:155], a[144:147], v[104:107]
    ds_read_b64_tr_b16 v[148:149], v6 offset:50752
    ds_read_b64_tr_b16 v[150:151], v6 offset:51264
    v_mfma_f32_16x16x32_bf16 v[108:111], v[152:155], a[148:151], v[108:111]
    buffer_load_dwordx4 v4, s[8:11], s75 offen offset:2112 lds
    v_mfma_f32_16x16x32_bf16 v[112:115], v[156:159], a[144:147], v[112:115]
    ds_read_b64_tr_b16 v[152:153], v6 offset:50784
    ds_read_b64_tr_b16 v[154:155], v6 offset:51296
    v_mfma_f32_16x16x32_bf16 v[116:119], v[156:159], a[148:151], v[116:119]
    s_waitcnt lgkmcnt(8)
    v_mfma_f32_16x16x32_bf16 v[120:123], v[160:163], a[144:147], v[120:123]
    ds_read_b64_tr_b16 v[156:157], v6 offset:50816
    ds_read_b64_tr_b16 v[158:159], v6 offset:51328
    v_mfma_f32_16x16x32_bf16 v[124:127], v[160:163], a[148:151], v[124:127]
    buffer_load_dwordx4 v5, s[8:11], s75 offen offset:3168 lds
    v_mfma_f32_16x16x32_bf16 v[144:147], v[164:167], v[180:183], v[144:147]
    ds_read_b64_tr_b16 v[160:161], v8 offset:50688
    ds_read_b64_tr_b16 v[162:163], v8 offset:51200
    s_add_u32 s75, s75, s66
    buffer_load_dwordx4 a[160:163], v10, s[12:15], s100 offen offset:0 sc1
    buffer_load_dwordx4 a[164:167], v10, s[12:15], s100 offen offset:1024 sc1
    buffer_load_dwordx4 a[168:171], v10, s[12:15], s100 offen offset:2048 sc1
    v_mfma_f32_16x16x32_bf16 v[128:131], v[168:171], a[144:147], v[128:131]
    ds_read_b64_tr_b16 v[164:165], v6 offset:50848
    ds_read_b64_tr_b16 v[166:167], v6 offset:51360
    v_mfma_f32_16x16x32_bf16 v[132:135], v[168:171], a[148:151], v[132:135]
    s_waitcnt lgkmcnt(10)
    v_mfma_f32_16x16x32_bf16 v[16:19], v[172:175], a[152:155], v[16:19]
    ds_read_b64_tr_b16 v[168:169], v6 offset:50880
    ds_read_b64_tr_b16 v[170:171], v6 offset:51392
    v_mfma_f32_16x16x32_bf16 v[20:23], v[172:175], a[156:159], v[20:23]
    buffer_load_dwordx4 a[136:139], v250, s[12:15], s39 offen offset:3072 sc1
    v_mfma_f32_16x16x32_bf16 v[24:27], v[176:179], a[152:155], v[24:27]
    ds_read_b64_tr_b16 v[172:173], v6 offset:50912
    ds_read_b64_tr_b16 v[174:175], v6 offset:51424
    v_mfma_f32_16x16x32_bf16 v[28:31], v[176:179], a[156:159], v[28:31]
    s_waitcnt lgkmcnt(10)
    s_add_u32 m0, s74, 118272
    v_mfma_f32_16x16x32_bf16 v[32:35], v[148:151], a[152:155], v[32:35]
    ds_read_b64_tr_b16 v[176:177], v6 offset:50944
    ds_read_b64_tr_b16 v[178:179], v6 offset:51456
    v_mfma_f32_16x16x32_bf16 v[36:39], v[148:151], a[156:159], v[36:39]
    ds_read_b128 v[180:183], v14 offset:12288
    v_mfma_f32_16x16x32_bf16 v[40:43], v[152:155], a[152:155], v[40:43]
    ds_read_b64_tr_b16 v[148:149], v6 offset:50976
    ds_read_b64_tr_b16 v[150:151], v6 offset:51488
    v_mfma_f32_16x16x32_bf16 v[44:47], v[152:155], a[156:159], v[44:47]
    s_waitcnt lgkmcnt(9)
    v_mfma_f32_16x16x32_bf16 v[48:51], v[156:159], a[152:155], v[48:51]
    ds_read_b64_tr_b16 v[152:153], v8 offset:50720
    ds_read_b64_tr_b16 v[154:155], v8 offset:51232
    v_mfma_f32_16x16x32_bf16 v[52:55], v[156:159], a[156:159], v[52:55]
    buffer_load_dwordx4 v2, s[8:11], s75 offen offset:0 lds
    v_mfma_f32_16x16x32_bf16 v[136:139], v[160:163], v[184:187], v[136:139]
    ds_read_b64_tr_b16 v[156:157], v6 offset:51008
    ds_read_b64_tr_b16 v[158:159], v6 offset:51520
    v_mfma_f32_16x16x32_bf16 v[56:59], v[164:167], a[152:155], v[56:59]
    ds_read_b64_tr_b16 v[160:161], v6 offset:51040
    ds_read_b64_tr_b16 v[162:163], v6 offset:51552
    v_mfma_f32_16x16x32_bf16 v[60:63], v[164:167], a[156:159], v[60:63]
    s_waitcnt lgkmcnt(11)
    v_mfma_f32_16x16x32_bf16 v[64:67], v[168:171], a[152:155], v[64:67]
    ds_read_b64_tr_b16 v[164:165], v6 offset:51072
    ds_read_b64_tr_b16 v[166:167], v6 offset:51584
    v_mfma_f32_16x16x32_bf16 v[68:71], v[168:171], a[156:159], v[68:71]
    buffer_load_dwordx4 v3, s[8:11], s75 offen offset:1056 lds
    v_mfma_f32_16x16x32_bf16 v[72:75], v[172:175], a[152:155], v[72:75]
    ds_read_b64_tr_b16 v[168:169], v6 offset:51104
    ds_read_b64_tr_b16 v[170:171], v6 offset:51616
    v_mfma_f32_16x16x32_bf16 v[76:79], v[172:175], a[156:159], v[76:79]
    s_waitcnt lgkmcnt(10)
    v_mfma_f32_16x16x32_bf16 v[80:83], v[176:179], a[152:155], v[80:83]
    ds_read_b64_tr_b16 v[172:173], v8 offset:50752
    ds_read_b64_tr_b16 v[174:175], v8 offset:51264
    v_mfma_f32_16x16x32_bf16 v[84:87], v[176:179], a[156:159], v[84:87]
    buffer_load_dwordx4 a[140:143], v250, s[12:15], s44 offen offset:3072 sc1
    v_mfma_f32_16x16x32_bf16 v[88:91], v[148:151], a[152:155], v[88:91]
    ds_read_b64_tr_b16 v[176:177], v6 offset:51136
    ds_read_b64_tr_b16 v[178:179], v6 offset:51648
    v_mfma_f32_16x16x32_bf16 v[92:95], v[148:151], a[156:159], v[92:95]
    s_waitcnt vmcnt(13)
    s_barrier
    s_waitcnt lgkmcnt(10)
    v_mfma_f32_16x16x32_bf16 v[140:143], v[152:155], v[184:187], v[140:143]
    ds_read_b64_tr_b16 v[148:149], v7 offset:0
    ds_read_b64_tr_b16 v[150:151], v7 offset:512
    v_mfma_f32_16x16x32_bf16 v[96:99], v[156:159], a[152:155], v[96:99]
    ds_read_b64_tr_b16 v[152:153], v7 offset:32
    ds_read_b64_tr_b16 v[154:155], v7 offset:544
    v_mfma_f32_16x16x32_bf16 v[100:103], v[156:159], a[156:159], v[100:103]
    s_waitcnt lgkmcnt(10)
    v_mfma_f32_16x16x32_bf16 v[104:107], v[160:163], a[152:155], v[104:107]
    ds_read_b64_tr_b16 v[156:157], v7 offset:64
    ds_read_b64_tr_b16 v[158:159], v7 offset:576
    v_mfma_f32_16x16x32_bf16 v[108:111], v[160:163], a[156:159], v[108:111]
    buffer_load_dwordx4 v4, s[8:11], s75 offen offset:2112 lds
    v_mfma_f32_16x16x32_bf16 v[112:115], v[164:167], a[152:155], v[112:115]
    ds_read_b64_tr_b16 v[160:161], v7 offset:96
    ds_read_b64_tr_b16 v[162:163], v7 offset:608
    v_mfma_f32_16x16x32_bf16 v[116:119], v[164:167], a[156:159], v[116:119]
    s_waitcnt lgkmcnt(8)
    v_mfma_f32_16x16x32_bf16 v[120:123], v[168:171], a[152:155], v[120:123]
    ds_read_b64_tr_b16 v[164:165], v7 offset:128
    ds_read_b64_tr_b16 v[166:167], v7 offset:640
    v_mfma_f32_16x16x32_bf16 v[124:127], v[168:171], a[156:159], v[124:127]
    buffer_load_dwordx4 v5, s[8:11], s75 offen offset:3168 lds
    v_mfma_f32_16x16x32_bf16 v[144:147], v[172:175], v[184:187], v[144:147]
    ds_read_b64_tr_b16 v[168:169], v9 offset:0
    ds_read_b64_tr_b16 v[170:171], v9 offset:512
    s_add_u32 s75, s75, s66
    buffer_load_dwordx4 a[172:175], v10, s[12:15], s100 offen offset:3072 sc1
    buffer_load_dwordx4 a[176:179], v11, s[12:15], s100 offen offset:0 sc1
    s_add_u32 s100, s100, 40960
    buffer_load_dwordx4 a[180:183], v10, s[12:15], s100 offen offset:0 sc1
    v_mfma_f32_16x16x32_bf16 v[128:131], v[176:179], a[152:155], v[128:131]
    ds_read_b64_tr_b16 v[172:173], v7 offset:160
    ds_read_b64_tr_b16 v[174:175], v7 offset:672
    v_mfma_f32_16x16x32_bf16 v[132:135], v[176:179], a[156:159], v[132:135]
    s_waitcnt lgkmcnt(10)
    v_mfma_f32_16x16x32_bf16 v[16:19], v[148:151], a[112:115], v[16:19]
    ds_read_b64_tr_b16 v[176:177], v7 offset:192
    ds_read_b64_tr_b16 v[178:179], v7 offset:704
    v_mfma_f32_16x16x32_bf16 v[20:23], v[148:151], a[116:119], v[20:23]
    buffer_load_dwordx4 a[144:147], v250, s[12:15], s40 offen offset:0 sc1
    v_mfma_f32_16x16x32_bf16 v[24:27], v[152:155], a[112:115], v[24:27]
    ds_read_b64_tr_b16 v[148:149], v7 offset:224
    ds_read_b64_tr_b16 v[150:151], v7 offset:736
    v_mfma_f32_16x16x32_bf16 v[28:31], v[152:155], a[116:119], v[28:31]
    s_waitcnt lgkmcnt(10)
    s_add_u32 m0, s74, 0
    v_mfma_f32_16x16x32_bf16 v[32:35], v[156:159], a[112:115], v[32:35]
    ds_read_b64_tr_b16 v[152:153], v7 offset:256
    ds_read_b64_tr_b16 v[154:155], v7 offset:768
    v_mfma_f32_16x16x32_bf16 v[36:39], v[156:159], a[116:119], v[36:39]
    ds_read_b128 v[184:187], v14 offset:13312
    v_mfma_f32_16x16x32_bf16 v[40:43], v[160:163], a[112:115], v[40:43]
    ds_read_b64_tr_b16 v[156:157], v7 offset:288
    ds_read_b64_tr_b16 v[158:159], v7 offset:800
    v_mfma_f32_16x16x32_bf16 v[44:47], v[160:163], a[116:119], v[44:47]
    s_waitcnt lgkmcnt(9)
    v_mfma_f32_16x16x32_bf16 v[48:51], v[164:167], a[112:115], v[48:51]
    ds_read_b64_tr_b16 v[160:161], v9 offset:32
    ds_read_b64_tr_b16 v[162:163], v9 offset:544
    v_mfma_f32_16x16x32_bf16 v[52:55], v[164:167], a[116:119], v[52:55]
    buffer_load_dwordx4 v2, s[8:11], s75 offen offset:0 lds
    v_mfma_f32_16x16x32_bf16 v[136:139], v[168:171], v[180:183], v[136:139]
    ds_read_b64_tr_b16 v[164:165], v7 offset:320
    ds_read_b64_tr_b16 v[166:167], v7 offset:832
    v_mfma_f32_16x16x32_bf16 v[56:59], v[172:175], a[112:115], v[56:59]
    ds_read_b64_tr_b16 v[168:169], v7 offset:352
    ds_read_b64_tr_b16 v[170:171], v7 offset:864
    v_mfma_f32_16x16x32_bf16 v[60:63], v[172:175], a[116:119], v[60:63]
    s_waitcnt lgkmcnt(11)
    v_mfma_f32_16x16x32_bf16 v[64:67], v[176:179], a[112:115], v[64:67]
    ds_read_b64_tr_b16 v[172:173], v7 offset:384
    ds_read_b64_tr_b16 v[174:175], v7 offset:896
    v_mfma_f32_16x16x32_bf16 v[68:71], v[176:179], a[116:119], v[68:71]
    buffer_load_dwordx4 v3, s[8:11], s75 offen offset:1056 lds
    v_mfma_f32_16x16x32_bf16 v[72:75], v[148:151], a[112:115], v[72:75]
    ds_read_b64_tr_b16 v[176:177], v7 offset:416
    ds_read_b64_tr_b16 v[178:179], v7 offset:928
    v_mfma_f32_16x16x32_bf16 v[76:79], v[148:151], a[116:119], v[76:79]
    s_waitcnt lgkmcnt(10)
    v_mfma_f32_16x16x32_bf16 v[80:83], v[152:155], a[112:115], v[80:83]
    ds_read_b64_tr_b16 v[148:149], v9 offset:64
    ds_read_b64_tr_b16 v[150:151], v9 offset:576
    v_mfma_f32_16x16x32_bf16 v[84:87], v[152:155], a[116:119], v[84:87]
    buffer_load_dwordx4 a[148:151], v250, s[12:15], s45 offen offset:0 sc1
    v_mfma_f32_16x16x32_bf16 v[88:91], v[156:159], a[112:115], v[88:91]
    ds_read_b64_tr_b16 v[152:153], v7 offset:448
    ds_read_b64_tr_b16 v[154:155], v7 offset:960
    v_mfma_f32_16x16x32_bf16 v[92:95], v[156:159], a[116:119], v[92:95]
    s_waitcnt lgkmcnt(10)
    v_mfma_f32_16x16x32_bf16 v[140:143], v[160:163], v[180:183], v[140:143]
    ds_read_b64_tr_b16 v[156:157], v7 offset:16896
    ds_read_b64_tr_b16 v[158:159], v7 offset:17408
    v_mfma_f32_16x16x32_bf16 v[96:99], v[164:167], a[112:115], v[96:99]
    ds_read_b64_tr_b16 v[160:161], v7 offset:16928
    ds_read_b64_tr_b16 v[162:163], v7 offset:17440
    v_mfma_f32_16x16x32_bf16 v[100:103], v[164:167], a[116:119], v[100:103]
    s_waitcnt lgkmcnt(10)
    v_mfma_f32_16x16x32_bf16 v[104:107], v[168:171], a[112:115], v[104:107]
    ds_read_b64_tr_b16 v[164:165], v7 offset:16960
    ds_read_b64_tr_b16 v[166:167], v7 offset:17472
    v_mfma_f32_16x16x32_bf16 v[108:111], v[168:171], a[116:119], v[108:111]
    buffer_load_dwordx4 v4, s[8:11], s75 offen offset:2112 lds
    v_mfma_f32_16x16x32_bf16 v[112:115], v[172:175], a[112:115], v[112:115]
    ds_read_b64_tr_b16 v[168:169], v7 offset:16992
    ds_read_b64_tr_b16 v[170:171], v7 offset:17504
    v_mfma_f32_16x16x32_bf16 v[116:119], v[172:175], a[116:119], v[116:119]
    s_waitcnt lgkmcnt(8)
    v_mfma_f32_16x16x32_bf16 v[120:123], v[176:179], a[112:115], v[120:123]
    ds_read_b64_tr_b16 v[172:173], v7 offset:17024
    ds_read_b64_tr_b16 v[174:175], v7 offset:17536
    v_mfma_f32_16x16x32_bf16 v[124:127], v[176:179], a[116:119], v[124:127]
    buffer_load_dwordx4 v5, s[8:11], s75 offen offset:3168 lds
    v_mfma_f32_16x16x32_bf16 v[144:147], v[148:151], v[180:183], v[144:147]
    ds_read_b64_tr_b16 v[176:177], v9 offset:16896
    ds_read_b64_tr_b16 v[178:179], v9 offset:17408
    s_add_u32 s75, s75, s66
    buffer_load_dwordx4 a[184:187], v10, s[12:15], s100 offen offset:1024 sc1
    buffer_load_dwordx4 a[188:191], v10, s[12:15], s100 offen offset:2048 sc1
    buffer_load_dwordx4 a[192:195], v10, s[12:15], s100 offen offset:3072 sc1
    v_mfma_f32_16x16x32_bf16 v[128:131], v[152:155], a[112:115], v[128:131]
    ds_read_b64_tr_b16 v[148:149], v7 offset:17056
    ds_read_b64_tr_b16 v[150:151], v7 offset:17568
    v_mfma_f32_16x16x32_bf16 v[132:135], v[152:155], a[116:119], v[132:135]
    s_waitcnt lgkmcnt(10)
    v_mfma_f32_16x16x32_bf16 v[16:19], v[156:159], a[120:123], v[16:19]
    ds_read_b64_tr_b16 v[152:153], v7 offset:17088
    ds_read_b64_tr_b16 v[154:155], v7 offset:17600
    v_mfma_f32_16x16x32_bf16 v[20:23], v[156:159], a[124:127], v[20:23]
    buffer_load_dwordx4 a[152:155], v250, s[12:15], s40 offen offset:1024 sc1
    v_mfma_f32_16x16x32_bf16 v[24:27], v[160:163], a[120:123], v[24:27]
    ds_read_b64_tr_b16 v[156:157], v7 offset:17120
    ds_read_b64_tr_b16 v[158:159], v7 offset:17632
    v_mfma_f32_16x16x32_bf16 v[28:31], v[160:163], a[124:127], v[28:31]
    s_waitcnt lgkmcnt(10)
    s_add_u32 m0, s74, 16896
    v_mfma_f32_16x16x32_bf16 v[32:35], v[164:167], a[120:123], v[32:35]
    ds_read_b64_tr_b16 v[160:161], v7 offset:17152
    ds_read_b64_tr_b16 v[162:163], v7 offset:17664
    v_mfma_f32_16x16x32_bf16 v[36:39], v[164:167], a[124:127], v[36:39]
    ds_read_b128 v[180:183], v14 offset:14336
    v_mfma_f32_16x16x32_bf16 v[40:43], v[168:171], a[120:123], v[40:43]
    ds_read_b64_tr_b16 v[164:165], v7 offset:17184
    ds_read_b64_tr_b16 v[166:167], v7 offset:17696
    v_mfma_f32_16x16x32_bf16 v[44:47], v[168:171], a[124:127], v[44:47]
    s_waitcnt lgkmcnt(9)
    v_mfma_f32_16x16x32_bf16 v[48:51], v[172:175], a[120:123], v[48:51]
    ds_read_b64_tr_b16 v[168:169], v9 offset:16928
    ds_read_b64_tr_b16 v[170:171], v9 offset:17440
    v_mfma_f32_16x16x32_bf16 v[52:55], v[172:175], a[124:127], v[52:55]
    buffer_load_dwordx4 v2, s[8:11], s75 offen offset:0 lds
    v_mfma_f32_16x16x32_bf16 v[136:139], v[176:179], v[184:187], v[136:139]
    ds_read_b64_tr_b16 v[172:173], v7 offset:17216
    ds_read_b64_tr_b16 v[174:175], v7 offset:17728
    v_mfma_f32_16x16x32_bf16 v[56:59], v[148:151], a[120:123], v[56:59]
    ds_read_b64_tr_b16 v[176:177], v7 offset:17248
    ds_read_b64_tr_b16 v[178:179], v7 offset:17760
    v_mfma_f32_16x16x32_bf16 v[60:63], v[148:151], a[124:127], v[60:63]
    s_waitcnt lgkmcnt(11)
    v_mfma_f32_16x16x32_bf16 v[64:67], v[152:155], a[120:123], v[64:67]
    ds_read_b64_tr_b16 v[148:149], v7 offset:17280
    ds_read_b64_tr_b16 v[150:151], v7 offset:17792
    v_mfma_f32_16x16x32_bf16 v[68:71], v[152:155], a[124:127], v[68:71]
    buffer_load_dwordx4 v3, s[8:11], s75 offen offset:1056 lds
    v_mfma_f32_16x16x32_bf16 v[72:75], v[156:159], a[120:123], v[72:75]
    ds_read_b64_tr_b16 v[152:153], v7 offset:17312
    ds_read_b64_tr_b16 v[154:155], v7 offset:17824
    v_mfma_f32_16x16x32_bf16 v[76:79], v[156:159], a[124:127], v[76:79]
    s_waitcnt lgkmcnt(10)
    v_mfma_f32_16x16x32_bf16 v[80:83], v[160:163], a[120:123], v[80:83]
    ds_read_b64_tr_b16 v[156:157], v9 offset:16960
    ds_read_b64_tr_b16 v[158:159], v9 offset:17472
    v_mfma_f32_16x16x32_bf16 v[84:87], v[160:163], a[124:127], v[84:87]
    buffer_load_dwordx4 a[156:159], v250, s[12:15], s45 offen offset:1024 sc1
    v_mfma_f32_16x16x32_bf16 v[88:91], v[164:167], a[120:123], v[88:91]
    ds_read_b64_tr_b16 v[160:161], v7 offset:17344
    ds_read_b64_tr_b16 v[162:163], v7 offset:17856
    v_mfma_f32_16x16x32_bf16 v[92:95], v[164:167], a[124:127], v[92:95]
    s_waitcnt vmcnt(16)
    s_barrier
    s_waitcnt lgkmcnt(10)
    v_mfma_f32_16x16x32_bf16 v[140:143], v[168:171], v[184:187], v[140:143]
    ds_read_b64_tr_b16 v[164:165], v7 offset:33792
    ds_read_b64_tr_b16 v[166:167], v7 offset:34304
    v_mfma_f32_16x16x32_bf16 v[96:99], v[172:175], a[120:123], v[96:99]
    ds_read_b64_tr_b16 v[168:169], v7 offset:33824
    ds_read_b64_tr_b16 v[170:171], v7 offset:34336
    v_mfma_f32_16x16x32_bf16 v[100:103], v[172:175], a[124:127], v[100:103]
    s_waitcnt lgkmcnt(10)
    v_mfma_f32_16x16x32_bf16 v[104:107], v[176:179], a[120:123], v[104:107]
    ds_read_b64_tr_b16 v[172:173], v7 offset:33856
    ds_read_b64_tr_b16 v[174:175], v7 offset:34368
    v_mfma_f32_16x16x32_bf16 v[108:111], v[176:179], a[124:127], v[108:111]
    buffer_load_dwordx4 v4, s[8:11], s75 offen offset:2112 lds
    v_mfma_f32_16x16x32_bf16 v[112:115], v[148:151], a[120:123], v[112:115]
    ds_read_b64_tr_b16 v[176:177], v7 offset:33888
    ds_read_b64_tr_b16 v[178:179], v7 offset:34400
    v_mfma_f32_16x16x32_bf16 v[116:119], v[148:151], a[124:127], v[116:119]
    s_waitcnt lgkmcnt(8)
    v_mfma_f32_16x16x32_bf16 v[120:123], v[152:155], a[120:123], v[120:123]
    ds_read_b64_tr_b16 v[148:149], v7 offset:33920
    ds_read_b64_tr_b16 v[150:151], v7 offset:34432
    v_mfma_f32_16x16x32_bf16 v[124:127], v[152:155], a[124:127], v[124:127]
    buffer_load_dwordx4 v5, s[8:11], s75 offen offset:3168 lds
    v_mfma_f32_16x16x32_bf16 v[144:147], v[156:159], v[184:187], v[144:147]
    ds_read_b64_tr_b16 v[152:153], v9 offset:33792
    ds_read_b64_tr_b16 v[154:155], v9 offset:34304
    s_add_u32 s75, s75, s66
    buffer_load_dwordx4 a[196:199], v11, s[12:15], s100 offen offset:0 sc1
    s_add_u32 s100, s100, 40960
    buffer_load_dwordx4 a[200:203], v10, s[12:15], s100 offen offset:0 sc1
    buffer_load_dwordx4 a[204:207], v10, s[12:15], s100 offen offset:1024 sc1
    v_mfma_f32_16x16x32_bf16 v[128:131], v[160:163], a[120:123], v[128:131]
    ds_read_b64_tr_b16 v[156:157], v7 offset:33952
    ds_read_b64_tr_b16 v[158:159], v7 offset:34464
    v_mfma_f32_16x16x32_bf16 v[132:135], v[160:163], a[124:127], v[132:135]
    s_waitcnt lgkmcnt(10)
    v_mfma_f32_16x16x32_bf16 v[16:19], v[164:167], a[128:131], v[16:19]
    ds_read_b64_tr_b16 v[160:161], v7 offset:33984
    ds_read_b64_tr_b16 v[162:163], v7 offset:34496
    v_mfma_f32_16x16x32_bf16 v[20:23], v[164:167], a[132:135], v[20:23]
    buffer_load_dwordx4 a[112:115], v250, s[12:15], s40 offen offset:2048 sc1
    v_mfma_f32_16x16x32_bf16 v[24:27], v[168:171], a[128:131], v[24:27]
    ds_read_b64_tr_b16 v[164:165], v7 offset:34016
    ds_read_b64_tr_b16 v[166:167], v7 offset:34528
    v_mfma_f32_16x16x32_bf16 v[28:31], v[168:171], a[132:135], v[28:31]
    s_waitcnt lgkmcnt(10)
    s_add_u32 m0, s74, 33792
    v_mfma_f32_16x16x32_bf16 v[32:35], v[172:175], a[128:131], v[32:35]
    ds_read_b64_tr_b16 v[168:169], v7 offset:34048
    ds_read_b64_tr_b16 v[170:171], v7 offset:34560
    v_mfma_f32_16x16x32_bf16 v[36:39], v[172:175], a[132:135], v[36:39]
    ds_read_b128 v[184:187], v14 offset:15360
    v_mfma_f32_16x16x32_bf16 v[40:43], v[176:179], a[128:131], v[40:43]
    ds_read_b64_tr_b16 v[172:173], v7 offset:34080
    ds_read_b64_tr_b16 v[174:175], v7 offset:34592
    v_mfma_f32_16x16x32_bf16 v[44:47], v[176:179], a[132:135], v[44:47]
    s_waitcnt lgkmcnt(9)
    v_mfma_f32_16x16x32_bf16 v[48:51], v[148:151], a[128:131], v[48:51]
    ds_read_b64_tr_b16 v[176:177], v9 offset:33824
    ds_read_b64_tr_b16 v[178:179], v9 offset:34336
    v_mfma_f32_16x16x32_bf16 v[52:55], v[148:151], a[132:135], v[52:55]
    buffer_load_dwordx4 v2, s[8:11], s75 offen offset:0 lds
    v_mfma_f32_16x16x32_bf16 v[136:139], v[152:155], v[180:183], v[136:139]
    ds_read_b64_tr_b16 v[148:149], v7 offset:34112
    ds_read_b64_tr_b16 v[150:151], v7 offset:34624
    v_mfma_f32_16x16x32_bf16 v[56:59], v[156:159], a[128:131], v[56:59]
    ds_read_b64_tr_b16 v[152:153], v7 offset:34144
    ds_read_b64_tr_b16 v[154:155], v7 offset:34656
    v_mfma_f32_16x16x32_bf16 v[60:63], v[156:159], a[132:135], v[60:63]
    s_waitcnt lgkmcnt(11)
    v_mfma_f32_16x16x32_bf16 v[64:67], v[160:163], a[128:131], v[64:67]
    ds_read_b64_tr_b16 v[156:157], v7 offset:34176
    ds_read_b64_tr_b16 v[158:159], v7 offset:34688
    v_mfma_f32_16x16x32_bf16 v[68:71], v[160:163], a[132:135], v[68:71]
    buffer_load_dwordx4 v3, s[8:11], s75 offen offset:1056 lds
    v_mfma_f32_16x16x32_bf16 v[72:75], v[164:167], a[128:131], v[72:75]
    ds_read_b64_tr_b16 v[160:161], v7 offset:34208
    ds_read_b64_tr_b16 v[162:163], v7 offset:34720
    v_mfma_f32_16x16x32_bf16 v[76:79], v[164:167], a[132:135], v[76:79]
    s_waitcnt lgkmcnt(10)
    v_mfma_f32_16x16x32_bf16 v[80:83], v[168:171], a[128:131], v[80:83]
    ds_read_b64_tr_b16 v[164:165], v9 offset:33856
    ds_read_b64_tr_b16 v[166:167], v9 offset:34368
    v_mfma_f32_16x16x32_bf16 v[84:87], v[168:171], a[132:135], v[84:87]
    buffer_load_dwordx4 a[116:119], v250, s[12:15], s45 offen offset:2048 sc1
    v_mfma_f32_16x16x32_bf16 v[88:91], v[172:175], a[128:131], v[88:91]
    ds_read_b64_tr_b16 v[168:169], v7 offset:34240
    ds_read_b64_tr_b16 v[170:171], v7 offset:34752
    v_mfma_f32_16x16x32_bf16 v[92:95], v[172:175], a[132:135], v[92:95]
    s_waitcnt lgkmcnt(10)
    v_mfma_f32_16x16x32_bf16 v[140:143], v[176:179], v[180:183], v[140:143]
    ds_read_b64_tr_b16 v[172:173], v7 offset:50688
    ds_read_b64_tr_b16 v[174:175], v7 offset:51200
    v_mfma_f32_16x16x32_bf16 v[96:99], v[148:151], a[128:131], v[96:99]
    ds_read_b64_tr_b16 v[176:177], v7 offset:50720
    ds_read_b64_tr_b16 v[178:179], v7 offset:51232
    v_mfma_f32_16x16x32_bf16 v[100:103], v[148:151], a[132:135], v[100:103]
    s_waitcnt lgkmcnt(10)
    v_mfma_f32_16x16x32_bf16 v[104:107], v[152:155], a[128:131], v[104:107]
    ds_read_b64_tr_b16 v[148:149], v7 offset:50752
    ds_read_b64_tr_b16 v[150:151], v7 offset:51264
    v_mfma_f32_16x16x32_bf16 v[108:111], v[152:155], a[132:135], v[108:111]
    buffer_load_dwordx4 v4, s[8:11], s75 offen offset:2112 lds
    v_mfma_f32_16x16x32_bf16 v[112:115], v[156:159], a[128:131], v[112:115]
    ds_read_b64_tr_b16 v[152:153], v7 offset:50784
    ds_read_b64_tr_b16 v[154:155], v7 offset:51296
    v_mfma_f32_16x16x32_bf16 v[116:119], v[156:159], a[132:135], v[116:119]
    s_waitcnt lgkmcnt(8)
    v_mfma_f32_16x16x32_bf16 v[120:123], v[160:163], a[128:131], v[120:123]
    ds_read_b64_tr_b16 v[156:157], v7 offset:50816
    ds_read_b64_tr_b16 v[158:159], v7 offset:51328
    v_mfma_f32_16x16x32_bf16 v[124:127], v[160:163], a[132:135], v[124:127]
    buffer_load_dwordx4 v5, s[8:11], s75 offen offset:3168 lds
    v_mfma_f32_16x16x32_bf16 v[144:147], v[164:167], v[180:183], v[144:147]
    ds_read_b64_tr_b16 v[160:161], v9 offset:50688
    ds_read_b64_tr_b16 v[162:163], v9 offset:51200
    s_add_u32 s75, s75, s66
    buffer_load_dwordx4 a[208:211], v10, s[12:15], s100 offen offset:2048 sc1
    buffer_load_dwordx4 a[212:215], v10, s[12:15], s100 offen offset:3072 sc1
    buffer_load_dwordx4 a[216:219], v11, s[12:15], s100 offen offset:0 sc1
    s_add_u32 s100, s100, 40960
    v_mfma_f32_16x16x32_bf16 v[128:131], v[168:171], a[128:131], v[128:131]
    ds_read_b64_tr_b16 v[164:165], v7 offset:50848
    ds_read_b64_tr_b16 v[166:167], v7 offset:51360
    v_mfma_f32_16x16x32_bf16 v[132:135], v[168:171], a[132:135], v[132:135]
    s_waitcnt lgkmcnt(10)
    v_mfma_f32_16x16x32_bf16 v[16:19], v[172:175], a[136:139], v[16:19]
    ds_read_b64_tr_b16 v[168:169], v7 offset:50880
    ds_read_b64_tr_b16 v[170:171], v7 offset:51392
    v_mfma_f32_16x16x32_bf16 v[20:23], v[172:175], a[140:143], v[20:23]
    buffer_load_dwordx4 a[120:123], v250, s[12:15], s40 offen offset:3072 sc1
    v_mfma_f32_16x16x32_bf16 v[24:27], v[176:179], a[136:139], v[24:27]
    ds_read_b64_tr_b16 v[172:173], v7 offset:50912
    ds_read_b64_tr_b16 v[174:175], v7 offset:51424
    v_mfma_f32_16x16x32_bf16 v[28:31], v[176:179], a[140:143], v[28:31]
    s_waitcnt lgkmcnt(10)
    s_add_u32 m0, s74, 50688
    v_mfma_f32_16x16x32_bf16 v[32:35], v[148:151], a[136:139], v[32:35]
    ds_read_b64_tr_b16 v[176:177], v7 offset:50944
    ds_read_b64_tr_b16 v[178:179], v7 offset:51456
    v_mfma_f32_16x16x32_bf16 v[36:39], v[148:151], a[140:143], v[36:39]
    ds_read_b128 v[180:183], v14 offset:16384
    v_mfma_f32_16x16x32_bf16 v[40:43], v[152:155], a[136:139], v[40:43]
    ds_read_b64_tr_b16 v[148:149], v7 offset:50976
    ds_read_b64_tr_b16 v[150:151], v7 offset:51488
    v_mfma_f32_16x16x32_bf16 v[44:47], v[152:155], a[140:143], v[44:47]
    s_waitcnt lgkmcnt(9)
    v_mfma_f32_16x16x32_bf16 v[48:51], v[156:159], a[136:139], v[48:51]
    ds_read_b64_tr_b16 v[152:153], v9 offset:50720
    ds_read_b64_tr_b16 v[154:155], v9 offset:51232
    v_mfma_f32_16x16x32_bf16 v[52:55], v[156:159], a[140:143], v[52:55]
    buffer_load_dwordx4 v2, s[8:11], s75 offen offset:0 lds
    v_mfma_f32_16x16x32_bf16 v[136:139], v[160:163], v[184:187], v[136:139]
    ds_read_b64_tr_b16 v[156:157], v7 offset:51008
    ds_read_b64_tr_b16 v[158:159], v7 offset:51520
    v_mfma_f32_16x16x32_bf16 v[56:59], v[164:167], a[136:139], v[56:59]
    ds_read_b64_tr_b16 v[160:161], v7 offset:51040
    ds_read_b64_tr_b16 v[162:163], v7 offset:51552
    v_mfma_f32_16x16x32_bf16 v[60:63], v[164:167], a[140:143], v[60:63]
    s_waitcnt lgkmcnt(11)
    v_mfma_f32_16x16x32_bf16 v[64:67], v[168:171], a[136:139], v[64:67]
    ds_read_b64_tr_b16 v[164:165], v7 offset:51072
    ds_read_b64_tr_b16 v[166:167], v7 offset:51584
    v_mfma_f32_16x16x32_bf16 v[68:71], v[168:171], a[140:143], v[68:71]
    buffer_load_dwordx4 v3, s[8:11], s75 offen offset:1056 lds
    v_mfma_f32_16x16x32_bf16 v[72:75], v[172:175], a[136:139], v[72:75]
    ds_read_b64_tr_b16 v[168:169], v7 offset:51104
    ds_read_b64_tr_b16 v[170:171], v7 offset:51616
    v_mfma_f32_16x16x32_bf16 v[76:79], v[172:175], a[140:143], v[76:79]
    s_waitcnt lgkmcnt(10)
    v_mfma_f32_16x16x32_bf16 v[80:83], v[176:179], a[136:139], v[80:83]
    ds_read_b64_tr_b16 v[172:173], v9 offset:50752
    ds_read_b64_tr_b16 v[174:175], v9 offset:51264
    v_mfma_f32_16x16x32_bf16 v[84:87], v[176:179], a[140:143], v[84:87]
    buffer_load_dwordx4 a[124:127], v250, s[12:15], s45 offen offset:3072 sc1
    v_mfma_f32_16x16x32_bf16 v[88:91], v[148:151], a[136:139], v[88:91]
    ds_read_b64_tr_b16 v[176:177], v7 offset:51136
    ds_read_b64_tr_b16 v[178:179], v7 offset:51648
    v_mfma_f32_16x16x32_bf16 v[92:95], v[148:151], a[140:143], v[92:95]
    s_waitcnt vmcnt(16)
    s_barrier
    s_waitcnt lgkmcnt(10)
    v_mfma_f32_16x16x32_bf16 v[140:143], v[152:155], v[184:187], v[140:143]
    ds_read_b64_tr_b16 v[148:149], v6 offset:0
    ds_read_b64_tr_b16 v[150:151], v6 offset:512
    v_mfma_f32_16x16x32_bf16 v[96:99], v[156:159], a[136:139], v[96:99]
    ds_read_b64_tr_b16 v[152:153], v6 offset:32
    ds_read_b64_tr_b16 v[154:155], v6 offset:544
    v_mfma_f32_16x16x32_bf16 v[100:103], v[156:159], a[140:143], v[100:103]
    s_waitcnt lgkmcnt(10)
    v_mfma_f32_16x16x32_bf16 v[104:107], v[160:163], a[136:139], v[104:107]
    ds_read_b64_tr_b16 v[156:157], v6 offset:64
    ds_read_b64_tr_b16 v[158:159], v6 offset:576
    v_mfma_f32_16x16x32_bf16 v[108:111], v[160:163], a[140:143], v[108:111]
    buffer_load_dwordx4 v4, s[8:11], s75 offen offset:2112 lds
    v_mfma_f32_16x16x32_bf16 v[112:115], v[164:167], a[136:139], v[112:115]
    ds_read_b64_tr_b16 v[160:161], v6 offset:96
    ds_read_b64_tr_b16 v[162:163], v6 offset:608
    v_mfma_f32_16x16x32_bf16 v[116:119], v[164:167], a[140:143], v[116:119]
    s_waitcnt lgkmcnt(8)
    v_mfma_f32_16x16x32_bf16 v[120:123], v[168:171], a[136:139], v[120:123]
    ds_read_b64_tr_b16 v[164:165], v6 offset:128
    ds_read_b64_tr_b16 v[166:167], v6 offset:640
    v_mfma_f32_16x16x32_bf16 v[124:127], v[168:171], a[140:143], v[124:127]
    buffer_load_dwordx4 v5, s[8:11], s75 offen offset:3168 lds
    v_mfma_f32_16x16x32_bf16 v[144:147], v[172:175], v[184:187], v[144:147]
    ds_read_b64_tr_b16 v[168:169], v8 offset:0
    ds_read_b64_tr_b16 v[170:171], v8 offset:512
    s_add_u32 s75, s75, s66
    buffer_load_dwordx4 a[220:223], v10, s[12:15], s100 offen offset:0 sc1
    buffer_load_dwordx4 a[224:227], v10, s[12:15], s100 offen offset:1024 sc1
    buffer_load_dwordx4 a[228:231], v10, s[12:15], s100 offen offset:2048 sc1
    v_mfma_f32_16x16x32_bf16 v[128:131], v[176:179], a[136:139], v[128:131]
    ds_read_b64_tr_b16 v[172:173], v6 offset:160
    ds_read_b64_tr_b16 v[174:175], v6 offset:672
    v_mfma_f32_16x16x32_bf16 v[132:135], v[176:179], a[140:143], v[132:135]
    s_waitcnt lgkmcnt(10)
    v_mfma_f32_16x16x32_bf16 v[16:19], v[148:151], a[144:147], v[16:19]
    ds_read_b64_tr_b16 v[176:177], v6 offset:192
    ds_read_b64_tr_b16 v[178:179], v6 offset:704
    v_mfma_f32_16x16x32_bf16 v[20:23], v[148:151], a[148:151], v[20:23]
    buffer_load_dwordx4 a[232:235], v10, s[12:15], s100 offen offset:3072 sc1
    v_mfma_f32_16x16x32_bf16 v[24:27], v[152:155], a[144:147], v[24:27]
    ds_read_b64_tr_b16 v[148:149], v6 offset:224
    ds_read_b64_tr_b16 v[150:151], v6 offset:736
    v_mfma_f32_16x16x32_bf16 v[28:31], v[152:155], a[148:151], v[28:31]
    s_waitcnt lgkmcnt(10)
    v_mfma_f32_16x16x32_bf16 v[32:35], v[156:159], a[144:147], v[32:35]
    ds_read_b64_tr_b16 v[152:153], v6 offset:256
    ds_read_b64_tr_b16 v[154:155], v6 offset:768
    v_mfma_f32_16x16x32_bf16 v[36:39], v[156:159], a[148:151], v[36:39]
    buffer_load_dwordx4 a[236:239], v11, s[12:15], s100 offen offset:0 sc1
    v_mfma_f32_16x16x32_bf16 v[40:43], v[160:163], a[144:147], v[40:43]
    ds_read_b64_tr_b16 v[156:157], v6 offset:288
    ds_read_b64_tr_b16 v[158:159], v6 offset:800
    v_mfma_f32_16x16x32_bf16 v[44:47], v[160:163], a[148:151], v[44:47]
    s_waitcnt lgkmcnt(8)
    ds_read_b128 v[184:187], v14 offset:17408
    v_mfma_f32_16x16x32_bf16 v[48:51], v[164:167], a[144:147], v[48:51]
    ds_read_b64_tr_b16 v[160:161], v8 offset:32
    ds_read_b64_tr_b16 v[162:163], v8 offset:544
    v_mfma_f32_16x16x32_bf16 v[52:55], v[164:167], a[148:151], v[52:55]
    s_add_u32 s100, s100, 40960
    v_mfma_f32_16x16x32_bf16 v[136:139], v[168:171], v[180:183], v[136:139]
    ds_read_b64_tr_b16 v[164:165], v6 offset:320
    ds_read_b64_tr_b16 v[166:167], v6 offset:832
    v_mfma_f32_16x16x32_bf16 v[56:59], v[172:175], a[144:147], v[56:59]
    ds_read_b64_tr_b16 v[168:169], v6 offset:352
    ds_read_b64_tr_b16 v[170:171], v6 offset:864
    v_mfma_f32_16x16x32_bf16 v[60:63], v[172:175], a[148:151], v[60:63]
    s_waitcnt lgkmcnt(11)
    v_mfma_f32_16x16x32_bf16 v[64:67], v[176:179], a[144:147], v[64:67]
    ds_read_b64_tr_b16 v[172:173], v6 offset:384
    ds_read_b64_tr_b16 v[174:175], v6 offset:896
    v_mfma_f32_16x16x32_bf16 v[68:71], v[176:179], a[148:151], v[68:71]
    buffer_load_dwordx4 a[240:243], v10, s[12:15], s101 offen offset:0 sc1
    v_mfma_f32_16x16x32_bf16 v[72:75], v[148:151], a[144:147], v[72:75]
    ds_read_b64_tr_b16 v[176:177], v6 offset:416
    ds_read_b64_tr_b16 v[178:179], v6 offset:928
    v_mfma_f32_16x16x32_bf16 v[76:79], v[148:151], a[148:151], v[76:79]
    s_waitcnt lgkmcnt(11)
    v_mfma_f32_16x16x32_bf16 v[80:83], v[152:155], a[144:147], v[80:83]
    ds_read_b64_tr_b16 v[148:149], v8 offset:64
    ds_read_b64_tr_b16 v[150:151], v8 offset:576
    v_mfma_f32_16x16x32_bf16 v[84:87], v[152:155], a[148:151], v[84:87]
    buffer_load_dwordx4 a[244:247], v10, s[12:15], s101 offen offset:1024 sc1
    v_mfma_f32_16x16x32_bf16 v[88:91], v[156:159], a[144:147], v[88:91]
    ds_read_b64_tr_b16 v[152:153], v6 offset:448
    ds_read_b64_tr_b16 v[154:155], v6 offset:960
    v_mfma_f32_16x16x32_bf16 v[92:95], v[156:159], a[148:151], v[92:95]
    s_waitcnt lgkmcnt(10)
    v_mfma_f32_16x16x32_bf16 v[140:143], v[160:163], v[180:183], v[140:143]
    ds_read_b64_tr_b16 v[156:157], v6 offset:16896
    ds_read_b64_tr_b16 v[158:159], v6 offset:17408
    v_mfma_f32_16x16x32_bf16 v[96:99], v[164:167], a[144:147], v[96:99]
    ds_read_b64_tr_b16 v[160:161], v6 offset:16928
    ds_read_b64_tr_b16 v[162:163], v6 offset:17440
    v_mfma_f32_16x16x32_bf16 v[100:103], v[164:167], a[148:151], v[100:103]
    s_waitcnt lgkmcnt(10)
    v_mfma_f32_16x16x32_bf16 v[104:107], v[168:171], a[144:147], v[104:107]
    ds_read_b64_tr_b16 v[164:165], v6 offset:16960
    ds_read_b64_tr_b16 v[166:167], v6 offset:17472
    v_mfma_f32_16x16x32_bf16 v[108:111], v[168:171], a[148:151], v[108:111]
    buffer_load_dwordx4 a[248:251], v10, s[12:15], s101 offen offset:2048 sc1
    v_mfma_f32_16x16x32_bf16 v[112:115], v[172:175], a[144:147], v[112:115]
    ds_read_b64_tr_b16 v[168:169], v6 offset:16992
    ds_read_b64_tr_b16 v[170:171], v6 offset:17504
    v_mfma_f32_16x16x32_bf16 v[116:119], v[172:175], a[148:151], v[116:119]
    s_waitcnt lgkmcnt(8)
    v_mfma_f32_16x16x32_bf16 v[120:123], v[176:179], a[144:147], v[120:123]
    ds_read_b64_tr_b16 v[172:173], v6 offset:17024
    ds_read_b64_tr_b16 v[174:175], v6 offset:17536
    v_mfma_f32_16x16x32_bf16 v[124:127], v[176:179], a[148:151], v[124:127]
    buffer_load_dwordx4 a[252:255], v10, s[12:15], s101 offen offset:3072 sc1
    v_mfma_f32_16x16x32_bf16 v[144:147], v[148:151], v[180:183], v[144:147]
    ds_read_b64_tr_b16 v[176:177], v8 offset:16896
    ds_read_b64_tr_b16 v[178:179], v8 offset:17408
    buffer_load_dwordx4 a[0:3], v11, s[12:15], s101 offen offset:0 sc1
    s_add_u32 s101, s101, 40960
    buffer_load_dwordx4 a[4:7], v10, s[12:15], s101 offen offset:0 sc1
    v_mfma_f32_16x16x32_bf16 v[128:131], v[152:155], a[144:147], v[128:131]
    ds_read_b64_tr_b16 v[148:149], v6 offset:17056
    ds_read_b64_tr_b16 v[150:151], v6 offset:17568
    v_mfma_f32_16x16x32_bf16 v[132:135], v[152:155], a[148:151], v[132:135]
    s_waitcnt lgkmcnt(10)
    v_mfma_f32_16x16x32_bf16 v[16:19], v[156:159], a[152:155], v[16:19]
    ds_read_b64_tr_b16 v[152:153], v6 offset:17088
    ds_read_b64_tr_b16 v[154:155], v6 offset:17600
    v_mfma_f32_16x16x32_bf16 v[20:23], v[156:159], a[156:159], v[20:23]
    buffer_load_dwordx4 a[8:11], v10, s[12:15], s101 offen offset:1024 sc1
    v_mfma_f32_16x16x32_bf16 v[24:27], v[160:163], a[152:155], v[24:27]
    ds_read_b64_tr_b16 v[156:157], v6 offset:17120
    ds_read_b64_tr_b16 v[158:159], v6 offset:17632
    v_mfma_f32_16x16x32_bf16 v[28:31], v[160:163], a[156:159], v[28:31]
    s_waitcnt lgkmcnt(10)
    v_mfma_f32_16x16x32_bf16 v[32:35], v[164:167], a[152:155], v[32:35]
    ds_read_b64_tr_b16 v[160:161], v6 offset:17152
    ds_read_b64_tr_b16 v[162:163], v6 offset:17664
    v_mfma_f32_16x16x32_bf16 v[36:39], v[164:167], a[156:159], v[36:39]
    buffer_load_dwordx4 a[12:15], v10, s[12:15], s101 offen offset:2048 sc1
    v_mfma_f32_16x16x32_bf16 v[40:43], v[168:171], a[152:155], v[40:43]
    ds_read_b64_tr_b16 v[164:165], v6 offset:17184
    ds_read_b64_tr_b16 v[166:167], v6 offset:17696
    v_mfma_f32_16x16x32_bf16 v[44:47], v[168:171], a[156:159], v[44:47]
    s_waitcnt lgkmcnt(8)
    ds_read_b128 v[180:183], v14 offset:18432
    v_mfma_f32_16x16x32_bf16 v[48:51], v[172:175], a[152:155], v[48:51]
    ds_read_b64_tr_b16 v[168:169], v8 offset:16928
    ds_read_b64_tr_b16 v[170:171], v8 offset:17440
    v_mfma_f32_16x16x32_bf16 v[52:55], v[172:175], a[156:159], v[52:55]
    buffer_load_dwordx4 a[16:19], v10, s[12:15], s101 offen offset:3072 sc1
    v_mfma_f32_16x16x32_bf16 v[136:139], v[176:179], v[184:187], v[136:139]
    ds_read_b64_tr_b16 v[172:173], v6 offset:17216
    ds_read_b64_tr_b16 v[174:175], v6 offset:17728
    v_mfma_f32_16x16x32_bf16 v[56:59], v[148:151], a[152:155], v[56:59]
    ds_read_b64_tr_b16 v[176:177], v6 offset:17248
    ds_read_b64_tr_b16 v[178:179], v6 offset:17760
    v_mfma_f32_16x16x32_bf16 v[60:63], v[148:151], a[156:159], v[60:63]
    s_waitcnt lgkmcnt(11)
    v_mfma_f32_16x16x32_bf16 v[64:67], v[152:155], a[152:155], v[64:67]
    ds_read_b64_tr_b16 v[148:149], v6 offset:17280
    ds_read_b64_tr_b16 v[150:151], v6 offset:17792
    v_mfma_f32_16x16x32_bf16 v[68:71], v[152:155], a[156:159], v[68:71]
    buffer_load_dwordx4 a[20:23], v11, s[12:15], s101 offen offset:0 sc1
    v_mfma_f32_16x16x32_bf16 v[72:75], v[156:159], a[152:155], v[72:75]
    ds_read_b64_tr_b16 v[152:153], v6 offset:17312
    ds_read_b64_tr_b16 v[154:155], v6 offset:17824
    v_mfma_f32_16x16x32_bf16 v[76:79], v[156:159], a[156:159], v[76:79]
    s_waitcnt lgkmcnt(11)
    s_add_u32 s101, s101, 40960
    v_mfma_f32_16x16x32_bf16 v[80:83], v[160:163], a[152:155], v[80:83]
    ds_read_b64_tr_b16 v[156:157], v8 offset:16960
    ds_read_b64_tr_b16 v[158:159], v8 offset:17472
    v_mfma_f32_16x16x32_bf16 v[84:87], v[160:163], a[156:159], v[84:87]
    buffer_load_dwordx4 a[24:27], v10, s[12:15], s101 offen offset:0 sc1
    v_mfma_f32_16x16x32_bf16 v[88:91], v[164:167], a[152:155], v[88:91]
    ds_read_b64_tr_b16 v[160:161], v6 offset:17344
    ds_read_b64_tr_b16 v[162:163], v6 offset:17856
    v_mfma_f32_16x16x32_bf16 v[92:95], v[164:167], a[156:159], v[92:95]
    s_waitcnt vmcnt(16)
    s_barrier
    s_waitcnt lgkmcnt(10)
    v_mfma_f32_16x16x32_bf16 v[140:143], v[168:171], v[184:187], v[140:143]
    ds_read_b64_tr_b16 v[164:165], v6 offset:33792
    ds_read_b64_tr_b16 v[166:167], v6 offset:34304
    v_mfma_f32_16x16x32_bf16 v[96:99], v[172:175], a[152:155], v[96:99]
    ds_read_b64_tr_b16 v[168:169], v6 offset:33824
    ds_read_b64_tr_b16 v[170:171], v6 offset:34336
    v_mfma_f32_16x16x32_bf16 v[100:103], v[172:175], a[156:159], v[100:103]
    s_waitcnt lgkmcnt(10)
    v_mfma_f32_16x16x32_bf16 v[104:107], v[176:179], a[152:155], v[104:107]
    ds_read_b64_tr_b16 v[172:173], v6 offset:33856
    ds_read_b64_tr_b16 v[174:175], v6 offset:34368
    v_mfma_f32_16x16x32_bf16 v[108:111], v[176:179], a[156:159], v[108:111]
    buffer_load_dwordx4 a[28:31], v10, s[12:15], s101 offen offset:1024 sc1
    v_mfma_f32_16x16x32_bf16 v[112:115], v[148:151], a[152:155], v[112:115]
    ds_read_b64_tr_b16 v[176:177], v6 offset:33888
    ds_read_b64_tr_b16 v[178:179], v6 offset:34400
    v_mfma_f32_16x16x32_bf16 v[116:119], v[148:151], a[156:159], v[116:119]
    s_waitcnt lgkmcnt(8)
    v_mfma_f32_16x16x32_bf16 v[120:123], v[152:155], a[152:155], v[120:123]
    ds_read_b64_tr_b16 v[148:149], v6 offset:33920
    ds_read_b64_tr_b16 v[150:151], v6 offset:34432
    v_mfma_f32_16x16x32_bf16 v[124:127], v[152:155], a[156:159], v[124:127]
    buffer_load_dwordx4 a[32:35], v10, s[12:15], s101 offen offset:2048 sc1
    v_mfma_f32_16x16x32_bf16 v[144:147], v[156:159], v[184:187], v[144:147]
    ds_read_b64_tr_b16 v[152:153], v8 offset:33792
    ds_read_b64_tr_b16 v[154:155], v8 offset:34304
    buffer_load_dwordx4 a[36:39], v10, s[12:15], s101 offen offset:3072 sc1
    v_mfma_f32_16x16x32_bf16 v[128:131], v[160:163], a[152:155], v[128:131]
    ds_read_b64_tr_b16 v[156:157], v6 offset:33952
    ds_read_b64_tr_b16 v[158:159], v6 offset:34464
    v_mfma_f32_16x16x32_bf16 v[132:135], v[160:163], a[156:159], v[132:135]
    s_waitcnt lgkmcnt(10)
    v_mfma_f32_16x16x32_bf16 v[16:19], v[164:167], a[112:115], v[16:19]
    ds_read_b64_tr_b16 v[160:161], v6 offset:33984
    ds_read_b64_tr_b16 v[162:163], v6 offset:34496
    v_mfma_f32_16x16x32_bf16 v[20:23], v[164:167], a[116:119], v[20:23]
    buffer_load_dwordx4 a[40:43], v11, s[12:15], s101 offen offset:0 sc1
    v_mfma_f32_16x16x32_bf16 v[24:27], v[168:171], a[112:115], v[24:27]
    ds_read_b64_tr_b16 v[164:165], v6 offset:34016
    ds_read_b64_tr_b16 v[166:167], v6 offset:34528
    v_mfma_f32_16x16x32_bf16 v[28:31], v[168:171], a[116:119], v[28:31]
    s_waitcnt lgkmcnt(10)
    s_add_u32 s101, s101, 40960
    v_mfma_f32_16x16x32_bf16 v[32:35], v[172:175], a[112:115], v[32:35]
    ds_read_b64_tr_b16 v[168:169], v6 offset:34048
    ds_read_b64_tr_b16 v[170:171], v6 offset:34560
    v_mfma_f32_16x16x32_bf16 v[36:39], v[172:175], a[116:119], v[36:39]
    ds_read_b128 v[184:187], v14 offset:19456
    v_mfma_f32_16x16x32_bf16 v[40:43], v[176:179], a[112:115], v[40:43]
    ds_read_b64_tr_b16 v[172:173], v6 offset:34080
    ds_read_b64_tr_b16 v[174:175], v6 offset:34592
    v_mfma_f32_16x16x32_bf16 v[44:47], v[176:179], a[116:119], v[44:47]
    s_waitcnt lgkmcnt(9)
    v_mfma_f32_16x16x32_bf16 v[48:51], v[148:151], a[112:115], v[48:51]
    ds_read_b64_tr_b16 v[176:177], v8 offset:33824
    ds_read_b64_tr_b16 v[178:179], v8 offset:34336
    v_mfma_f32_16x16x32_bf16 v[52:55], v[148:151], a[116:119], v[52:55]
    buffer_load_dwordx4 a[44:47], v10, s[12:15], s101 offen offset:0 sc1
    v_mfma_f32_16x16x32_bf16 v[136:139], v[152:155], v[180:183], v[136:139]
    ds_read_b64_tr_b16 v[148:149], v6 offset:34112
    ds_read_b64_tr_b16 v[150:151], v6 offset:34624
    v_mfma_f32_16x16x32_bf16 v[56:59], v[156:159], a[112:115], v[56:59]
    ds_read_b64_tr_b16 v[152:153], v6 offset:34144
    ds_read_b64_tr_b16 v[154:155], v6 offset:34656
    v_mfma_f32_16x16x32_bf16 v[60:63], v[156:159], a[116:119], v[60:63]
    s_waitcnt lgkmcnt(11)
    v_mfma_f32_16x16x32_bf16 v[64:67], v[160:163], a[112:115], v[64:67]
    ds_read_b64_tr_b16 v[156:157], v6 offset:34176
    ds_read_b64_tr_b16 v[158:159], v6 offset:34688
    v_mfma_f32_16x16x32_bf16 v[68:71], v[160:163], a[116:119], v[68:71]
    buffer_load_dwordx4 a[48:51], v10, s[12:15], s101 offen offset:1024 sc1
    v_mfma_f32_16x16x32_bf16 v[72:75], v[164:167], a[112:115], v[72:75]
    ds_read_b64_tr_b16 v[160:161], v6 offset:34208
    ds_read_b64_tr_b16 v[162:163], v6 offset:34720
    v_mfma_f32_16x16x32_bf16 v[76:79], v[164:167], a[116:119], v[76:79]
    s_waitcnt lgkmcnt(10)
    v_mfma_f32_16x16x32_bf16 v[80:83], v[168:171], a[112:115], v[80:83]
    ds_read_b64_tr_b16 v[164:165], v8 offset:33856
    ds_read_b64_tr_b16 v[166:167], v8 offset:34368
    v_mfma_f32_16x16x32_bf16 v[84:87], v[168:171], a[116:119], v[84:87]
    buffer_load_dwordx4 a[52:55], v10, s[12:15], s101 offen offset:2048 sc1
    v_mfma_f32_16x16x32_bf16 v[88:91], v[172:175], a[112:115], v[88:91]
    ds_read_b64_tr_b16 v[168:169], v6 offset:34240
    ds_read_b64_tr_b16 v[170:171], v6 offset:34752
    v_mfma_f32_16x16x32_bf16 v[92:95], v[172:175], a[116:119], v[92:95]
    s_waitcnt lgkmcnt(10)
    v_mfma_f32_16x16x32_bf16 v[140:143], v[176:179], v[180:183], v[140:143]
    ds_read_b64_tr_b16 v[172:173], v6 offset:50688
    ds_read_b64_tr_b16 v[174:175], v6 offset:51200
    v_mfma_f32_16x16x32_bf16 v[96:99], v[148:151], a[112:115], v[96:99]
    ds_read_b64_tr_b16 v[176:177], v6 offset:50720
    ds_read_b64_tr_b16 v[178:179], v6 offset:51232
    v_mfma_f32_16x16x32_bf16 v[100:103], v[148:151], a[116:119], v[100:103]
    s_waitcnt lgkmcnt(10)
    v_mfma_f32_16x16x32_bf16 v[104:107], v[152:155], a[112:115], v[104:107]
    ds_read_b64_tr_b16 v[148:149], v6 offset:50752
    ds_read_b64_tr_b16 v[150:151], v6 offset:51264
    v_mfma_f32_16x16x32_bf16 v[108:111], v[152:155], a[116:119], v[108:111]
    buffer_load_dwordx4 a[56:59], v10, s[12:15], s101 offen offset:3072 sc1
    v_mfma_f32_16x16x32_bf16 v[112:115], v[156:159], a[112:115], v[112:115]
    ds_read_b64_tr_b16 v[152:153], v6 offset:50784
    ds_read_b64_tr_b16 v[154:155], v6 offset:51296
    v_mfma_f32_16x16x32_bf16 v[116:119], v[156:159], a[116:119], v[116:119]
    s_waitcnt lgkmcnt(8)
    v_mfma_f32_16x16x32_bf16 v[120:123], v[160:163], a[112:115], v[120:123]
    ds_read_b64_tr_b16 v[156:157], v6 offset:50816
    ds_read_b64_tr_b16 v[158:159], v6 offset:51328
    v_mfma_f32_16x16x32_bf16 v[124:127], v[160:163], a[116:119], v[124:127]
    buffer_load_dwordx4 a[60:63], v11, s[12:15], s101 offen offset:0 sc1
    v_mfma_f32_16x16x32_bf16 v[144:147], v[164:167], v[180:183], v[144:147]
    ds_read_b64_tr_b16 v[160:161], v8 offset:50688
    ds_read_b64_tr_b16 v[162:163], v8 offset:51200
    s_add_u32 s101, s101, 40960
    buffer_load_dwordx4 a[64:67], v10, s[12:15], s100 offen offset:0 sc1
    buffer_load_dwordx4 a[68:71], v10, s[12:15], s100 offen offset:1024 sc1
    v_mfma_f32_16x16x32_bf16 v[128:131], v[168:171], a[112:115], v[128:131]
    ds_read_b64_tr_b16 v[164:165], v6 offset:50848
    ds_read_b64_tr_b16 v[166:167], v6 offset:51360
    v_mfma_f32_16x16x32_bf16 v[132:135], v[168:171], a[116:119], v[132:135]
    s_waitcnt lgkmcnt(10)
    v_mfma_f32_16x16x32_bf16 v[16:19], v[172:175], a[120:123], v[16:19]
    ds_read_b64_tr_b16 v[168:169], v6 offset:50880
    ds_read_b64_tr_b16 v[170:171], v6 offset:51392
    v_mfma_f32_16x16x32_bf16 v[20:23], v[172:175], a[124:127], v[20:23]
    buffer_load_dwordx4 a[72:75], v10, s[12:15], s100 offen offset:2048 sc1
    v_mfma_f32_16x16x32_bf16 v[24:27], v[176:179], a[120:123], v[24:27]
    ds_read_b64_tr_b16 v[172:173], v6 offset:50912
    ds_read_b64_tr_b16 v[174:175], v6 offset:51424
    v_mfma_f32_16x16x32_bf16 v[28:31], v[176:179], a[124:127], v[28:31]
    s_waitcnt lgkmcnt(10)
    v_mfma_f32_16x16x32_bf16 v[32:35], v[148:151], a[120:123], v[32:35]
    ds_read_b64_tr_b16 v[176:177], v6 offset:50944
    ds_read_b64_tr_b16 v[178:179], v6 offset:51456
    v_mfma_f32_16x16x32_bf16 v[36:39], v[148:151], a[124:127], v[36:39]
    buffer_load_dwordx4 a[76:79], v10, s[12:15], s100 offen offset:3072 sc1
    v_mfma_f32_16x16x32_bf16 v[40:43], v[152:155], a[120:123], v[40:43]
    ds_read_b64_tr_b16 v[148:149], v6 offset:50976
    ds_read_b64_tr_b16 v[150:151], v6 offset:51488
    v_mfma_f32_16x16x32_bf16 v[44:47], v[152:155], a[124:127], v[44:47]
    s_waitcnt lgkmcnt(8)
    v_mfma_f32_16x16x32_bf16 v[48:51], v[156:159], a[120:123], v[48:51]
    ds_read_b64_tr_b16 v[152:153], v8 offset:50720
    ds_read_b64_tr_b16 v[154:155], v8 offset:51232
    v_mfma_f32_16x16x32_bf16 v[52:55], v[156:159], a[124:127], v[52:55]
    buffer_load_dwordx4 a[80:83], v11, s[12:15], s100 offen offset:0 sc1
    v_mfma_f32_16x16x32_bf16 v[136:139], v[160:163], v[184:187], v[136:139]
    ds_read_b64_tr_b16 v[156:157], v6 offset:51008
    ds_read_b64_tr_b16 v[158:159], v6 offset:51520
    v_mfma_f32_16x16x32_bf16 v[56:59], v[164:167], a[120:123], v[56:59]
    ds_read_b64_tr_b16 v[160:161], v6 offset:51040
    ds_read_b64_tr_b16 v[162:163], v6 offset:51552
    v_mfma_f32_16x16x32_bf16 v[60:63], v[164:167], a[124:127], v[60:63]
    s_waitcnt lgkmcnt(10)
    s_add_u32 s100, s100, 40960
    v_mfma_f32_16x16x32_bf16 v[64:67], v[168:171], a[120:123], v[64:67]
    ds_read_b64_tr_b16 v[164:165], v6 offset:51072
    ds_read_b64_tr_b16 v[166:167], v6 offset:51584
    v_mfma_f32_16x16x32_bf16 v[68:71], v[168:171], a[124:127], v[68:71]
    s_add_u32 s100, s100, s18
    v_mfma_f32_16x16x32_bf16 v[72:75], v[172:175], a[120:123], v[72:75]
    ds_read_b64_tr_b16 v[168:169], v6 offset:51104
    ds_read_b64_tr_b16 v[170:171], v6 offset:51616
    v_mfma_f32_16x16x32_bf16 v[76:79], v[172:175], a[124:127], v[76:79]
    s_waitcnt lgkmcnt(10)
    v_mfma_f32_16x16x32_bf16 v[80:83], v[176:179], a[120:123], v[80:83]
    ds_read_b64_tr_b16 v[172:173], v8 offset:50752
    ds_read_b64_tr_b16 v[174:175], v8 offset:51264
    v_mfma_f32_16x16x32_bf16 v[84:87], v[176:179], a[124:127], v[84:87]
    buffer_load_dwordx4 a[84:87], v10, s[12:15], s100 offen offset:0 sc1
    v_mfma_f32_16x16x32_bf16 v[88:91], v[148:151], a[120:123], v[88:91]
    ds_read_b64_tr_b16 v[176:177], v6 offset:51136
    ds_read_b64_tr_b16 v[178:179], v6 offset:51648
    v_mfma_f32_16x16x32_bf16 v[92:95], v[148:151], a[124:127], v[92:95]
    s_waitcnt lgkmcnt(10)
    v_mfma_f32_16x16x32_bf16 v[140:143], v[152:155], v[184:187], v[140:143]
    v_mfma_f32_16x16x32_bf16 v[96:99], v[156:159], a[120:123], v[96:99]
    buffer_load_dwordx4 a[88:91], v10, s[12:15], s100 offen offset:1024 sc1
    v_mfma_f32_16x16x32_bf16 v[100:103], v[156:159], a[124:127], v[100:103]
    s_waitcnt lgkmcnt(6)
    v_mfma_f32_16x16x32_bf16 v[104:107], v[160:163], a[120:123], v[104:107]
    buffer_load_dwordx4 a[92:95], v10, s[12:15], s100 offen offset:2048 sc1
    v_mfma_f32_16x16x32_bf16 v[108:111], v[160:163], a[124:127], v[108:111]
    buffer_load_dwordx4 a[96:99], v10, s[12:15], s100 offen offset:3072 sc1
    v_mfma_f32_16x16x32_bf16 v[112:115], v[164:167], a[120:123], v[112:115]
    buffer_load_dwordx4 a[100:103], v11, s[12:15], s100 offen offset:0 sc1
    v_mfma_f32_16x16x32_bf16 v[116:119], v[164:167], a[124:127], v[116:119]
    s_waitcnt lgkmcnt(0)
    s_add_u32 s100, s100, 40960
    v_mfma_f32_16x16x32_bf16 v[120:123], v[168:171], a[120:123], v[120:123]
    v_mfma_f32_16x16x32_bf16 v[124:127], v[168:171], a[124:127], v[124:127]
    v_mfma_f32_16x16x32_bf16 v[144:147], v[172:175], v[184:187], v[144:147]
    v_mfma_f32_16x16x32_bf16 v[128:131], v[176:179], a[120:123], v[128:131]
    v_mfma_f32_16x16x32_bf16 v[132:135], v[176:179], a[124:127], v[132:135]
    v_cvt_pk_bf16_f32 v196, v16, v17
    v_cvt_pk_bf16_f32 v197, v18, v19
    ds_write_b64 v216, v[196:197] offset:0
    v_cvt_pk_bf16_f32 v198, v20, v21
    v_cvt_pk_bf16_f32 v199, v22, v23
    ds_write_b64 v216, v[198:199] offset:7936
    buffer_load_dwordx4 a[104:107], v10, s[12:15], s100 offen offset:0 sc1
    v_cvt_pk_bf16_f32 v200, v24, v25
    v_cvt_pk_bf16_f32 v201, v26, v27
    ds_write_b64 v216, v[200:201] offset:32
    v_cvt_pk_bf16_f32 v202, v28, v29
    v_cvt_pk_bf16_f32 v203, v30, v31
    ds_write_b64 v216, v[202:203] offset:7968
    buffer_load_dwordx4 a[108:111], v10, s[12:15], s100 offen offset:1024 sc1
    v_cvt_pk_bf16_f32 v196, v32, v33
    v_cvt_pk_bf16_f32 v197, v34, v35
    ds_write_b64 v216, v[196:197] offset:64
    v_cvt_pk_bf16_f32 v198, v36, v37
    v_cvt_pk_bf16_f32 v199, v38, v39
    ds_write_b64 v216, v[198:199] offset:8000
    buffer_load_dwordx4 a[112:115], v10, s[12:15], s100 offen offset:2048 sc1
    v_cvt_pk_bf16_f32 v200, v40, v41
    v_cvt_pk_bf16_f32 v201, v42, v43
    ds_write_b64 v216, v[200:201] offset:96
    v_cvt_pk_bf16_f32 v202, v44, v45
    v_cvt_pk_bf16_f32 v203, v46, v47
    ds_write_b64 v216, v[202:203] offset:8032
    buffer_load_dwordx4 a[116:119], v10, s[12:15], s100 offen offset:3072 sc1
    v_cvt_pk_bf16_f32 v196, v48, v49
    v_cvt_pk_bf16_f32 v197, v50, v51
    ds_write_b64 v216, v[196:197] offset:128
    v_cvt_pk_bf16_f32 v198, v52, v53
    v_cvt_pk_bf16_f32 v199, v54, v55
    ds_write_b64 v216, v[198:199] offset:8064
    buffer_load_dwordx4 a[120:123], v11, s[12:15], s100 offen offset:0 sc1
    s_add_u32 s100, s100, 40960
    v_cvt_pk_bf16_f32 v200, v136, v137
    v_cvt_pk_bf16_f32 v201, v138, v139
    ds_write_b64 v217, v[200:201] offset:0
    v_cvt_pk_bf16_f32 v202, v56, v57
    v_cvt_pk_bf16_f32 v203, v58, v59
    ds_write_b64 v216, v[202:203] offset:160
    buffer_load_dwordx4 a[124:127], v10, s[12:15], s101 offen offset:0 sc1
    v_cvt_pk_bf16_f32 v196, v60, v61
    v_cvt_pk_bf16_f32 v197, v62, v63
    ds_write_b64 v216, v[196:197] offset:8096
    v_cvt_pk_bf16_f32 v198, v64, v65
    v_cvt_pk_bf16_f32 v199, v66, v67
    ds_write_b64 v216, v[198:199] offset:192
    buffer_load_dwordx4 a[128:131], v10, s[12:15], s101 offen offset:1024 sc1
    v_cvt_pk_bf16_f32 v200, v68, v69
    v_cvt_pk_bf16_f32 v201, v70, v71
    ds_write_b64 v216, v[200:201] offset:8128
    v_cvt_pk_bf16_f32 v202, v72, v73
    v_cvt_pk_bf16_f32 v203, v74, v75
    ds_write_b64 v216, v[202:203] offset:224
    buffer_load_dwordx4 a[132:135], v10, s[12:15], s101 offen offset:2048 sc1
    v_cvt_pk_bf16_f32 v196, v76, v77
    v_cvt_pk_bf16_f32 v197, v78, v79
    ds_write_b64 v216, v[196:197] offset:8160
    v_cvt_pk_bf16_f32 v198, v80, v81
    v_cvt_pk_bf16_f32 v199, v82, v83
    ds_write_b64 v216, v[198:199] offset:256
    buffer_load_dwordx4 a[136:139], v10, s[12:15], s101 offen offset:3072 sc1
    v_cvt_pk_bf16_f32 v200, v84, v85
    v_cvt_pk_bf16_f32 v201, v86, v87
    ds_write_b64 v216, v[200:201] offset:8192
    v_cvt_pk_bf16_f32 v202, v88, v89
    v_cvt_pk_bf16_f32 v203, v90, v91
    ds_write_b64 v216, v[202:203] offset:288
    buffer_load_dwordx4 a[140:143], v11, s[12:15], s101 offen offset:0 sc1
    s_add_u32 s101, s101, 40960
    v_cvt_pk_bf16_f32 v196, v92, v93
    v_cvt_pk_bf16_f32 v197, v94, v95
    ds_write_b64 v216, v[196:197] offset:8224
    v_cvt_pk_bf16_f32 v198, v140, v141
    v_cvt_pk_bf16_f32 v199, v142, v143
    ds_write_b64 v217, v[198:199] offset:32
    buffer_load_dwordx4 a[144:147], v10, s[12:15], s101 offen offset:0 sc1
    v_cvt_pk_bf16_f32 v200, v96, v97
    v_cvt_pk_bf16_f32 v201, v98, v99
    ds_write_b64 v216, v[200:201] offset:320
    v_cvt_pk_bf16_f32 v202, v100, v101
    v_cvt_pk_bf16_f32 v203, v102, v103
    ds_write_b64 v216, v[202:203] offset:8256
    buffer_load_dwordx4 a[148:151], v10, s[12:15], s101 offen offset:1024 sc1
    v_cvt_pk_bf16_f32 v196, v104, v105
    v_cvt_pk_bf16_f32 v197, v106, v107
    ds_write_b64 v216, v[196:197] offset:352
    v_cvt_pk_bf16_f32 v198, v108, v109
    v_cvt_pk_bf16_f32 v199, v110, v111
    ds_write_b64 v216, v[198:199] offset:8288
    buffer_load_dwordx4 a[152:155], v10, s[12:15], s101 offen offset:2048 sc1
    v_cvt_pk_bf16_f32 v200, v112, v113
    v_cvt_pk_bf16_f32 v201, v114, v115
    ds_write_b64 v216, v[200:201] offset:384
    v_cvt_pk_bf16_f32 v202, v116, v117
    v_cvt_pk_bf16_f32 v203, v118, v119
    ds_write_b64 v216, v[202:203] offset:8320
    buffer_load_dwordx4 a[156:159], v10, s[12:15], s101 offen offset:3072 sc1
    v_cvt_pk_bf16_f32 v196, v120, v121
    v_cvt_pk_bf16_f32 v197, v122, v123
    ds_write_b64 v216, v[196:197] offset:416
    v_cvt_pk_bf16_f32 v198, v124, v125
    v_cvt_pk_bf16_f32 v199, v126, v127
    ds_write_b64 v216, v[198:199] offset:8352
    buffer_load_dwordx4 v[228:231], v11, s[12:15], s101 offen offset:0 sc1
    s_add_u32 s101, s101, 40960
    v_cvt_pk_bf16_f32 v200, v144, v145
    v_cvt_pk_bf16_f32 v201, v146, v147
    ds_write_b64 v217, v[200:201] offset:64
    v_cvt_pk_bf16_f32 v202, v128, v129
    v_cvt_pk_bf16_f32 v203, v130, v131
    ds_write_b64 v216, v[202:203] offset:448
    buffer_load_dwordx4 v[232:235], v10, s[12:15], s101 offen offset:0 sc1
    v_cvt_pk_bf16_f32 v196, v132, v133
    v_cvt_pk_bf16_f32 v197, v134, v135
    ds_write_b64 v216, v[196:197] offset:8384
    s_mov_b32 s36, 0xeeeeeeee
    s_mov_b32 s37, 0xeeeeeeee
    s_mov_b32 s38, 0xcccccccc
    s_mov_b32 s39, 0xcccccccc
    s_mov_b32 s40, 0x88888888
    s_mov_b32 s41, 0x88888888
    s_waitcnt lgkmcnt(0)
    s_barrier
    ds_read_b128 v[16:19], v218 offset:7936
    ds_read_b128 v[36:39], v218 offset:160
    ds_read_b128 v[56:59], v218 offset:4128
    ds_read_b128 v[76:79], v218 offset:8096
    ds_read_b128 v[20:23], v218 offset:7952
    ds_read_b128 v[40:43], v218 offset:176
    ds_read_b128 v[60:63], v218 offset:4144
    ds_read_b128 v[80:83], v218 offset:8112
    ds_read_b128 v[24:27], v218 offset:7968
    ds_read_b128 v[44:47], v218 offset:192
    ds_read_b128 v[64:67], v218 offset:4160
    ds_read_b128 v[84:87], v218 offset:8128
    ds_read_b128 v[28:31], v218 offset:7984
    ds_read_b128 v[48:51], v218 offset:208
    ds_read_b128 v[68:71], v218 offset:4176
    ds_read_b128 v[88:91], v218 offset:8144
    ds_read_b128 v[32:35], v218 offset:8000
    ds_read_b128 v[52:55], v218 offset:224
    ds_read_b128 v[72:75], v218 offset:4192
    ds_read_b128 v[92:95], v218 offset:8160
    s_mov_b64 s[42:43], 0xff
    s_mov_b64 s[44:45], 0x1111
    s_mov_b64 s[46:47], 0x3333
    s_mov_b64 s[48:49], 0x7777
    s_mov_b32 s50, 0xffff0000
    s_mov_b32 s52, 0x3e64f92e
    s_mov_b32 s54, 0x3fb8aa3b
    s_mov_b32 s53, 0x3e64f92e
    s_mov_b32 s55, 0x3fb8aa3b
    s_and_b32 s72, s60, 1
    s_or_b32 s72, s72, s61
    s_waitcnt lgkmcnt(15)
    v_mfma_f32_4x4x4_16b_bf16 v[192:195], v[36:37], v[16:17], 0
    ds_read_b64_tr_b16 v[96:97], v219 offset:320
    s_waitcnt lgkmcnt(15)
    v_mfma_f32_4x4x4_16b_bf16 v[196:199], v[56:57], v[16:17], 0
    ds_read_b64_tr_b16 v[106:107], v219 offset:4288
    s_waitcnt lgkmcnt(15)
    v_mfma_f32_4x4x4_16b_bf16 v[200:203], v[76:77], v[16:17], 0
    ds_read_b64_tr_b16 v[116:117], v219 offset:8256
    buffer_load_dwordx4 v[236:239], v10, s[12:15], s101 offen offset:1024 sc1
    v_mfma_f32_4x4x4_16b_bf16 v[192:195], v[38:39], v[18:19], v[192:195]
    ds_read_b64_tr_b16 v[98:99], v219 offset:328
    v_mfma_f32_4x4x4_16b_bf16 v[196:199], v[58:59], v[18:19], v[196:199]
    ds_read_b64_tr_b16 v[108:109], v219 offset:4296
    v_mfma_f32_4x4x4_16b_bf16 v[200:203], v[78:79], v[18:19], v[200:203]
    ds_read_b64_tr_b16 v[118:119], v219 offset:8264
    buffer_load_dwordx4 v[240:243], v10, s[12:15], s101 offen offset:2048 sc1
    s_waitcnt lgkmcnt(15)
    v_mfma_f32_4x4x4_16b_bf16 v[192:195], v[40:41], v[20:21], v[192:195]
    ds_read_b64_tr_b16 v[100:101], v219 offset:336
    s_waitcnt lgkmcnt(15)
    v_mfma_f32_4x4x4_16b_bf16 v[196:199], v[60:61], v[20:21], v[196:199]
    ds_read_b64_tr_b16 v[110:111], v219 offset:4304
    s_waitcnt lgkmcnt(15)
    v_mfma_f32_4x4x4_16b_bf16 v[200:203], v[80:81], v[20:21], v[200:203]
    ds_read_b64_tr_b16 v[120:121], v219 offset:8272
    buffer_load_dwordx4 v[244:247], v10, s[12:15], s101 offen offset:3072 sc1
    v_mfma_f32_4x4x4_16b_bf16 v[192:195], v[42:43], v[22:23], v[192:195]
    ds_read_b64_tr_b16 v[102:103], v219 offset:344
    v_mfma_f32_4x4x4_16b_bf16 v[196:199], v[62:63], v[22:23], v[196:199]
    ds_read_b64_tr_b16 v[112:113], v219 offset:4312
    v_mfma_f32_4x4x4_16b_bf16 v[200:203], v[82:83], v[22:23], v[200:203]
    ds_read_b64_tr_b16 v[122:123], v219 offset:8280
    s_add_u32 s73, s16, 0
    s_add_u32 m0, s17, 0
    s_nop 0
    buffer_load_dwordx4 v10, s[12:15], s73 offen offset:0 sc1 lds
    s_waitcnt lgkmcnt(15)
    v_mfma_f32_4x4x4_16b_bf16 v[192:195], v[44:45], v[24:25], v[192:195]
    ds_read_b64_tr_b16 v[104:105], v219 offset:352
    s_waitcnt lgkmcnt(15)
    v_mfma_f32_4x4x4_16b_bf16 v[196:199], v[64:65], v[24:25], v[196:199]
    ds_read_b64_tr_b16 v[114:115], v219 offset:4320
    s_waitcnt lgkmcnt(15)
    v_mfma_f32_4x4x4_16b_bf16 v[200:203], v[84:85], v[24:25], v[200:203]
    ds_read_b64_tr_b16 v[124:125], v219 offset:8288
    buffer_load_dwordx4 v10, s[12:15], s73 offen offset:1024 sc1 lds
    v_mfma_f32_4x4x4_16b_bf16 v[204:207], v[46:47], v[26:27], 0
    ds_read_b64_tr_b16 v[126:127], v219 offset:360
    v_mfma_f32_4x4x4_16b_bf16 v[208:211], v[66:67], v[26:27], 0
    ds_read_b64_tr_b16 v[136:137], v219 offset:4328
    v_mfma_f32_4x4x4_16b_bf16 v[212:215], v[86:87], v[26:27], 0
    ds_read_b64_tr_b16 v[146:147], v219 offset:8296
    buffer_load_dwordx4 v10, s[12:15], s73 offen offset:2048 sc1 lds
    s_waitcnt lgkmcnt(15)
    v_mfma_f32_4x4x4_16b_bf16 v[204:207], v[48:49], v[28:29], v[204:207]
    ds_read_b64_tr_b16 v[128:129], v219 offset:368
    s_waitcnt lgkmcnt(15)
    v_mfma_f32_4x4x4_16b_bf16 v[208:211], v[68:69], v[28:29], v[208:211]
    ds_read_b64_tr_b16 v[138:139], v219 offset:4336
    s_waitcnt lgkmcnt(15)
    v_mfma_f32_4x4x4_16b_bf16 v[212:215], v[88:89], v[28:29], v[212:215]
    ds_read_b64_tr_b16 v[148:149], v219 offset:8304
    buffer_load_dwordx4 v10, s[12:15], s73 offen offset:3072 sc1 lds
    v_mfma_f32_4x4x4_16b_bf16 v[204:207], v[50:51], v[30:31], v[204:207]
    ds_read_b64_tr_b16 v[130:131], v219 offset:376
    v_mfma_f32_4x4x4_16b_bf16 v[208:211], v[70:71], v[30:31], v[208:211]
    ds_read_b64_tr_b16 v[140:141], v219 offset:4344
    v_mfma_f32_4x4x4_16b_bf16 v[212:215], v[90:91], v[30:31], v[212:215]
    ds_read_b64_tr_b16 v[150:151], v219 offset:8312
    s_add_u32 m0, s17, 4096
    s_nop 0
    buffer_load_dwordx4 v11, s[12:15], s73 offen offset:0 sc1 lds
    s_waitcnt lgkmcnt(15)
    v_mfma_f32_4x4x4_16b_bf16 v[204:207], v[52:53], v[32:33], v[204:207]
    ds_read_b64_tr_b16 v[132:133], v219 offset:384
    s_waitcnt lgkmcnt(15)
    v_mfma_f32_4x4x4_16b_bf16 v[208:211], v[72:73], v[32:33], v[208:211]
    ds_read_b64_tr_b16 v[142:143], v219 offset:4352
    s_waitcnt lgkmcnt(15)
    v_mfma_f32_4x4x4_16b_bf16 v[212:215], v[92:93], v[32:33], v[212:215]
    ds_read_b64_tr_b16 v[152:153], v219 offset:8320
    s_add_u32 s73, s16, 163840
    s_add_u32 m0, s17, 20480
    s_nop 0
    buffer_load_dwordx4 v10, s[12:15], s73 offen offset:0 sc1 lds
    v_mfma_f32_4x4x4_16b_bf16 v[204:207], v[54:55], v[34:35], v[204:207]
    ds_read_b64_tr_b16 v[134:135], v219 offset:392
    v_mfma_f32_4x4x4_16b_bf16 v[208:211], v[74:75], v[34:35], v[208:211]
    ds_read_b64_tr_b16 v[144:145], v219 offset:4360
    v_mfma_f32_4x4x4_16b_bf16 v[212:215], v[94:95], v[34:35], v[212:215]
    ds_read_b64_tr_b16 v[154:155], v219 offset:8328
    buffer_load_dwordx4 v10, s[12:15], s73 offen offset:1024 sc1 lds
    v_cndmask_b32 v201, v193, v201, s[36:37]
    v_cndmask_b32 v202, v194, v202, s[38:39]
    v_cndmask_b32 v203, v195, v203, s[40:41]
    v_cvt_pk_bf16_f32 v192, v196, v197
    v_cvt_pk_bf16_f32 v193, v198, v199
    v_cvt_pk_bf16_f32 v194, v200, v201
    v_cvt_pk_bf16_f32 v195, v202, v203
    buffer_load_dwordx4 v10, s[12:15], s73 offen offset:2048 sc1 lds
    v_lshlrev_b32 v196, 16, v192
    v_and_b32 v197, s50, v192
    v_lshlrev_b32 v198, 16, v193
    v_and_b32 v199, s50, v193
    v_lshlrev_b32 v200, 16, v194
    v_and_b32 v201, s50, v194
    v_lshlrev_b32 v202, 16, v195
    v_and_b32 v203, s50, v195
    buffer_load_dwordx4 v10, s[12:15], s73 offen offset:3072 sc1 lds
    v_pk_mul_f32 v[196:197], v[196:197], s[52:53]
    v_pk_mul_f32 v[198:199], v[198:199], s[52:53]
    v_pk_mul_f32 v[200:201], v[200:201], s[52:53]
    v_pk_mul_f32 v[202:203], v[202:203], s[52:53]
    s_add_u32 m0, s17, 24576
    s_nop 0
    buffer_load_dwordx4 v11, s[12:15], s73 offen offset:0 sc1 lds
    v_cvt_pk_bf16_f32 v192, v196, v197
    v_cvt_pk_bf16_f32 v193, v198, v199
    v_cvt_pk_bf16_f32 v194, v200, v201
    v_cvt_pk_bf16_f32 v195, v202, v203
    v_lshlrev_b32 v196, 16, v192
    v_and_b32 v197, s50, v192
    v_lshlrev_b32 v198, 16, v193
    v_and_b32 v199, s50, v193
    v_lshlrev_b32 v200, 16, v194
    v_and_b32 v201, s50, v194
    v_lshlrev_b32 v202, 16, v195
    v_and_b32 v203, s50, v195
    s_add_u32 s73, s16, 327680
    s_add_u32 m0, s17, 40960
    s_nop 0
    buffer_load_dwordx4 v10, s[12:15], s73 offen offset:0 sc1 lds
    s_cmp_eq_u32 s72, 0
    s_cbranch_scc0 L_nomask_7
    v_mov_b32 v190, 0xce6e6b28
    v_cndmask_b32 v196, v196, v190, s[42:43]
    v_cndmask_b32 v197, v197, v190, s[42:43]
    v_cndmask_b32 v198, v198, v190, s[42:43]
    v_cndmask_b32 v199, v199, v190, s[42:43]
    v_cndmask_b32 v201, v201, v190, s[44:45]
    v_cndmask_b32 v202, v202, v190, s[46:47]
    v_cndmask_b32 v203, v203, v190, s[48:49]
L_nomask_7:
    v_max3_f32 v192, v196, v197, v198
    v_max3_f32 v193, v199, v200, v201
    v_max3_f32 v192, v192, v202, v203
    v_max_f32 v192, v192, v193
    v_mul_f32 v192, s54, v192
    buffer_load_dwordx4 v10, s[12:15], s73 offen offset:1024 sc1 lds
    v_pk_fma_f32 v[196:197], v[196:197], s[54:55], v[192:193] op_sel_hi:[1,1,0] neg_lo:[0,0,1] neg_hi:[0,0,1]
    v_pk_fma_f32 v[198:199], v[198:199], s[54:55], v[192:193] op_sel_hi:[1,1,0] neg_lo:[0,0,1] neg_hi:[0,0,1]
    v_pk_fma_f32 v[200:201], v[200:201], s[54:55], v[192:193] op_sel_hi:[1,1,0] neg_lo:[0,0,1] neg_hi:[0,0,1]
    v_pk_fma_f32 v[202:203], v[202:203], s[54:55], v[192:193] op_sel_hi:[1,1,0] neg_lo:[0,0,1] neg_hi:[0,0,1]
    buffer_load_dwordx4 v10, s[12:15], s73 offen offset:2048 sc1 lds
    v_exp_f32 v196, v196
    v_exp_f32 v197, v197
    v_exp_f32 v198, v198
    v_exp_f32 v199, v199
    v_exp_f32 v200, v200
    v_exp_f32 v201, v201
    v_exp_f32 v202, v202
    v_exp_f32 v203, v203
    buffer_load_dwordx4 v10, s[12:15], s73 offen offset:3072 sc1 lds
    v_pk_add_f32 v[192:193], v[196:197], v[198:199]
    v_pk_add_f32 v[194:195], v[200:201], v[202:203]
    v_pk_add_f32 v[192:193], v[192:193], v[194:195]
    v_add_f32 v192, v192, v193
    v_rcp_f32 v192, v192
    s_add_u32 m0, s17, 45056
    s_nop 0
    buffer_load_dwordx4 v11, s[12:15], s73 offen offset:0 sc1 lds
    v_pk_mul_f32 v[196:197], v[196:197], v[192:193] op_sel_hi:[1,0]
    v_pk_mul_f32 v[198:199], v[198:199], v[192:193] op_sel_hi:[1,0]
    v_pk_mul_f32 v[200:201], v[200:201], v[192:193] op_sel_hi:[1,0]
    v_pk_mul_f32 v[202:203], v[202:203], v[192:193] op_sel_hi:[1,0]
    v_cvt_pk_bf16_f32 v38, v196, v197
    v_cvt_pk_bf16_f32 v39, v198, v199
    v_cvt_pk_bf16_f32 v36, v200, v201
    v_cvt_pk_bf16_f32 v37, v202, v203
    v_and_b32 v40, v36, v221
    v_and_b32 v41, v37, v222
    v_xor_b32 v36, v36, v40
    v_xor_b32 v37, v37, v41
    s_waitcnt lgkmcnt(15)
    v_mfma_f32_4x4x4_16b_bf16 v[44:47], v[106:107], v[38:39], 0
    s_waitcnt lgkmcnt(15)
    v_mfma_f32_4x4x4_16b_bf16 v[48:51], v[108:109], v[38:39], 0
    s_waitcnt lgkmcnt(15)
    v_mfma_f32_4x4x4_16b_bf16 v[52:55], v[110:111], v[38:39], 0
    s_waitcnt lgkmcnt(15)
    v_mfma_f32_4x4x4_16b_bf16 v[56:59], v[112:113], v[38:39], 0
    s_waitcnt lgkmcnt(15)
    v_mfma_f32_4x4x4_16b_bf16 v[60:63], v[114:115], v[38:39], 0
    v_mfma_f32_4x4x4_16b_bf16 v[44:47], v[116:117], v[40:41], v[44:47]
    v_mfma_f32_4x4x4_16b_bf16 v[48:51], v[118:119], v[40:41], v[48:51]
    v_mfma_f32_4x4x4_16b_bf16 v[52:55], v[120:121], v[40:41], v[52:55]
    v_mfma_f32_4x4x4_16b_bf16 v[56:59], v[122:123], v[40:41], v[56:59]
    s_waitcnt lgkmcnt(15)
    v_mfma_f32_4x4x4_16b_bf16 v[60:63], v[124:125], v[40:41], v[60:63]
    v_mfma_f32_4x4x4_16b_bf16 v[44:47], v[96:97], v[36:37], v[44:47]
    v_mfma_f32_4x4x4_16b_bf16 v[48:51], v[98:99], v[36:37], v[48:51]
    v_mfma_f32_4x4x4_16b_bf16 v[52:55], v[100:101], v[36:37], v[52:55]
    v_mfma_f32_4x4x4_16b_bf16 v[56:59], v[102:103], v[36:37], v[56:59]
    v_mfma_f32_4x4x4_16b_bf16 v[60:63], v[104:105], v[36:37], v[60:63]
    buffer_load_dword v13, v15, s[12:15], 0 offen sc1
    v_cndmask_b32 v213, v205, v213, s[36:37]
    v_cndmask_b32 v214, v206, v214, s[38:39]
    v_cndmask_b32 v215, v207, v215, s[40:41]
    v_cvt_pk_bf16_f32 v204, v208, v209
    v_cvt_pk_bf16_f32 v205, v210, v211
    v_cvt_pk_bf16_f32 v206, v212, v213
    v_cvt_pk_bf16_f32 v207, v214, v215
    v_lshlrev_b32 v208, 16, v204
    v_and_b32 v209, s50, v204
    v_lshlrev_b32 v210, 16, v205
    v_and_b32 v211, s50, v205
    v_lshlrev_b32 v212, 16, v206
    v_and_b32 v213, s50, v206
    v_lshlrev_b32 v214, 16, v207
    v_and_b32 v215, s50, v207
    v_pk_mul_f32 v[208:209], v[208:209], s[52:53]
    v_pk_mul_f32 v[210:211], v[210:211], s[52:53]
    v_pk_mul_f32 v[212:213], v[212:213], s[52:53]
    v_pk_mul_f32 v[214:215], v[214:215], s[52:53]
    v_cvt_pk_bf16_f32 v204, v208, v209
    v_cvt_pk_bf16_f32 v205, v210, v211
    v_cvt_pk_bf16_f32 v206, v212, v213
    v_cvt_pk_bf16_f32 v207, v214, v215
    v_lshlrev_b32 v208, 16, v204
    v_and_b32 v209, s50, v204
    v_lshlrev_b32 v210, 16, v205
    v_and_b32 v211, s50, v205
    v_lshlrev_b32 v212, 16, v206
    v_and_b32 v213, s50, v206
    v_lshlrev_b32 v214, 16, v207
    v_and_b32 v215, s50, v207
    s_cmp_eq_u32 s72, 0
    s_cbranch_scc0 L_nomask_8
    v_mov_b32 v190, 0xce6e6b28
    v_cndmask_b32 v208, v208, v190, s[42:43]
    v_cndmask_b32 v209, v209, v190, s[42:43]
    v_cndmask_b32 v210, v210, v190, s[42:43]
    v_cndmask_b32 v211, v211, v190, s[42:43]
    v_cndmask_b32 v213, v213, v190, s[44:45]
    v_cndmask_b32 v214, v214, v190, s[46:47]
    v_cndmask_b32 v215, v215, v190, s[48:49]
L_nomask_8:
    v_max3_f32 v204, v208, v209, v210
    v_max3_f32 v205, v211, v212, v213
    v_max3_f32 v204, v204, v214, v215
    v_max_f32 v204, v204, v205
    v_mul_f32 v204, s54, v204
    v_pk_fma_f32 v[208:209], v[208:209], s[54:55], v[204:205] op_sel_hi:[1,1,0] neg_lo:[0,0,1] neg_hi:[0,0,1]
    v_pk_fma_f32 v[210:211], v[210:211], s[54:55], v[204:205] op_sel_hi:[1,1,0] neg_lo:[0,0,1] neg_hi:[0,0,1]
    v_pk_fma_f32 v[212:213], v[212:213], s[54:55], v[204:205] op_sel_hi:[1,1,0] neg_lo:[0,0,1] neg_hi:[0,0,1]
    v_pk_fma_f32 v[214:215], v[214:215], s[54:55], v[204:205] op_sel_hi:[1,1,0] neg_lo:[0,0,1] neg_hi:[0,0,1]
    v_exp_f32 v208, v208
    v_exp_f32 v209, v209
    v_exp_f32 v210, v210
    v_exp_f32 v211, v211
    v_exp_f32 v212, v212
    v_exp_f32 v213, v213
    v_exp_f32 v214, v214
    v_exp_f32 v215, v215
    v_pk_add_f32 v[204:205], v[208:209], v[210:211]
    v_pk_add_f32 v[206:207], v[212:213], v[214:215]
    v_pk_add_f32 v[204:205], v[204:205], v[206:207]
    v_add_f32 v204, v204, v205
    v_rcp_f32 v204, v204
    v_cvt_pk_bf16_f32 v16, v44, v45
    v_cvt_pk_bf16_f32 v17, v46, v47
    v_cvt_pk_bf16_f32 v18, v48, v49
    v_cvt_pk_bf16_f32 v19, v50, v51
    v_cvt_pk_bf16_f32 v20, v52, v53
    v_cvt_pk_bf16_f32 v21, v54, v55
    v_cvt_pk_bf16_f32 v22, v56, v57
    v_cvt_pk_bf16_f32 v23, v58, v59
    v_cvt_pk_bf16_f32 v24, v60, v61
    v_cvt_pk_bf16_f32 v25, v62, v63
    buffer_store_dwordx4 v[16:19], v220, s[12:15], s35 offen offset:0 sc1
    buffer_store_dwordx4 v[20:23], v220, s[12:15], s35 offen offset:256 sc1
    v_pk_mul_f32 v[208:209], v[208:209], v[204:205] op_sel_hi:[1,0]
    v_pk_mul_f32 v[210:211], v[210:211], v[204:205] op_sel_hi:[1,0]
    v_pk_mul_f32 v[212:213], v[212:213], v[204:205] op_sel_hi:[1,0]
    v_pk_mul_f32 v[214:215], v[214:215], v[204:205] op_sel_hi:[1,0]
    v_cvt_pk_bf16_f32 v68, v208, v209
    v_cvt_pk_bf16_f32 v69, v210, v211
    v_cvt_pk_bf16_f32 v66, v212, v213
    v_cvt_pk_bf16_f32 v67, v214, v215
    v_and_b32 v70, v66, v221
    v_and_b32 v71, v67, v222
    v_xor_b32 v66, v66, v70
    v_xor_b32 v67, v67, v71
    s_waitcnt lgkmcnt(13)
    v_mfma_f32_4x4x4_16b_bf16 v[74:77], v[136:137], v[68:69], 0
    s_waitcnt lgkmcnt(10)
    v_mfma_f32_4x4x4_16b_bf16 v[78:81], v[138:139], v[68:69], 0
    s_waitcnt lgkmcnt(7)
    v_mfma_f32_4x4x4_16b_bf16 v[82:85], v[140:141], v[68:69], 0
    s_waitcnt lgkmcnt(4)
    v_mfma_f32_4x4x4_16b_bf16 v[86:89], v[142:143], v[68:69], 0
    s_waitcnt lgkmcnt(1)
    v_mfma_f32_4x4x4_16b_bf16 v[90:93], v[144:145], v[68:69], 0
    v_mfma_f32_4x4x4_16b_bf16 v[74:77], v[146:147], v[70:71], v[74:77]
    v_mfma_f32_4x4x4_16b_bf16 v[78:81], v[148:149], v[70:71], v[78:81]
    v_mfma_f32_4x4x4_16b_bf16 v[82:85], v[150:151], v[70:71], v[82:85]
    v_mfma_f32_4x4x4_16b_bf16 v[86:89], v[152:153], v[70:71], v[86:89]
    s_waitcnt lgkmcnt(0)
    v_mfma_f32_4x4x4_16b_bf16 v[90:93], v[154:155], v[70:71], v[90:93]
    v_mfma_f32_4x4x4_16b_bf16 v[74:77], v[126:127], v[66:67], v[74:77]
    v_mfma_f32_4x4x4_16b_bf16 v[78:81], v[128:129], v[66:67], v[78:81]
    v_mfma_f32_4x4x4_16b_bf16 v[82:85], v[130:131], v[66:67], v[82:85]
    v_mfma_f32_4x4x4_16b_bf16 v[86:89], v[132:133], v[66:67], v[86:89]
    v_mfma_f32_4x4x4_16b_bf16 v[90:93], v[134:135], v[66:67], v[90:93]
    s_nop 0
    v_cvt_pk_bf16_f32 v26, v74, v75
    v_cvt_pk_bf16_f32 v27, v76, v77
    buffer_store_dwordx4 v[24:27], v220, s[12:15], s35 offen offset:512 sc1
    v_cvt_pk_bf16_f32 v28, v78, v79
    v_cvt_pk_bf16_f32 v29, v80, v81
    v_cvt_pk_bf16_f32 v30, v82, v83
    v_cvt_pk_bf16_f32 v31, v84, v85
    buffer_store_dwordx4 v[28:31], v220, s[12:15], s35 offen offset:768 sc1
    v_cvt_pk_bf16_f32 v32, v86, v87
    v_cvt_pk_bf16_f32 v33, v88, v89
    v_cvt_pk_bf16_f32 v34, v90, v91
    v_cvt_pk_bf16_f32 v35, v92, v93
    buffer_store_dwordx4 v[32:35], v220, s[12:15], s35 offen offset:1024 sc1
    s_waitcnt vmcnt(5)
    v_cmp_ne_u32 vcc, s79, v13
    s_nop 0
    s_cmp_eq_u64 vcc, 0
    s_cselect_b32 s19, 1, 0
    s_cselect_b32 s68, 0, 1073741824
    v_add_u32 v6, s68, v10
    s_branch L_phase2
L_ffn:
    s_mul_i32 s71, s76, 303104
    s_add_u32 s71, s71, 2641920
    s_mul_i32 s72, s60, 14
    s_add_u32 s73, s72, 7
    s_min_u32 s73, s73, 47
    s_lshl_b32 s72, s72, 10
    s_add_u32 s72, s71, s72
    s_lshl_b32 s73, s73, 10
    s_add_u32 s73, s71, s73
    s_add_u32 s71, s60, 1
    s_and_b32 s71, s71, 3
    s_mul_i32 s71, s71, 75776
    s_add_u32 s24, s72, s71
    s_add_u32 s28, s73, s71
    s_add_u32 s71, s60, 2
    s_and_b32 s71, s71, 3
    s_mul_i32 s71, s71, 75776
    s_add_u32 s25, s72, s71
    s_add_u32 s29, s73, s71
    s_add_u32 s71, s60, 3
    s_and_b32 s71, s71, 3
    s_mul_i32 s71, s71, 75776
    s_add_u32 s26, s72, s71
    s_add_u32 s30, s73, s71
    s_add_u32 s71, s60, 4
    s_and_b32 s71, s71, 3
    s_mul_i32 s71, s71, 75776
    s_add_u32 s27, s72, s71
    s_add_u32 s31, s73, s71
    s_cmp_eq_u32 s60, 0
    s_cbranch_scc0 L_lnw_9
    buffer_load_dword v13, v12, s[12:15], 0 offen sc1
    s_waitcnt vmcnt(0)
    v_cmp_ne_u32 vcc, s79, v13
    s_mov_b32 s78, 0
    s_nop 3
    s_cbranch_vccz L_polled_ln_11
L_poll_ln_10:
    s_sleep 1
    buffer_load_dword v13, v12, s[12:15], 0 offen sc1
    s_waitcnt vmcnt(0)
    v_cmp_ne_u32 vcc, s79, v13
    s_add_u32 s78, s78, 1
    s_nop 3
    s_cbranch_vccz L_polled_ln_11
    s_cmp_lt_u32 s78, 0x40000
    s_cbranch_scc1 L_poll_ln_10
L_polled_ln_11:
L_lnw_9:
    s_waitcnt lgkmcnt(0)
    s_barrier
    buffer_load_dwordx4 a[112:115], v250, s[12:15], s36 offen offset:0 sc1
    buffer_load_dwordx4 a[116:119], v250, s[12:15], s41 offen offset:0 sc1
    buffer_load_dwordx4 a[120:123], v250, s[12:15], s36 offen offset:1024 sc1
    buffer_load_dwordx4 a[124:127], v250, s[12:15], s41 offen offset:1024 sc1
    buffer_load_dwordx4 a[128:131], v250, s[12:15], s36 offen offset:2048 sc1
    buffer_load_dwordx4 a[132:135], v250, s[12:15], s41 offen offset:2048 sc1
    buffer_load_dwordx4 a[136:139], v250, s[12:15], s36 offen offset:3072 sc1
    buffer_load_dwordx4 a[140:143], v250, s[12:15], s41 offen offset:3072 sc1
    v_mov_b32 v189, 155648
    ds_read_b32 v188, v189 offset:4
    s_waitcnt lgkmcnt(0)
    v_readfirstlane_b32 s79, v188
    s_lshl_b32 s71, s60, 9
    s_add_u32 s71, s71, 135168
    v_lshl_add_u32 v188, v1, 3, s71
    s_waitcnt vmcnt(8)
    ds_write_b64 v188, v[226:227]
    v_lshrrev_b32 v188, 4, v1
    v_lshl_add_u32 v188, v188, 3, s71
    ds_read_b64 v[196:197], v188 offset:0
    ds_read_b64 v[198:199], v188 offset:32
    ds_read_b64 v[200:201], v188 offset:64
    ds_read_b64 v[202:203], v188 offset:96
    ds_read_b64 v[204:205], v188 offset:128
    ds_read_b64 v[206:207], v188 offset:160
    ds_read_b64 v[208:209], v188 offset:192
    ds_read_b64 v[210:211], v188 offset:224
    ds_read_b64 v[212:213], v188 offset:256
    ds_read_b64 v[214:215], v188 offset:288
    ds_read_b64 v[216:217], v188 offset:320
    ds_read_b64 v[218:219], v188 offset:352
    ds_read_b64 v[220:221], v188 offset:384
    ds_read_b64 v[222:223], v188 offset:416
    s_mov_b32 s72, 0xffff0000
    s_waitcnt lgkmcnt(13)
    v_lshlrev_b32 v16, 16, v196
    v_and_b32 v17, s72, v196
    v_lshlrev_b32 v18, 16, v197
    v_and_b32 v19, s72, v197
    v_lshlrev_b32 v20, 16, v196
    v_and_b32 v21, s72, v196
    v_lshlrev_b32 v22, 16, v197
    v_and_b32 v23, s72, v197
    s_waitcnt lgkmcnt(12)
    v_lshlrev_b32 v24, 16, v198
    v_and_b32 v25, s72, v198
    v_lshlrev_b32 v26, 16, v199
    v_and_b32 v27, s72, v199
    v_lshlrev_b32 v28, 16, v198
    v_and_b32 v29, s72, v198
    v_lshlrev_b32 v30, 16, v199
    v_and_b32 v31, s72, v199
    s_waitcnt lgkmcnt(11)
    v_lshlrev_b32 v32, 16, v200
    v_and_b32 v33, s72, v200
    v_lshlrev_b32 v34, 16, v201
    v_and_b32 v35, s72, v201
    v_lshlrev_b32 v36, 16, v200
    v_and_b32 v37, s72, v200
    v_lshlrev_b32 v38, 16, v201
    v_and_b32 v39, s72, v201
    s_waitcnt lgkmcnt(10)
    v_lshlrev_b32 v40, 16, v202
    v_and_b32 v41, s72, v202
    v_lshlrev_b32 v42, 16, v203
    v_and_b32 v43, s72, v203
    v_lshlrev_b32 v44, 16, v202
    v_and_b32 v45, s72, v202
    v_lshlrev_b32 v46, 16, v203
    v_and_b32 v47, s72, v203
    s_waitcnt lgkmcnt(9)
    v_lshlrev_b32 v48, 16, v204
    v_and_b32 v49, s72, v204
    v_lshlrev_b32 v50, 16, v205
    v_and_b32 v51, s72, v205
    v_lshlrev_b32 v52, 16, v204
    v_and_b32 v53, s72, v204
    v_lshlrev_b32 v54, 16, v205
    v_and_b32 v55, s72, v205
    s_waitcnt lgkmcnt(8)
    v_lshlrev_b32 v56, 16, v206
    v_and_b32 v57, s72, v206
    v_lshlrev_b32 v58, 16, v207
    v_and_b32 v59, s72, v207
    v_lshlrev_b32 v60, 16, v206
    v_and_b32 v61, s72, v206
    v_lshlrev_b32 v62, 16, v207
    v_and_b32 v63, s72, v207
    s_waitcnt lgkmcnt(7)
    v_lshlrev_b32 v64, 16, v208
    v_and_b32 v65, s72, v208
    v_lshlrev_b32 v66, 16, v209
    v_and_b32 v67, s72, v209
    v_lshlrev_b32 v68, 16, v208
    v_and_b32 v69, s72, v208
    v_lshlrev_b32 v70, 16, v209
    v_and_b32 v71, s72, v209
    s_waitcnt lgkmcnt(6)
    v_lshlrev_b32 v72, 16, v210
    v_and_b32 v73, s72, v210
    v_lshlrev_b32 v74, 16, v211
    v_and_b32 v75, s72, v211
    v_lshlrev_b32 v76, 16, v210
    v_and_b32 v77, s72, v210
    v_lshlrev_b32 v78, 16, v211
    v_and_b32 v79, s72, v211
    s_waitcnt lgkmcnt(5)
    v_lshlrev_b32 v80, 16, v212
    v_and_b32 v81, s72, v212
    v_lshlrev_b32 v82, 16, v213
    v_and_b32 v83, s72, v213
    v_lshlrev_b32 v84, 16, v212
    v_and_b32 v85, s72, v212
    v_lshlrev_b32 v86, 16, v213
    v_and_b32 v87, s72, v213
    s_waitcnt lgkmcnt(4)
    v_lshlrev_b32 v88, 16, v214
    v_and_b32 v89, s72, v214
    v_lshlrev_b32 v90, 16, v215
    v_and_b32 v91, s72, v215
    v_lshlrev_b32 v92, 16, v214
    v_and_b32 v93, s72, v214
    v_lshlrev_b32 v94, 16, v215
    v_and_b32 v95, s72, v215
    s_waitcnt lgkmcnt(3)
    v_lshlrev_b32 v96, 16, v216
    v_and_b32 v97, s72, v216
    v_lshlrev_b32 v98, 16, v217
    v_and_b32 v99, s72, v217
    v_lshlrev_b32 v100, 16, v216
    v_and_b32 v101, s72, v216
    v_lshlrev_b32 v102, 16, v217
    v_and_b32 v103, s72, v217
    s_waitcnt lgkmcnt(2)
    v_lshlrev_b32 v104, 16, v218
    v_and_b32 v105, s72, v218
    v_lshlrev_b32 v106, 16, v219
    v_and_b32 v107, s72, v219
    v_lshlrev_b32 v108, 16, v218
    v_and_b32 v109, s72, v218
    v_lshlrev_b32 v110, 16, v219
    v_and_b32 v111, s72, v219
    s_waitcnt lgkmcnt(1)
    v_lshlrev_b32 v112, 16, v220
    v_and_b32 v113, s72, v220
    v_lshlrev_b32 v114, 16, v221
    v_and_b32 v115, s72, v221
    v_lshlrev_b32 v116, 16, v220
    v_and_b32 v117, s72, v220
    v_lshlrev_b32 v118, 16, v221
    v_and_b32 v119, s72, v221
    s_waitcnt lgkmcnt(0)
    v_lshlrev_b32 v120, 16, v222
    v_and_b32 v121, s72, v222
    v_lshlrev_b32 v122, 16, v223
    v_and_b32 v123, s72, v223
    v_lshlrev_b32 v124, 16, v222
    v_and_b32 v125, s72, v222
    v_lshlrev_b32 v126, 16, v223
    v_and_b32 v127, s72, v223
    v_mov_b32 v128, 0xc0135761
    v_mov_b32 v129, 0xc0135761
    v_mov_b32 v130, 1.0
    v_mov_b32 v131, 1.0
    s_mov_b32 s46, 0xbdd2d3e8
    s_mov_b32 s47, 0xbdd2d3e8
    s_mul_i32 s48, s33, 75776
    s_lshl_b32 s71, s67, 10
    s_add_u32 s48, s48, s71
    s_add_u32 s48, s48, 2641920
    s_add_u32 s49, s48, 75776
    ds_read_b64_tr_b16 v[148:149], v6 offset:0
    ds_read_b64_tr_b16 v[150:151], v6 offset:512
    ds_read_b64_tr_b16 v[152:153], v6 offset:32
    ds_read_b64_tr_b16 v[154:155], v6 offset:544
    ds_read_b64_tr_b16 v[156:157], v6 offset:64
    ds_read_b64_tr_b16 v[158:159], v6 offset:576
    ds_read_b64_tr_b16 v[160:161], v6 offset:96
    ds_read_b64_tr_b16 v[162:163], v6 offset:608
    ds_read_b64_tr_b16 v[164:165], v6 offset:128
    ds_read_b64_tr_b16 v[166:167], v6 offset:640
    ds_read_b64_tr_b16 v[168:169], v6 offset:160
    ds_read_b64_tr_b16 v[170:171], v6 offset:672
    ds_read_b64_tr_b16 v[172:173], v6 offset:192
    ds_read_b64_tr_b16 v[174:175], v6 offset:704
    s_cmp_eq_u32 s60, 0
    s_mov_b32 s71, 1073741824
    s_cselect_b32 s71, 15400960, s71
    v_lshl_add_u32 v12, v1, 6, s71
    s_waitcnt vmcnt(6) lgkmcnt(10)
    v_mfma_f32_16x16x32_bf16 v[16:19], v[148:151], a[112:115], v[16:19]
    ds_read_b64_tr_b16 v[176:177], v6 offset:224
    ds_read_b64_tr_b16 v[178:179], v6 offset:736
    v_mfma_f32_16x16x32_bf16 v[20:23], v[148:151], a[116:119], v[20:23]
    buffer_load_dwordx4 a[144:147], v250, s[12:15], s37 offen offset:0 sc1
    v_mfma_f32_16x16x32_bf16 v[24:27], v[152:155], a[112:115], v[24:27]
    ds_read_b64_tr_b16 v[148:149], v6 offset:256
    ds_read_b64_tr_b16 v[150:151], v6 offset:768
    v_mfma_f32_16x16x32_bf16 v[28:31], v[152:155], a[116:119], v[28:31]
    s_waitcnt lgkmcnt(10)
    s_add_u32 m0, s74, 67584
    v_mfma_f32_16x16x32_bf16 v[32:35], v[156:159], a[112:115], v[32:35]
    ds_read_b64_tr_b16 v[152:153], v6 offset:288
    ds_read_b64_tr_b16 v[154:155], v6 offset:800
    v_mfma_f32_16x16x32_bf16 v[36:39], v[156:159], a[116:119], v[36:39]
    buffer_load_dwordx4 v2, s[8:11], s75 offen offset:0 lds
    v_mfma_f32_16x16x32_bf16 v[40:43], v[160:163], a[112:115], v[40:43]
    ds_read_b64_tr_b16 v[156:157], v6 offset:320
    ds_read_b64_tr_b16 v[158:159], v6 offset:832
    v_mfma_f32_16x16x32_bf16 v[44:47], v[160:163], a[116:119], v[44:47]
    s_waitcnt lgkmcnt(10)
    v_mfma_f32_16x16x32_bf16 v[48:51], v[164:167], a[112:115], v[48:51]
    ds_read_b64_tr_b16 v[160:161], v6 offset:352
    ds_read_b64_tr_b16 v[162:163], v6 offset:864
    v_mfma_f32_16x16x32_bf16 v[52:55], v[164:167], a[116:119], v[52:55]
    buffer_load_dwordx4 v3, s[8:11], s75 offen offset:1056 lds
    v_mfma_f32_16x16x32_bf16 v[56:59], v[168:171], a[112:115], v[56:59]
    ds_read_b64_tr_b16 v[164:165], v6 offset:384
    ds_read_b64_tr_b16 v[166:167], v6 offset:896
    v_mfma_f32_16x16x32_bf16 v[60:63], v[168:171], a[116:119], v[60:63]
    s_waitcnt lgkmcnt(10)
    v_mfma_f32_16x16x32_bf16 v[64:67], v[172:175], a[112:115], v[64:67]
    ds_read_b64_tr_b16 v[168:169], v6 offset:416
    ds_read_b64_tr_b16 v[170:171], v6 offset:928
    v_mfma_f32_16x16x32_bf16 v[68:71], v[172:175], a[116:119], v[68:71]
    buffer_load_dwordx4 a[148:151], v250, s[12:15], s42 offen offset:0 sc1
    v_mfma_f32_16x16x32_bf16 v[72:75], v[176:179], a[112:115], v[72:75]
    ds_read_b64_tr_b16 v[172:173], v6 offset:16896
    ds_read_b64_tr_b16 v[174:175], v6 offset:17408
    v_mfma_f32_16x16x32_bf16 v[76:79], v[176:179], a[116:119], v[76:79]
    s_waitcnt lgkmcnt(10)
    v_mfma_f32_16x16x32_bf16 v[80:83], v[148:151], a[112:115], v[80:83]
    ds_read_b64_tr_b16 v[176:177], v6 offset:16928
    ds_read_b64_tr_b16 v[178:179], v6 offset:17440
    v_mfma_f32_16x16x32_bf16 v[84:87], v[148:151], a[116:119], v[84:87]
    buffer_load_dwordx4 v4, s[8:11], s75 offen offset:2112 lds
    v_mfma_f32_16x16x32_bf16 v[88:91], v[152:155], a[112:115], v[88:91]
    ds_read_b64_tr_b16 v[148:149], v6 offset:16960
    ds_read_b64_tr_b16 v[150:151], v6 offset:17472
    v_mfma_f32_16x16x32_bf16 v[92:95], v[152:155], a[116:119], v[92:95]
    s_waitcnt lgkmcnt(10)
    v_mfma_f32_16x16x32_bf16 v[96:99], v[156:159], a[112:115], v[96:99]
    ds_read_b64_tr_b16 v[152:153], v6 offset:16992
    ds_read_b64_tr_b16 v[154:155], v6 offset:17504
    v_mfma_f32_16x16x32_bf16 v[100:103], v[156:159], a[116:119], v[100:103]
    buffer_load_dwordx4 v5, s[8:11], s75 offen offset:3168 lds
    v_mfma_f32_16x16x32_bf16 v[104:107], v[160:163], a[112:115], v[104:107]
    ds_read_b64_tr_b16 v[156:157], v6 offset:17024
    ds_read_b64_tr_b16 v[158:159], v6 offset:17536
    v_mfma_f32_16x16x32_bf16 v[108:111], v[160:163], a[116:119], v[108:111]
    s_waitcnt lgkmcnt(10)
    s_add_u32 s75, s75, s66
    v_mfma_f32_16x16x32_bf16 v[112:115], v[164:167], a[112:115], v[112:115]
    ds_read_b64_tr_b16 v[160:161], v6 offset:17056
    ds_read_b64_tr_b16 v[162:163], v6 offset:17568
    v_mfma_f32_16x16x32_bf16 v[116:119], v[164:167], a[116:119], v[116:119]
    buffer_load_dword v191, v0, s[8:11], 0 offen
    v_mfma_f32_16x16x32_bf16 v[120:123], v[168:171], a[112:115], v[120:123]
    ds_read_b64_tr_b16 v[164:165], v6 offset:17088
    ds_read_b64_tr_b16 v[166:167], v6 offset:17600
    v_mfma_f32_16x16x32_bf16 v[124:127], v[168:171], a[116:119], v[124:127]
    s_waitcnt vmcnt(11) lgkmcnt(10)
    v_mfma_f32_16x16x32_bf16 v[16:19], v[172:175], a[120:123], v[16:19]
    ds_read_b64_tr_b16 v[168:169], v6 offset:17120
    ds_read_b64_tr_b16 v[170:171], v6 offset:17632
    v_mfma_f32_16x16x32_bf16 v[20:23], v[172:175], a[124:127], v[20:23]
    buffer_load_dwordx4 a[152:155], v250, s[12:15], s37 offen offset:1024 sc1
    v_mfma_f32_16x16x32_bf16 v[24:27], v[176:179], a[120:123], v[24:27]
    ds_read_b64_tr_b16 v[172:173], v6 offset:17152
    ds_read_b64_tr_b16 v[174:175], v6 offset:17664
    v_mfma_f32_16x16x32_bf16 v[28:31], v[176:179], a[124:127], v[28:31]
    s_waitcnt lgkmcnt(10)
    s_add_u32 m0, s74, 84480
    v_mfma_f32_16x16x32_bf16 v[32:35], v[148:151], a[120:123], v[32:35]
    ds_read_b64_tr_b16 v[176:177], v6 offset:17184
    ds_read_b64_tr_b16 v[178:179], v6 offset:17696
    v_mfma_f32_16x16x32_bf16 v[36:39], v[148:151], a[124:127], v[36:39]
    buffer_load_dwordx4 v2, s[8:11], s75 offen offset:0 lds
    v_mfma_f32_16x16x32_bf16 v[40:43], v[152:155], a[120:123], v[40:43]
    ds_read_b64_tr_b16 v[148:149], v6 offset:17216
    ds_read_b64_tr_b16 v[150:151], v6 offset:17728
    v_mfma_f32_16x16x32_bf16 v[44:47], v[152:155], a[124:127], v[44:47]
    s_waitcnt lgkmcnt(10)
    v_mfma_f32_16x16x32_bf16 v[48:51], v[156:159], a[120:123], v[48:51]
    ds_read_b64_tr_b16 v[152:153], v6 offset:17248
    ds_read_b64_tr_b16 v[154:155], v6 offset:17760
    v_mfma_f32_16x16x32_bf16 v[52:55], v[156:159], a[124:127], v[52:55]
    buffer_load_dwordx4 v3, s[8:11], s75 offen offset:1056 lds
    v_mfma_f32_16x16x32_bf16 v[56:59], v[160:163], a[120:123], v[56:59]
    ds_read_b64_tr_b16 v[156:157], v6 offset:17280
    ds_read_b64_tr_b16 v[158:159], v6 offset:17792
    v_mfma_f32_16x16x32_bf16 v[60:63], v[160:163], a[124:127], v[60:63]
    s_waitcnt lgkmcnt(10)
    v_mfma_f32_16x16x32_bf16 v[64:67], v[164:167], a[120:123], v[64:67]
    ds_read_b64_tr_b16 v[160:161], v6 offset:17312
    ds_read_b64_tr_b16 v[162:163], v6 offset:17824
    v_mfma_f32_16x16x32_bf16 v[68:71], v[164:167], a[124:127], v[68:71]
    s_barrier
    v_mfma_f32_16x16x32_bf16 v[72:75], v[168:171], a[120:123], v[72:75]
    ds_read_b64_tr_b16 v[164:165], v6 offset:33792
    ds_read_b64_tr_b16 v[166:167], v6 offset:34304
    v_mfma_f32_16x16x32_bf16 v[76:79], v[168:171], a[124:127], v[76:79]
    s_waitcnt lgkmcnt(10)
    v_mfma_f32_16x16x32_bf16 v[80:83], v[172:175], a[120:123], v[80:83]
    ds_read_b64_tr_b16 v[168:169], v6 offset:33824
    ds_read_b64_tr_b16 v[170:171], v6 offset:34336
    v_mfma_f32_16x16x32_bf16 v[84:87], v[172:175], a[124:127], v[84:87]
    buffer_load_dwordx4 a[156:159], v250, s[12:15], s42 offen offset:1024 sc1
    v_mfma_f32_16x16x32_bf16 v[88:91], v[176:179], a[120:123], v[88:91]
    ds_read_b64_tr_b16 v[172:173], v6 offset:33856
    ds_read_b64_tr_b16 v[174:175], v6 offset:34368
    v_mfma_f32_16x16x32_bf16 v[92:95], v[176:179], a[124:127], v[92:95]
    s_waitcnt lgkmcnt(10)
    v_mfma_f32_16x16x32_bf16 v[96:99], v[148:151], a[120:123], v[96:99]
    ds_read_b64_tr_b16 v[176:177], v6 offset:33888
    ds_read_b64_tr_b16 v[178:179], v6 offset:34400
    v_mfma_f32_16x16x32_bf16 v[100:103], v[148:151], a[124:127], v[100:103]
    buffer_load_dwordx4 v4, s[8:11], s75 offen offset:2112 lds
    v_mfma_f32_16x16x32_bf16 v[104:107], v[152:155], a[120:123], v[104:107]
    ds_read_b64_tr_b16 v[148:149], v6 offset:33920
    ds_read_b64_tr_b16 v[150:151], v6 offset:34432
    v_mfma_f32_16x16x32_bf16 v[108:111], v[152:155], a[124:127], v[108:111]
    s_waitcnt lgkmcnt(10)
    v_mfma_f32_16x16x32_bf16 v[112:115], v[156:159], a[120:123], v[112:115]
    ds_read_b64_tr_b16 v[152:153], v6 offset:33952
    ds_read_b64_tr_b16 v[154:155], v6 offset:34464
    v_mfma_f32_16x16x32_bf16 v[116:119], v[156:159], a[124:127], v[116:119]
    buffer_load_dwordx4 v5, s[8:11], s75 offen offset:3168 lds
    s_add_u32 s75, s75, s66
    s_lshl_b32 s71, s65, 8
    buffer_load_dword v190, v0, s[8:11], s71 offen
    v_mfma_f32_16x16x32_bf16 v[120:123], v[160:163], a[120:123], v[120:123]
    ds_read_b64_tr_b16 v[156:157], v6 offset:33984
    ds_read_b64_tr_b16 v[158:159], v6 offset:34496
    v_mfma_f32_16x16x32_bf16 v[124:127], v[160:163], a[124:127], v[124:127]
    s_waitcnt vmcnt(16) lgkmcnt(10)
    s_lshr_b32 s71, s2, 2
    s_lshl_b32 s71, s71, 6
    v_mfma_f32_16x16x32_bf16 v[16:19], v[164:167], a[128:131], v[16:19]
    ds_read_b64_tr_b16 v[160:161], v6 offset:34016
    ds_read_b64_tr_b16 v[162:163], v6 offset:34528
    v_mfma_f32_16x16x32_bf16 v[20:23], v[164:167], a[132:135], v[20:23]
    s_and_b32 s72, s2, 3
    s_lshl_b32 s72, s72, 2
    s_add_u32 s71, s71, s72
    v_mfma_f32_16x16x32_bf16 v[24:27], v[168:171], a[128:131], v[24:27]
    ds_read_b64_tr_b16 v[164:165], v6 offset:34048
    ds_read_b64_tr_b16 v[166:167], v6 offset:34560
    v_mfma_f32_16x16x32_bf16 v[28:31], v[168:171], a[132:135], v[28:31]
    s_waitcnt lgkmcnt(10)
    s_add_u32 s71, s71, 15400960
    s_cmp_eq_u32 s60, 1
    v_mfma_f32_16x16x32_bf16 v[32:35], v[172:175], a[128:131], v[32:35]
    ds_read_b64_tr_b16 v[168:169], v6 offset:34080
    ds_read_b64_tr_b16 v[170:171], v6 offset:34592
    v_mfma_f32_16x16x32_bf16 v[36:39], v[172:175], a[132:135], v[36:39]
    s_cselect_b32 s71, s71, 1073741824
    v_mov_b32 v188, s79
    v_lshlrev_b32 v189, 24, v1
    v_mfma_f32_16x16x32_bf16 v[40:43], v[176:179], a[128:131], v[40:43]
    ds_read_b64_tr_b16 v[172:173], v6 offset:34112
    ds_read_b64_tr_b16 v[174:175], v6 offset:34624
    v_mfma_f32_16x16x32_bf16 v[44:47], v[176:179], a[132:135], v[44:47]
    s_waitcnt lgkmcnt(10)
    buffer_store_dword v188, v189, s[12:15], s71 offen sc1
    v_mfma_f32_16x16x32_bf16 v[48:51], v[148:151], a[128:131], v[48:51]
    ds_read_b64_tr_b16 v[176:177], v6 offset:34144
    ds_read_b64_tr_b16 v[178:179], v6 offset:34656
    v_mfma_f32_16x16x32_bf16 v[52:55], v[148:151], a[132:135], v[52:55]
    buffer_load_dwordx4 a[112:115], v250, s[12:15], s37 offen offset:2048 sc1
    s_add_u32 m0, s74, 101376
    v_mfma_f32_16x16x32_bf16 v[56:59], v[152:155], a[128:131], v[56:59]
    ds_read_b64_tr_b16 v[148:149], v6 offset:34176
    ds_read_b64_tr_b16 v[150:151], v6 offset:34688
    v_mfma_f32_16x16x32_bf16 v[60:63], v[152:155], a[132:135], v[60:63]
    s_waitcnt lgkmcnt(10)
    buffer_load_dwordx4 v2, s[8:11], s75 offen offset:0 lds
    v_mfma_f32_16x16x32_bf16 v[64:67], v[156:159], a[128:131], v[64:67]
    ds_read_b64_tr_b16 v[152:153], v6 offset:34208
    ds_read_b64_tr_b16 v[154:155], v6 offset:34720
    v_mfma_f32_16x16x32_bf16 v[68:71], v[156:159], a[132:135], v[68:71]
    buffer_load_dwordx4 v3, s[8:11], s75 offen offset:1056 lds
    v_mfma_f32_16x16x32_bf16 v[72:75], v[160:163], a[128:131], v[72:75]
    ds_read_b64_tr_b16 v[156:157], v6 offset:50688
    ds_read_b64_tr_b16 v[158:159], v6 offset:51200
    v_mfma_f32_16x16x32_bf16 v[76:79], v[160:163], a[132:135], v[76:79]
    s_waitcnt lgkmcnt(10)
    buffer_load_dwordx4 a[116:119], v250, s[12:15], s42 offen offset:2048 sc1
    v_mfma_f32_16x16x32_bf16 v[80:83], v[164:167], a[128:131], v[80:83]
    ds_read_b64_tr_b16 v[160:161], v6 offset:50720
    ds_read_b64_tr_b16 v[162:163], v6 offset:51232
    v_mfma_f32_16x16x32_bf16 v[84:87], v[164:167], a[132:135], v[84:87]
    buffer_load_dwordx4 v4, s[8:11], s75 offen offset:2112 lds
    v_mfma_f32_16x16x32_bf16 v[88:91], v[168:171], a[128:131], v[88:91]
    ds_read_b64_tr_b16 v[164:165], v6 offset:50752
    ds_read_b64_tr_b16 v[166:167], v6 offset:51264
    v_mfma_f32_16x16x32_bf16 v[92:95], v[168:171], a[132:135], v[92:95]
    s_waitcnt lgkmcnt(10)
    buffer_load_dwordx4 v5, s[8:11], s75 offen offset:3168 lds
    v_mfma_f32_16x16x32_bf16 v[96:99], v[172:175], a[128:131], v[96:99]
    ds_read_b64_tr_b16 v[168:169], v6 offset:50784
    ds_read_b64_tr_b16 v[170:171], v6 offset:51296
    v_mfma_f32_16x16x32_bf16 v[100:103], v[172:175], a[132:135], v[100:103]
    s_add_u32 s75, s75, s66
    v_mfma_f32_16x16x32_bf16 v[104:107], v[176:179], a[128:131], v[104:107]
    ds_read_b64_tr_b16 v[172:173], v6 offset:50816
    ds_read_b64_tr_b16 v[174:175], v6 offset:51328
    v_mfma_f32_16x16x32_bf16 v[108:111], v[176:179], a[132:135], v[108:111]
    s_waitcnt lgkmcnt(10)
    v_mfma_f32_16x16x32_bf16 v[112:115], v[148:151], a[128:131], v[112:115]
    ds_read_b64_tr_b16 v[176:177], v6 offset:50848
    ds_read_b64_tr_b16 v[178:179], v6 offset:51360
    v_mfma_f32_16x16x32_bf16 v[116:119], v[148:151], a[132:135], v[116:119]
    v_mfma_f32_16x16x32_bf16 v[120:123], v[152:155], a[128:131], v[120:123]
    ds_read_b64_tr_b16 v[148:149], v6 offset:50880
    ds_read_b64_tr_b16 v[150:151], v6 offset:51392
    v_mfma_f32_16x16x32_bf16 v[124:127], v[152:155], a[132:135], v[124:127]
    s_waitcnt vmcnt(21) lgkmcnt(10)
    v_mfma_f32_16x16x32_bf16 v[16:19], v[156:159], a[136:139], v[16:19]
    ds_read_b64_tr_b16 v[152:153], v6 offset:50912
    ds_read_b64_tr_b16 v[154:155], v6 offset:51424
    v_mfma_f32_16x16x32_bf16 v[20:23], v[156:159], a[140:143], v[20:23]
    buffer_load_dwordx4 a[120:123], v250, s[12:15], s37 offen offset:3072 sc1
    v_mfma_f32_16x16x32_bf16 v[24:27], v[160:163], a[136:139], v[24:27]
    ds_read_b64_tr_b16 v[156:157], v6 offset:50944
    ds_read_b64_tr_b16 v[158:159], v6 offset:51456
    v_mfma_f32_16x16x32_bf16 v[28:31], v[160:163], a[140:143], v[28:31]
    s_waitcnt lgkmcnt(10)
    s_add_u32 m0, s74, 118272
    v_mfma_f32_16x16x32_bf16 v[32:35], v[164:167], a[136:139], v[32:35]
    ds_read_b64_tr_b16 v[160:161], v6 offset:50976
    ds_read_b64_tr_b16 v[162:163], v6 offset:51488
    v_mfma_f32_16x16x32_bf16 v[36:39], v[164:167], a[140:143], v[36:39]
    buffer_load_dwordx4 v2, s[8:11], s75 offen offset:0 lds
    v_mfma_f32_16x16x32_bf16 v[40:43], v[168:171], a[136:139], v[40:43]
    ds_read_b64_tr_b16 v[164:165], v6 offset:51008
    ds_read_b64_tr_b16 v[166:167], v6 offset:51520
    v_mfma_f32_16x16x32_bf16 v[44:47], v[168:171], a[140:143], v[44:47]
    s_waitcnt lgkmcnt(10)
    v_mfma_f32_16x16x32_bf16 v[48:51], v[172:175], a[136:139], v[48:51]
    ds_read_b64_tr_b16 v[168:169], v6 offset:51040
    ds_read_b64_tr_b16 v[170:171], v6 offset:51552
    v_mfma_f32_16x16x32_bf16 v[52:55], v[172:175], a[140:143], v[52:55]
    buffer_load_dwordx4 v3, s[8:11], s75 offen offset:1056 lds
    v_mfma_f32_16x16x32_bf16 v[56:59], v[176:179], a[136:139], v[56:59]
    ds_read_b64_tr_b16 v[172:173], v6 offset:51072
    ds_read_b64_tr_b16 v[174:175], v6 offset:51584
    v_mfma_f32_16x16x32_bf16 v[60:63], v[176:179], a[140:143], v[60:63]
    s_waitcnt lgkmcnt(10)
    v_mfma_f32_16x16x32_bf16 v[64:67], v[148:151], a[136:139], v[64:67]
    ds_read_b64_tr_b16 v[176:177], v6 offset:51104
    ds_read_b64_tr_b16 v[178:179], v6 offset:51616
    v_mfma_f32_16x16x32_bf16 v[68:71], v[148:151], a[140:143], v[68:71]
    s_waitcnt vmcnt(11)
    s_barrier
    v_mfma_f32_16x16x32_bf16 v[72:75], v[152:155], a[136:139], v[72:75]
    ds_read_b64_tr_b16 v[148:149], v7 offset:0
    ds_read_b64_tr_b16 v[150:151], v7 offset:512
    v_mfma_f32_16x16x32_bf16 v[76:79], v[152:155], a[140:143], v[76:79]
    s_waitcnt lgkmcnt(10)
    v_mfma_f32_16x16x32_bf16 v[80:83], v[156:159], a[136:139], v[80:83]
    ds_read_b64_tr_b16 v[152:153], v7 offset:32
    ds_read_b64_tr_b16 v[154:155], v7 offset:544
    v_mfma_f32_16x16x32_bf16 v[84:87], v[156:159], a[140:143], v[84:87]
    buffer_load_dwordx4 a[124:127], v250, s[12:15], s42 offen offset:3072 sc1
    v_mfma_f32_16x16x32_bf16 v[88:91], v[160:163], a[136:139], v[88:91]
    ds_read_b64_tr_b16 v[156:157], v7 offset:64
    ds_read_b64_tr_b16 v[158:159], v7 offset:576
    v_mfma_f32_16x16x32_bf16 v[92:95], v[160:163], a[140:143], v[92:95]
    s_waitcnt lgkmcnt(10)
    v_mfma_f32_16x16x32_bf16 v[96:99], v[164:167], a[136:139], v[96:99]
    ds_read_b64_tr_b16 v[160:161], v7 offset:96
    ds_read_b64_tr_b16 v[162:163], v7 offset:608
    v_mfma_f32_16x16x32_bf16 v[100:103], v[164:167], a[140:143], v[100:103]
    buffer_load_dwordx4 v4, s[8:11], s75 offen offset:2112 lds
    v_mfma_f32_16x16x32_bf16 v[104:107], v[168:171], a[136:139], v[104:107]
    ds_read_b64_tr_b16 v[164:165], v7 offset:128
    ds_read_b64_tr_b16 v[166:167], v7 offset:640
    v_mfma_f32_16x16x32_bf16 v[108:111], v[168:171], a[140:143], v[108:111]
    s_waitcnt lgkmcnt(10)
    v_mfma_f32_16x16x32_bf16 v[112:115], v[172:175], a[136:139], v[112:115]
    ds_read_b64_tr_b16 v[168:169], v7 offset:160
    ds_read_b64_tr_b16 v[170:171], v7 offset:672
    v_mfma_f32_16x16x32_bf16 v[116:119], v[172:175], a[140:143], v[116:119]
    buffer_load_dwordx4 v5, s[8:11], s75 offen offset:3168 lds
    s_add_u32 s75, s75, s66
    v_mfma_f32_16x16x32_bf16 v[120:123], v[176:179], a[136:139], v[120:123]
    ds_read_b64_tr_b16 v[172:173], v7 offset:192
    ds_read_b64_tr_b16 v[174:175], v7 offset:704
    v_mfma_f32_16x16x32_bf16 v[124:127], v[176:179], a[140:143], v[124:127]
    s_waitcnt lgkmcnt(10)
    v_mfma_f32_16x16x32_bf16 v[16:19], v[148:151], a[144:147], v[16:19]
    ds_read_b64_tr_b16 v[176:177], v7 offset:224
    ds_read_b64_tr_b16 v[178:179], v7 offset:736
    v_mfma_f32_16x16x32_bf16 v[20:23], v[148:151], a[148:151], v[20:23]
    buffer_load_dwordx4 a[128:131], v250, s[12:15], s38 offen offset:0 sc1
    v_mfma_f32_16x16x32_bf16 v[24:27], v[152:155], a[144:147], v[24:27]
    ds_read_b64_tr_b16 v[148:149], v7 offset:256
    ds_read_b64_tr_b16 v[150:151], v7 offset:768
    v_mfma_f32_16x16x32_bf16 v[28:31], v[152:155], a[148:151], v[28:31]
    s_waitcnt lgkmcnt(10)
    s_add_u32 m0, s74, 0
    v_mfma_f32_16x16x32_bf16 v[32:35], v[156:159], a[144:147], v[32:35]
    ds_read_b64_tr_b16 v[152:153], v7 offset:288
    ds_read_b64_tr_b16 v[154:155], v7 offset:800
    v_mfma_f32_16x16x32_bf16 v[36:39], v[156:159], a[148:151], v[36:39]
    buffer_load_dwordx4 v2, s[8:11], s75 offen offset:0 lds
    v_mfma_f32_16x16x32_bf16 v[40:43], v[160:163], a[144:147], v[40:43]
    ds_read_b64_tr_b16 v[156:157], v7 offset:320
    ds_read_b64_tr_b16 v[158:159], v7 offset:832
    v_mfma_f32_16x16x32_bf16 v[44:47], v[160:163], a[148:151], v[44:47]
    s_waitcnt lgkmcnt(10)
    v_mfma_f32_16x16x32_bf16 v[48:51], v[164:167], a[144:147], v[48:51]
    ds_read_b64_tr_b16 v[160:161], v7 offset:352
    ds_read_b64_tr_b16 v[162:163], v7 offset:864
    v_mfma_f32_16x16x32_bf16 v[52:55], v[164:167], a[148:151], v[52:55]
    buffer_load_dwordx4 v3, s[8:11], s75 offen offset:1056 lds
    v_mfma_f32_16x16x32_bf16 v[56:59], v[168:171], a[144:147], v[56:59]
    ds_read_b64_tr_b16 v[164:165], v7 offset:384
    ds_read_b64_tr_b16 v[166:167], v7 offset:896
    v_mfma_f32_16x16x32_bf16 v[60:63], v[168:171], a[148:151], v[60:63]
    s_waitcnt lgkmcnt(10)
    v_mfma_f32_16x16x32_bf16 v[64:67], v[172:175], a[144:147], v[64:67]
    ds_read_b64_tr_b16 v[168:169], v7 offset:416
    ds_read_b64_tr_b16 v[170:171], v7 offset:928
    v_mfma_f32_16x16x32_bf16 v[68:71], v[172:175], a[148:151], v[68:71]
    buffer_load_dwordx4 a[132:135], v250, s[12:15], s43 offen offset:0 sc1
    v_mfma_f32_16x16x32_bf16 v[72:75], v[176:179], a[144:147], v[72:75]
    ds_read_b64_tr_b16 v[172:173], v7 offset:16896
    ds_read_b64_tr_b16 v[174:175], v7 offset:17408
    v_mfma_f32_16x16x32_bf16 v[76:79], v[176:179], a[148:151], v[76:79]
    s_waitcnt lgkmcnt(10)
    v_mfma_f32_16x16x32_bf16 v[80:83], v[148:151], a[144:147], v[80:83]
    ds_read_b64_tr_b16 v[176:177], v7 offset:16928
    ds_read_b64_tr_b16 v[178:179], v7 offset:17440
    v_mfma_f32_16x16x32_bf16 v[84:87], v[148:151], a[148:151], v[84:87]
    buffer_load_dwordx4 v4, s[8:11], s75 offen offset:2112 lds
    v_mfma_f32_16x16x32_bf16 v[88:91], v[152:155], a[144:147], v[88:91]
    ds_read_b64_tr_b16 v[148:149], v7 offset:16960
    ds_read_b64_tr_b16 v[150:151], v7 offset:17472
    v_mfma_f32_16x16x32_bf16 v[92:95], v[152:155], a[148:151], v[92:95]
    s_waitcnt lgkmcnt(10)
    v_mfma_f32_16x16x32_bf16 v[96:99], v[156:159], a[144:147], v[96:99]
    ds_read_b64_tr_b16 v[152:153], v7 offset:16992
    ds_read_b64_tr_b16 v[154:155], v7 offset:17504
    v_mfma_f32_16x16x32_bf16 v[100:103], v[156:159], a[148:151], v[100:103]
    buffer_load_dwordx4 v5, s[8:11], s75 offen offset:3168 lds
    v_mfma_f32_16x16x32_bf16 v[104:107], v[160:163], a[144:147], v[104:107]
    ds_read_b64_tr_b16 v[156:157], v7 offset:17024
    ds_read_b64_tr_b16 v[158:159], v7 offset:17536
    v_mfma_f32_16x16x32_bf16 v[108:111], v[160:163], a[148:151], v[108:111]
    s_waitcnt lgkmcnt(10)
    s_add_u32 s75, s75, s66
    v_mfma_f32_16x16x32_bf16 v[112:115], v[164:167], a[144:147], v[112:115]
    ds_read_b64_tr_b16 v[160:161], v7 offset:17056
    ds_read_b64_tr_b16 v[162:163], v7 offset:17568
    v_mfma_f32_16x16x32_bf16 v[116:119], v[164:167], a[148:151], v[116:119]
    v_mfma_f32_16x16x32_bf16 v[120:123], v[168:171], a[144:147], v[120:123]
    ds_read_b64_tr_b16 v[164:165], v7 offset:17088
    ds_read_b64_tr_b16 v[166:167], v7 offset:17600
    v_mfma_f32_16x16x32_bf16 v[124:127], v[168:171], a[148:151], v[124:127]
    s_waitcnt lgkmcnt(10)
    v_mfma_f32_16x16x32_bf16 v[16:19], v[172:175], a[152:155], v[16:19]
    ds_read_b64_tr_b16 v[168:169], v7 offset:17120
    ds_read_b64_tr_b16 v[170:171], v7 offset:17632
    v_mfma_f32_16x16x32_bf16 v[20:23], v[172:175], a[156:159], v[20:23]
    buffer_load_dwordx4 a[136:139], v250, s[12:15], s38 offen offset:1024 sc1
    v_mfma_f32_16x16x32_bf16 v[24:27], v[176:179], a[152:155], v[24:27]
    ds_read_b64_tr_b16 v[172:173], v7 offset:17152
    ds_read_b64_tr_b16 v[174:175], v7 offset:17664
    v_mfma_f32_16x16x32_bf16 v[28:31], v[176:179], a[156:159], v[28:31]
    s_waitcnt lgkmcnt(10)
    s_add_u32 m0, s74, 16896
    v_mfma_f32_16x16x32_bf16 v[32:35], v[148:151], a[152:155], v[32:35]
    ds_read_b64_tr_b16 v[176:177], v7 offset:17184
    ds_read_b64_tr_b16 v[178:179], v7 offset:17696
    v_mfma_f32_16x16x32_bf16 v[36:39], v[148:151], a[156:159], v[36:39]
    buffer_load_dwordx4 v2, s[8:11], s75 offen offset:0 lds
    v_mfma_f32_16x16x32_bf16 v[40:43], v[152:155], a[152:155], v[40:43]
    ds_read_b64_tr_b16 v[148:149], v7 offset:17216
    ds_read_b64_tr_b16 v[150:151], v7 offset:17728
    v_mfma_f32_16x16x32_bf16 v[44:47], v[152:155], a[156:159], v[44:47]
    s_waitcnt lgkmcnt(10)
    v_mfma_f32_16x16x32_bf16 v[48:51], v[156:159], a[152:155], v[48:51]
    ds_read_b64_tr_b16 v[152:153], v7 offset:17248
    ds_read_b64_tr_b16 v[154:155], v7 offset:17760
    v_mfma_f32_16x16x32_bf16 v[52:55], v[156:159], a[156:159], v[52:55]
    buffer_load_dwordx4 v3, s[8:11], s75 offen offset:1056 lds
    v_mfma_f32_16x16x32_bf16 v[56:59], v[160:163], a[152:155], v[56:59]
    ds_read_b64_tr_b16 v[156:157], v7 offset:17280
    ds_read_b64_tr_b16 v[158:159], v7 offset:17792
    v_mfma_f32_16x16x32_bf16 v[60:63], v[160:163], a[156:159], v[60:63]
    s_waitcnt lgkmcnt(10)
    v_mfma_f32_16x16x32_bf16 v[64:67], v[164:167], a[152:155], v[64:67]
    ds_read_b64_tr_b16 v[160:161], v7 offset:17312
    ds_read_b64_tr_b16 v[162:163], v7 offset:17824
    v_mfma_f32_16x16x32_bf16 v[68:71], v[164:167], a[156:159], v[68:71]
    s_waitcnt vmcnt(9)
    s_barrier
    v_mfma_f32_16x16x32_bf16 v[72:75], v[168:171], a[152:155], v[72:75]
    ds_read_b64_tr_b16 v[164:165], v7 offset:33792
    ds_read_b64_tr_b16 v[166:167], v7 offset:34304
    v_mfma_f32_16x16x32_bf16 v[76:79], v[168:171], a[156:159], v[76:79]
    s_waitcnt lgkmcnt(10)
    v_mfma_f32_16x16x32_bf16 v[80:83], v[172:175], a[152:155], v[80:83]
    ds_read_b64_tr_b16 v[168:169], v7 offset:33824
    ds_read_b64_tr_b16 v[170:171], v7 offset:34336
    v_mfma_f32_16x16x32_bf16 v[84:87], v[172:175], a[156:159], v[84:87]
    buffer_load_dwordx4 a[140:143], v250, s[12:15], s43 offen offset:1024 sc1
    v_mfma_f32_16x16x32_bf16 v[88:91], v[176:179], a[152:155], v[88:91]
    ds_read_b64_tr_b16 v[172:173], v7 offset:33856
    ds_read_b64_tr_b16 v[174:175], v7 offset:34368
    v_mfma_f32_16x16x32_bf16 v[92:95], v[176:179], a[156:159], v[92:95]
    s_waitcnt lgkmcnt(10)
    v_mfma_f32_16x16x32_bf16 v[96:99], v[148:151], a[152:155], v[96:99]
    ds_read_b64_tr_b16 v[176:177], v7 offset:33888
    ds_read_b64_tr_b16 v[178:179], v7 offset:34400
    v_mfma_f32_16x16x32_bf16 v[100:103], v[148:151], a[156:159], v[100:103]
    buffer_load_dwordx4 v4, s[8:11], s75 offen offset:2112 lds
    v_mfma_f32_16x16x32_bf16 v[104:107], v[152:155], a[152:155], v[104:107]
    ds_read_b64_tr_b16 v[148:149], v7 offset:33920
    ds_read_b64_tr_b16 v[150:151], v7 offset:34432
    v_mfma_f32_16x16x32_bf16 v[108:111], v[152:155], a[156:159], v[108:111]
    s_waitcnt lgkmcnt(10)
    v_mfma_f32_16x16x32_bf16 v[112:115], v[156:159], a[152:155], v[112:115]
    ds_read_b64_tr_b16 v[152:153], v7 offset:33952
    ds_read_b64_tr_b16 v[154:155], v7 offset:34464
    v_mfma_f32_16x16x32_bf16 v[116:119], v[156:159], a[156:159], v[116:119]
    buffer_load_dwordx4 v5, s[8:11], s75 offen offset:3168 lds
    s_add_u32 s75, s75, s66
    v_mfma_f32_16x16x32_bf16 v[120:123], v[160:163], a[152:155], v[120:123]
    ds_read_b64_tr_b16 v[156:157], v7 offset:33984
    ds_read_b64_tr_b16 v[158:159], v7 offset:34496
    v_mfma_f32_16x16x32_bf16 v[124:127], v[160:163], a[156:159], v[124:127]
    s_waitcnt lgkmcnt(10)
    v_mfma_f32_16x16x32_bf16 v[16:19], v[164:167], a[112:115], v[16:19]
    ds_read_b64_tr_b16 v[160:161], v7 offset:34016
    ds_read_b64_tr_b16 v[162:163], v7 offset:34528
    v_mfma_f32_16x16x32_bf16 v[20:23], v[164:167], a[116:119], v[20:23]
    buffer_load_dwordx4 a[144:147], v250, s[12:15], s38 offen offset:2048 sc1
    v_mfma_f32_16x16x32_bf16 v[24:27], v[168:171], a[112:115], v[24:27]
    ds_read_b64_tr_b16 v[164:165], v7 offset:34048
    ds_read_b64_tr_b16 v[166:167], v7 offset:34560
    v_mfma_f32_16x16x32_bf16 v[28:31], v[168:171], a[116:119], v[28:31]
    s_waitcnt lgkmcnt(10)
    s_add_u32 m0, s74, 33792
    v_mfma_f32_16x16x32_bf16 v[32:35], v[172:175], a[112:115], v[32:35]
    ds_read_b64_tr_b16 v[168:169], v7 offset:34080
    ds_read_b64_tr_b16 v[170:171], v7 offset:34592
    v_mfma_f32_16x16x32_bf16 v[36:39], v[172:175], a[116:119], v[36:39]
    buffer_load_dwordx4 v2, s[8:11], s75 offen offset:0 lds
    v_mfma_f32_16x16x32_bf16 v[40:43], v[176:179], a[112:115], v[40:43]
    ds_read_b64_tr_b16 v[172:173], v7 offset:34112
    ds_read_b64_tr_b16 v[174:175], v7 offset:34624
    v_mfma_f32_16x16x32_bf16 v[44:47], v[176:179], a[116:119], v[44:47]
    s_waitcnt lgkmcnt(10)
    v_mfma_f32_16x16x32_bf16 v[48:51], v[148:151], a[112:115], v[48:51]
    ds_read_b64_tr_b16 v[176:177], v7 offset:34144
    ds_read_b64_tr_b16 v[178:179], v7 offset:34656
    v_mfma_f32_16x16x32_bf16 v[52:55], v[148:151], a[116:119], v[52:55]
    buffer_load_dwordx4 v3, s[8:11], s75 offen offset:1056 lds
    v_mfma_f32_16x16x32_bf16 v[56:59], v[152:155], a[112:115], v[56:59]
    ds_read_b64_tr_b16 v[148:149], v7 offset:34176
    ds_read_b64_tr_b16 v[150:151], v7 offset:34688
    v_mfma_f32_16x16x32_bf16 v[60:63], v[152:155], a[116:119], v[60:63]
    s_waitcnt lgkmcnt(10)
    v_mfma_f32_16x16x32_bf16 v[64:67], v[156:159], a[112:115], v[64:67]
    ds_read_b64_tr_b16 v[152:153], v7 offset:34208
    ds_read_b64_tr_b16 v[154:155], v7 offset:34720
    v_mfma_f32_16x16x32_bf16 v[68:71], v[156:159], a[116:119], v[68:71]
    buffer_load_dwordx4 a[148:151], v250, s[12:15], s43 offen offset:2048 sc1
    v_mfma_f32_16x16x32_bf16 v[72:75], v[160:163], a[112:115], v[72:75]
    ds_read_b64_tr_b16 v[156:157], v7 offset:50688
    ds_read_b64_tr_b16 v[158:159], v7 offset:51200
    v_mfma_f32_16x16x32_bf16 v[76:79], v[160:163], a[116:119], v[76:79]
    s_waitcnt lgkmcnt(10)
    v_mfma_f32_16x16x32_bf16 v[80:83], v[164:167], a[112:115], v[80:83]
    ds_read_b64_tr_b16 v[160:161], v7 offset:50720
    ds_read_b64_tr_b16 v[162:163], v7 offset:51232
    v_mfma_f32_16x16x32_bf16 v[84:87], v[164:167], a[116:119], v[84:87]
    buffer_load_dwordx4 v4, s[8:11], s75 offen offset:2112 lds
    v_mfma_f32_16x16x32_bf16 v[88:91], v[168:171], a[112:115], v[88:91]
    ds_read_b64_tr_b16 v[164:165], v7 offset:50752
    ds_read_b64_tr_b16 v[166:167], v7 offset:51264
    v_mfma_f32_16x16x32_bf16 v[92:95], v[168:171], a[116:119], v[92:95]
    s_waitcnt lgkmcnt(10)
    v_mfma_f32_16x16x32_bf16 v[96:99], v[172:175], a[112:115], v[96:99]
    ds_read_b64_tr_b16 v[168:169], v7 offset:50784
    ds_read_b64_tr_b16 v[170:171], v7 offset:51296
    v_mfma_f32_16x16x32_bf16 v[100:103], v[172:175], a[116:119], v[100:103]
    buffer_load_dwordx4 v5, s[8:11], s75 offen offset:3168 lds
    v_mfma_f32_16x16x32_bf16 v[104:107], v[176:179], a[112:115], v[104:107]
    ds_read_b64_tr_b16 v[172:173], v7 offset:50816
    ds_read_b64_tr_b16 v[174:175], v7 offset:51328
    v_mfma_f32_16x16x32_bf16 v[108:111], v[176:179], a[116:119], v[108:111]
    s_waitcnt lgkmcnt(10)
    s_add_u32 s75, s75, s66
    v_mfma_f32_16x16x32_bf16 v[112:115], v[148:151], a[112:115], v[112:115]
    ds_read_b64_tr_b16 v[176:177], v7 offset:50848
    ds_read_b64_tr_b16 v[178:179], v7 offset:51360
    v_mfma_f32_16x16x32_bf16 v[116:119], v[148:151], a[116:119], v[116:119]
    v_mfma_f32_16x16x32_bf16 v[120:123], v[152:155], a[112:115], v[120:123]
    ds_read_b64_tr_b16 v[148:149], v7 offset:50880
    ds_read_b64_tr_b16 v[150:151], v7 offset:51392
    v_mfma_f32_16x16x32_bf16 v[124:127], v[152:155], a[116:119], v[124:127]
    s_waitcnt lgkmcnt(10)
    v_mfma_f32_16x16x32_bf16 v[16:19], v[156:159], a[120:123], v[16:19]
    ds_read_b64_tr_b16 v[152:153], v7 offset:50912
    ds_read_b64_tr_b16 v[154:155], v7 offset:51424
    v_mfma_f32_16x16x32_bf16 v[20:23], v[156:159], a[124:127], v[20:23]
    buffer_load_dwordx4 a[152:155], v250, s[12:15], s38 offen offset:3072 sc1
    v_mfma_f32_16x16x32_bf16 v[24:27], v[160:163], a[120:123], v[24:27]
    ds_read_b64_tr_b16 v[156:157], v7 offset:50944
    ds_read_b64_tr_b16 v[158:159], v7 offset:51456
    v_mfma_f32_16x16x32_bf16 v[28:31], v[160:163], a[124:127], v[28:31]
    s_waitcnt lgkmcnt(10)
    s_add_u32 m0, s74, 50688
    v_mfma_f32_16x16x32_bf16 v[32:35], v[164:167], a[120:123], v[32:35]
    ds_read_b64_tr_b16 v[160:161], v7 offset:50976
    ds_read_b64_tr_b16 v[162:163], v7 offset:51488
    v_mfma_f32_16x16x32_bf16 v[36:39], v[164:167], a[124:127], v[36:39]
    buffer_load_dwordx4 v2, s[8:11], s75 offen offset:0 lds
    v_mfma_f32_16x16x32_bf16 v[40:43], v[168:171], a[120:123], v[40:43]
    ds_read_b64_tr_b16 v[164:165], v7 offset:51008
    ds_read_b64_tr_b16 v[166:167], v7 offset:51520
    v_mfma_f32_16x16x32_bf16 v[44:47], v[168:171], a[124:127], v[44:47]
    s_waitcnt lgkmcnt(10)
    v_mfma_f32_16x16x32_bf16 v[48:51], v[172:175], a[120:123], v[48:51]
    ds_read_b64_tr_b16 v[168:169], v7 offset:51040
    ds_read_b64_tr_b16 v[170:171], v7 offset:51552
    v_mfma_f32_16x16x32_bf16 v[52:55], v[172:175], a[124:127], v[52:55]
    buffer_load_dwordx4 v3, s[8:11], s75 offen offset:1056 lds
    v_mfma_f32_16x16x32_bf16 v[56:59], v[176:179], a[120:123], v[56:59]
    ds_read_b64_tr_b16 v[172:173], v7 offset:51072
    ds_read_b64_tr_b16 v[174:175], v7 offset:51584
    v_mfma_f32_16x16x32_bf16 v[60:63], v[176:179], a[124:127], v[60:63]
    s_waitcnt lgkmcnt(10)
    v_mfma_f32_16x16x32_bf16 v[64:67], v[148:151], a[120:123], v[64:67]
    ds_read_b64_tr_b16 v[176:177], v7 offset:51104
    ds_read_b64_tr_b16 v[178:179], v7 offset:51616
    v_mfma_f32_16x16x32_bf16 v[68:71], v[148:151], a[124:127], v[68:71]
    s_waitcnt vmcnt(9)
    s_barrier
    v_mfma_f32_16x16x32_bf16 v[72:75], v[152:155], a[120:123], v[72:75]
    ds_read_b64_tr_b16 v[148:149], v6 offset:0
    ds_read_b64_tr_b16 v[150:151], v6 offset:512
    v_mfma_f32_16x16x32_bf16 v[76:79], v[152:155], a[124:127], v[76:79]
    s_waitcnt lgkmcnt(10)
    v_mfma_f32_16x16x32_bf16 v[80:83], v[156:159], a[120:123], v[80:83]
    ds_read_b64_tr_b16 v[152:153], v6 offset:32
    ds_read_b64_tr_b16 v[154:155], v6 offset:544
    v_mfma_f32_16x16x32_bf16 v[84:87], v[156:159], a[124:127], v[84:87]
    buffer_load_dwordx4 a[156:159], v250, s[12:15], s43 offen offset:3072 sc1
    v_mfma_f32_16x16x32_bf16 v[88:91], v[160:163], a[120:123], v[88:91]
    ds_read_b64_tr_b16 v[156:157], v6 offset:64
    ds_read_b64_tr_b16 v[158:159], v6 offset:576
    v_mfma_f32_16x16x32_bf16 v[92:95], v[160:163], a[124:127], v[92:95]
    s_waitcnt lgkmcnt(10)
    v_mfma_f32_16x16x32_bf16 v[96:99], v[164:167], a[120:123], v[96:99]
    ds_read_b64_tr_b16 v[160:161], v6 offset:96
    ds_read_b64_tr_b16 v[162:163], v6 offset:608
    v_mfma_f32_16x16x32_bf16 v[100:103], v[164:167], a[124:127], v[100:103]
    buffer_load_dwordx4 v4, s[8:11], s75 offen offset:2112 lds
    v_mfma_f32_16x16x32_bf16 v[104:107], v[168:171], a[120:123], v[104:107]
    ds_read_b64_tr_b16 v[164:165], v6 offset:128
    ds_read_b64_tr_b16 v[166:167], v6 offset:640
    v_mfma_f32_16x16x32_bf16 v[108:111], v[168:171], a[124:127], v[108:111]
    s_waitcnt lgkmcnt(10)
    v_mfma_f32_16x16x32_bf16 v[112:115], v[172:175], a[120:123], v[112:115]
    ds_read_b64_tr_b16 v[168:169], v6 offset:160
    ds_read_b64_tr_b16 v[170:171], v6 offset:672
    v_mfma_f32_16x16x32_bf16 v[116:119], v[172:175], a[124:127], v[116:119]
    buffer_load_dwordx4 v5, s[8:11], s75 offen offset:3168 lds
    s_add_u32 s75, s75, s66
    v_mfma_f32_16x16x32_bf16 v[120:123], v[176:179], a[120:123], v[120:123]
    ds_read_b64_tr_b16 v[172:173], v6 offset:192
    ds_read_b64_tr_b16 v[174:175], v6 offset:704
    v_mfma_f32_16x16x32_bf16 v[124:127], v[176:179], a[124:127], v[124:127]
    s_waitcnt lgkmcnt(10)
    v_mfma_f32_16x16x32_bf16 v[16:19], v[148:151], a[128:131], v[16:19]
    ds_read_b64_tr_b16 v[176:177], v6 offset:224
    ds_read_b64_tr_b16 v[178:179], v6 offset:736
    v_mfma_f32_16x16x32_bf16 v[20:23], v[148:151], a[132:135], v[20:23]
    buffer_load_dwordx4 a[112:115], v250, s[12:15], s39 offen offset:0 sc1
    v_mfma_f32_16x16x32_bf16 v[24:27], v[152:155], a[128:131], v[24:27]
    ds_read_b64_tr_b16 v[148:149], v6 offset:256
    ds_read_b64_tr_b16 v[150:151], v6 offset:768
    v_mfma_f32_16x16x32_bf16 v[28:31], v[152:155], a[132:135], v[28:31]
    s_waitcnt lgkmcnt(10)
    s_add_u32 m0, s74, 67584
    v_mfma_f32_16x16x32_bf16 v[32:35], v[156:159], a[128:131], v[32:35]
    ds_read_b64_tr_b16 v[152:153], v6 offset:288
    ds_read_b64_tr_b16 v[154:155], v6 offset:800
    v_mfma_f32_16x16x32_bf16 v[36:39], v[156:159], a[132:135], v[36:39]
    buffer_load_dwordx4 v2, s[8:11], s75 offen offset:0 lds
    v_mfma_f32_16x16x32_bf16 v[40:43], v[160:163], a[128:131], v[40:43]
    ds_read_b64_tr_b16 v[156:157], v6 offset:320
    ds_read_b64_tr_b16 v[158:159], v6 offset:832
    v_mfma_f32_16x16x32_bf16 v[44:47], v[160:163], a[132:135], v[44:47]
    s_waitcnt lgkmcnt(10)
    v_mfma_f32_16x16x32_bf16 v[48:51], v[164:167], a[128:131], v[48:51]
    ds_read_b64_tr_b16 v[160:161], v6 offset:352
    ds_read_b64_tr_b16 v[162:163], v6 offset:864
    v_mfma_f32_16x16x32_bf16 v[52:55], v[164:167], a[132:135], v[52:55]
    buffer_load_dwordx4 v3, s[8:11], s75 offen offset:1056 lds
    v_mfma_f32_16x16x32_bf16 v[56:59], v[168:171], a[128:131], v[56:59]
    ds_read_b64_tr_b16 v[164:165], v6 offset:384
    ds_read_b64_tr_b16 v[166:167], v6 offset:896
    v_mfma_f32_16x16x32_bf16 v[60:63], v[168:171], a[132:135], v[60:63]
    s_waitcnt lgkmcnt(10)
    v_mfma_f32_16x16x32_bf16 v[64:67], v[172:175], a[128:131], v[64:67]
    ds_read_b64_tr_b16 v[168:169], v6 offset:416
    ds_read_b64_tr_b16 v[170:171], v6 offset:928
    v_mfma_f32_16x16x32_bf16 v[68:71], v[172:175], a[132:135], v[68:71]
    buffer_load_dwordx4 a[116:119], v250, s[12:15], s44 offen offset:0 sc1
    v_mfma_f32_16x16x32_bf16 v[72:75], v[176:179], a[128:131], v[72:75]
    ds_read_b64_tr_b16 v[172:173], v6 offset:16896
    ds_read_b64_tr_b16 v[174:175], v6 offset:17408
    v_mfma_f32_16x16x32_bf16 v[76:79], v[176:179], a[132:135], v[76:79]
    s_waitcnt lgkmcnt(10)
    v_mfma_f32_16x16x32_bf16 v[80:83], v[148:151], a[128:131], v[80:83]
    ds_read_b64_tr_b16 v[176:177], v6 offset:16928
    ds_read_b64_tr_b16 v[178:179], v6 offset:17440
    v_mfma_f32_16x16x32_bf16 v[84:87], v[148:151], a[132:135], v[84:87]
    buffer_load_dwordx4 v4, s[8:11], s75 offen offset:2112 lds
    v_mfma_f32_16x16x32_bf16 v[88:91], v[152:155], a[128:131], v[88:91]
    ds_read_b64_tr_b16 v[148:149], v6 offset:16960
    ds_read_b64_tr_b16 v[150:151], v6 offset:17472
    v_mfma_f32_16x16x32_bf16 v[92:95], v[152:155], a[132:135], v[92:95]
    s_waitcnt lgkmcnt(10)
    v_mfma_f32_16x16x32_bf16 v[96:99], v[156:159], a[128:131], v[96:99]
    ds_read_b64_tr_b16 v[152:153], v6 offset:16992
    ds_read_b64_tr_b16 v[154:155], v6 offset:17504
    v_mfma_f32_16x16x32_bf16 v[100:103], v[156:159], a[132:135], v[100:103]
    buffer_load_dwordx4 v5, s[8:11], s75 offen offset:3168 lds
    v_mfma_f32_16x16x32_bf16 v[104:107], v[160:163], a[128:131], v[104:107]
    ds_read_b64_tr_b16 v[156:157], v6 offset:17024
    ds_read_b64_tr_b16 v[158:159], v6 offset:17536
    v_mfma_f32_16x16x32_bf16 v[108:111], v[160:163], a[132:135], v[108:111]
    s_waitcnt lgkmcnt(10)
    s_add_u32 s75, s75, s66
    v_mfma_f32_16x16x32_bf16 v[112:115], v[164:167], a[128:131], v[112:115]
    ds_read_b64_tr_b16 v[160:161], v6 offset:17056
    ds_read_b64_tr_b16 v[162:163], v6 offset:17568
    v_mfma_f32_16x16x32_bf16 v[116:119], v[164:167], a[132:135], v[116:119]
    v_mfma_f32_16x16x32_bf16 v[120:123], v[168:171], a[128:131], v[120:123]
    ds_read_b64_tr_b16 v[164:165], v6 offset:17088
    ds_read_b64_tr_b16 v[166:167], v6 offset:17600
    v_mfma_f32_16x16x32_bf16 v[124:127], v[168:171], a[132:135], v[124:127]
    s_waitcnt lgkmcnt(10)
    v_mfma_f32_16x16x32_bf16 v[16:19], v[172:175], a[136:139], v[16:19]
    ds_read_b64_tr_b16 v[168:169], v6 offset:17120
    ds_read_b64_tr_b16 v[170:171], v6 offset:17632
    v_mfma_f32_16x16x32_bf16 v[20:23], v[172:175], a[140:143], v[20:23]
    buffer_load_dwordx4 a[120:123], v250, s[12:15], s39 offen offset:1024 sc1
    v_mfma_f32_16x16x32_bf16 v[24:27], v[176:179], a[136:139], v[24:27]
    ds_read_b64_tr_b16 v[172:173], v6 offset:17152
    ds_read_b64_tr_b16 v[174:175], v6 offset:17664
    v_mfma_f32_16x16x32_bf16 v[28:31], v[176:179], a[140:143], v[28:31]
    s_waitcnt lgkmcnt(10)
    s_add_u32 m0, s74, 84480
    v_mfma_f32_16x16x32_bf16 v[32:35], v[148:151], a[136:139], v[32:35]
    ds_read_b64_tr_b16 v[176:177], v6 offset:17184
    ds_read_b64_tr_b16 v[178:179], v6 offset:17696
    v_mfma_f32_16x16x32_bf16 v[36:39], v[148:151], a[140:143], v[36:39]
    buffer_load_dwordx4 v2, s[8:11], s75 offen offset:0 lds
    v_mfma_f32_16x16x32_bf16 v[40:43], v[152:155], a[136:139], v[40:43]
    ds_read_b64_tr_b16 v[148:149], v6 offset:17216
    ds_read_b64_tr_b16 v[150:151], v6 offset:17728
    v_mfma_f32_16x16x32_bf16 v[44:47], v[152:155], a[140:143], v[44:47]
    s_waitcnt lgkmcnt(10)
    v_mfma_f32_16x16x32_bf16 v[48:51], v[156:159], a[136:139], v[48:51]
    ds_read_b64_tr_b16 v[152:153], v6 offset:17248
    ds_read_b64_tr_b16 v[154:155], v6 offset:17760
    v_mfma_f32_16x16x32_bf16 v[52:55], v[156:159], a[140:143], v[52:55]
    buffer_load_dwordx4 v3, s[8:11], s75 offen offset:1056 lds
    v_mfma_f32_16x16x32_bf16 v[56:59], v[160:163], a[136:139], v[56:59]
    ds_read_b64_tr_b16 v[156:157], v6 offset:17280
    ds_read_b64_tr_b16 v[158:159], v6 offset:17792
    v_mfma_f32_16x16x32_bf16 v[60:63], v[160:163], a[140:143], v[60:63]
    s_waitcnt lgkmcnt(10)
    v_mfma_f32_16x16x32_bf16 v[64:67], v[164:167], a[136:139], v[64:67]
    ds_read_b64_tr_b16 v[160:161], v6 offset:17312
    ds_read_b64_tr_b16 v[162:163], v6 offset:17824
    v_mfma_f32_16x16x32_bf16 v[68:71], v[164:167], a[140:143], v[68:71]
    s_waitcnt vmcnt(9)
    s_barrier
    v_mfma_f32_16x16x32_bf16 v[72:75], v[168:171], a[136:139], v[72:75]
    ds_read_b64_tr_b16 v[164:165], v6 offset:33792
    ds_read_b64_tr_b16 v[166:167], v6 offset:34304
    v_mfma_f32_16x16x32_bf16 v[76:79], v[168:171], a[140:143], v[76:79]
    s_waitcnt lgkmcnt(10)
    v_mfma_f32_16x16x32_bf16 v[80:83], v[172:175], a[136:139], v[80:83]
    ds_read_b64_tr_b16 v[168:169], v6 offset:33824
    ds_read_b64_tr_b16 v[170:171], v6 offset:34336
    v_mfma_f32_16x16x32_bf16 v[84:87], v[172:175], a[140:143], v[84:87]
    buffer_load_dwordx4 a[124:127], v250, s[12:15], s44 offen offset:1024 sc1
    v_mfma_f32_16x16x32_bf16 v[88:91], v[176:179], a[136:139], v[88:91]
    ds_read_b64_tr_b16 v[172:173], v6 offset:33856
    ds_read_b64_tr_b16 v[174:175], v6 offset:34368
    v_mfma_f32_16x16x32_bf16 v[92:95], v[176:179], a[140:143], v[92:95]
    s_waitcnt lgkmcnt(10)
    v_mfma_f32_16x16x32_bf16 v[96:99], v[148:151], a[136:139], v[96:99]
    ds_read_b64_tr_b16 v[176:177], v6 offset:33888
    ds_read_b64_tr_b16 v[178:179], v6 offset:34400
    v_mfma_f32_16x16x32_bf16 v[100:103], v[148:151], a[140:143], v[100:103]
    buffer_load_dwordx4 v4, s[8:11], s75 offen offset:2112 lds
    v_mfma_f32_16x16x32_bf16 v[104:107], v[152:155], a[136:139], v[104:107]
    ds_read_b64_tr_b16 v[148:149], v6 offset:33920
    ds_read_b64_tr_b16 v[150:151], v6 offset:34432
    v_mfma_f32_16x16x32_bf16 v[108:111], v[152:155], a[140:143], v[108:111]
    s_waitcnt lgkmcnt(10)
    v_mfma_f32_16x16x32_bf16 v[112:115], v[156:159], a[136:139], v[112:115]
    ds_read_b64_tr_b16 v[152:153], v6 offset:33952
    ds_read_b64_tr_b16 v[154:155], v6 offset:34464
    v_mfma_f32_16x16x32_bf16 v[116:119], v[156:159], a[140:143], v[116:119]
    buffer_load_dwordx4 v5, s[8:11], s75 offen offset:3168 lds
    s_add_u32 s75, s75, s66
    v_mfma_f32_16x16x32_bf16 v[120:123], v[160:163], a[136:139], v[120:123]
    ds_read_b64_tr_b16 v[156:157], v6 offset:33984
    ds_read_b64_tr_b16 v[158:159], v6 offset:34496
    v_mfma_f32_16x16x32_bf16 v[124:127], v[160:163], a[140:143], v[124:127]
    s_waitcnt lgkmcnt(10)
    v_mfma_f32_16x16x32_bf16 v[16:19], v[164:167], a[144:147], v[16:19]
    ds_read_b64_tr_b16 v[160:161], v6 offset:34016
    ds_read_b64_tr_b16 v[162:163], v6 offset:34528
    v_mfma_f32_16x16x32_bf16 v[20:23], v[164:167], a[148:151], v[20:23]
    buffer_load_dwordx4 a[128:131], v250, s[12:15], s39 offen offset:2048 sc1
    v_mfma_f32_16x16x32_bf16 v[24:27], v[168:171], a[144:147], v[24:27]
    ds_read_b64_tr_b16 v[164:165], v6 offset:34048
    ds_read_b64_tr_b16 v[166:167], v6 offset:34560
    v_mfma_f32_16x16x32_bf16 v[28:31], v[168:171], a[148:151], v[28:31]
    s_waitcnt lgkmcnt(10)
    s_add_u32 m0, s74, 101376
    v_mfma_f32_16x16x32_bf16 v[32:35], v[172:175], a[144:147], v[32:35]
    ds_read_b64_tr_b16 v[168:169], v6 offset:34080
    ds_read_b64_tr_b16 v[170:171], v6 offset:34592
    v_mfma_f32_16x16x32_bf16 v[36:39], v[172:175], a[148:151], v[36:39]
    buffer_load_dwordx4 v2, s[8:11], s75 offen offset:0 lds
    v_mfma_f32_16x16x32_bf16 v[40:43], v[176:179], a[144:147], v[40:43]
    ds_read_b64_tr_b16 v[172:173], v6 offset:34112
    ds_read_b64_tr_b16 v[174:175], v6 offset:34624
    v_mfma_f32_16x16x32_bf16 v[44:47], v[176:179], a[148:151], v[44:47]
    s_waitcnt lgkmcnt(10)
    v_mfma_f32_16x16x32_bf16 v[48:51], v[148:151], a[144:147], v[48:51]
    ds_read_b64_tr_b16 v[176:177], v6 offset:34144
    ds_read_b64_tr_b16 v[178:179], v6 offset:34656
    v_mfma_f32_16x16x32_bf16 v[52:55], v[148:151], a[148:151], v[52:55]
    buffer_load_dwordx4 v3, s[8:11], s75 offen offset:1056 lds
    v_mfma_f32_16x16x32_bf16 v[56:59], v[152:155], a[144:147], v[56:59]
    ds_read_b64_tr_b16 v[148:149], v6 offset:34176
    ds_read_b64_tr_b16 v[150:151], v6 offset:34688
    v_mfma_f32_16x16x32_bf16 v[60:63], v[152:155], a[148:151], v[60:63]
    s_waitcnt lgkmcnt(10)
    v_mfma_f32_16x16x32_bf16 v[64:67], v[156:159], a[144:147], v[64:67]
    ds_read_b64_tr_b16 v[152:153], v6 offset:34208
    ds_read_b64_tr_b16 v[154:155], v6 offset:34720
    v_mfma_f32_16x16x32_bf16 v[68:71], v[156:159], a[148:151], v[68:71]
    buffer_load_dwordx4 a[132:135], v250, s[12:15], s44 offen offset:2048 sc1
    v_mfma_f32_16x16x32_bf16 v[72:75], v[160:163], a[144:147], v[72:75]
    ds_read_b64_tr_b16 v[156:157], v6 offset:50688
    ds_read_b64_tr_b16 v[158:159], v6 offset:51200
    v_mfma_f32_16x16x32_bf16 v[76:79], v[160:163], a[148:151], v[76:79]
    s_waitcnt lgkmcnt(10)
    v_mfma_f32_16x16x32_bf16 v[80:83], v[164:167], a[144:147], v[80:83]
    ds_read_b64_tr_b16 v[160:161], v6 offset:50720
    ds_read_b64_tr_b16 v[162:163], v6 offset:51232
    v_mfma_f32_16x16x32_bf16 v[84:87], v[164:167], a[148:151], v[84:87]
    buffer_load_dwordx4 v4, s[8:11], s75 offen offset:2112 lds
    v_mfma_f32_16x16x32_bf16 v[88:91], v[168:171], a[144:147], v[88:91]
    ds_read_b64_tr_b16 v[164:165], v6 offset:50752
    ds_read_b64_tr_b16 v[166:167], v6 offset:51264
    v_mfma_f32_16x16x32_bf16 v[92:95], v[168:171], a[148:151], v[92:95]
    s_waitcnt lgkmcnt(10)
    v_mfma_f32_16x16x32_bf16 v[96:99], v[172:175], a[144:147], v[96:99]
    ds_read_b64_tr_b16 v[168:169], v6 offset:50784
    ds_read_b64_tr_b16 v[170:171], v6 offset:51296
    v_mfma_f32_16x16x32_bf16 v[100:103], v[172:175], a[148:151], v[100:103]
    buffer_load_dwordx4 v5, s[8:11], s75 offen offset:3168 lds
    v_mfma_f32_16x16x32_bf16 v[104:107], v[176:179], a[144:147], v[104:107]
    ds_read_b64_tr_b16 v[172:173], v6 offset:50816
    ds_read_b64_tr_b16 v[174:175], v6 offset:51328
    v_mfma_f32_16x16x32_bf16 v[108:111], v[176:179], a[148:151], v[108:111]
    s_waitcnt lgkmcnt(10)
    s_add_u32 s75, s75, s66
    v_mfma_f32_16x16x32_bf16 v[112:115], v[148:151], a[144:147], v[112:115]
    ds_read_b64_tr_b16 v[176:177], v6 offset:50848
    ds_read_b64_tr_b16 v[178:179], v6 offset:51360
    v_mfma_f32_16x16x32_bf16 v[116:119], v[148:151], a[148:151], v[116:119]
    v_mfma_f32_16x16x32_bf16 v[120:123], v[152:155], a[144:147], v[120:123]
    ds_read_b64_tr_b16 v[148:149], v6 offset:50880
    ds_read_b64_tr_b16 v[150:151], v6 offset:51392
    v_mfma_f32_16x16x32_bf16 v[124:127], v[152:155], a[148:151], v[124:127]
    s_waitcnt lgkmcnt(10)
    v_mfma_f32_16x16x32_bf16 v[16:19], v[156:159], a[152:155], v[16:19]
    ds_read_b64_tr_b16 v[152:153], v6 offset:50912
    ds_read_b64_tr_b16 v[154:155], v6 offset:51424
    v_mfma_f32_16x16x32_bf16 v[20:23], v[156:159], a[156:159], v[20:23]
    buffer_load_dwordx4 a[136:139], v250, s[12:15], s39 offen offset:3072 sc1
    v_mfma_f32_16x16x32_bf16 v[24:27], v[160:163], a[152:155], v[24:27]
    ds_read_b64_tr_b16 v[156:157], v6 offset:50944
    ds_read_b64_tr_b16 v[158:159], v6 offset:51456
    v_mfma_f32_16x16x32_bf16 v[28:31], v[160:163], a[156:159], v[28:31]
    s_waitcnt lgkmcnt(10)
    s_add_u32 m0, s74, 118272
    v_mfma_f32_16x16x32_bf16 v[32:35], v[164:167], a[152:155], v[32:35]
    ds_read_b64_tr_b16 v[160:161], v6 offset:50976
    ds_read_b64_tr_b16 v[162:163], v6 offset:51488
    v_mfma_f32_16x16x32_bf16 v[36:39], v[164:167], a[156:159], v[36:39]
    buffer_load_dwordx4 v2, s[8:11], s75 offen offset:0 lds
    v_mfma_f32_16x16x32_bf16 v[40:43], v[168:171], a[152:155], v[40:43]
    ds_read_b64_tr_b16 v[164:165], v6 offset:51008
    ds_read_b64_tr_b16 v[166:167], v6 offset:51520
    v_mfma_f32_16x16x32_bf16 v[44:47], v[168:171], a[156:159], v[44:47]
    s_waitcnt lgkmcnt(10)
    v_mfma_f32_16x16x32_bf16 v[48:51], v[172:175], a[152:155], v[48:51]
    ds_read_b64_tr_b16 v[168:169], v6 offset:51040
    ds_read_b64_tr_b16 v[170:171], v6 offset:51552
    v_mfma_f32_16x16x32_bf16 v[52:55], v[172:175], a[156:159], v[52:55]
    buffer_load_dwordx4 v3, s[8:11], s75 offen offset:1056 lds
    v_mfma_f32_16x16x32_bf16 v[56:59], v[176:179], a[152:155], v[56:59]
    ds_read_b64_tr_b16 v[172:173], v6 offset:51072
    ds_read_b64_tr_b16 v[174:175], v6 offset:51584
    v_mfma_f32_16x16x32_bf16 v[60:63], v[176:179], a[156:159], v[60:63]
    s_waitcnt lgkmcnt(10)
    v_mfma_f32_16x16x32_bf16 v[64:67], v[148:151], a[152:155], v[64:67]
    ds_read_b64_tr_b16 v[176:177], v6 offset:51104
    ds_read_b64_tr_b16 v[178:179], v6 offset:51616
    v_mfma_f32_16x16x32_bf16 v[68:71], v[148:151], a[156:159], v[68:71]
    s_waitcnt vmcnt(9)
    s_barrier
    v_mfma_f32_16x16x32_bf16 v[72:75], v[152:155], a[152:155], v[72:75]
    ds_read_b64_tr_b16 v[148:149], v7 offset:0
    ds_read_b64_tr_b16 v[150:151], v7 offset:512
    v_mfma_f32_16x16x32_bf16 v[76:79], v[152:155], a[156:159], v[76:79]
    s_waitcnt lgkmcnt(10)
    v_mfma_f32_16x16x32_bf16 v[80:83], v[156:159], a[152:155], v[80:83]
    ds_read_b64_tr_b16 v[152:153], v7 offset:32
    ds_read_b64_tr_b16 v[154:155], v7 offset:544
    v_mfma_f32_16x16x32_bf16 v[84:87], v[156:159], a[156:159], v[84:87]
    buffer_load_dwordx4 a[140:143], v250, s[12:15], s44 offen offset:3072 sc1
    v_mfma_f32_16x16x32_bf16 v[88:91], v[160:163], a[152:155], v[88:91]
    ds_read_b64_tr_b16 v[156:157], v7 offset:64
    ds_read_b64_tr_b16 v[158:159], v7 offset:576
    v_mfma_f32_16x16x32_bf16 v[92:95], v[160:163], a[156:159], v[92:95]
    s_waitcnt lgkmcnt(10)
    v_mfma_f32_16x16x32_bf16 v[96:99], v[164:167], a[152:155], v[96:99]
    ds_read_b64_tr_b16 v[160:161], v7 offset:96
    ds_read_b64_tr_b16 v[162:163], v7 offset:608
    v_mfma_f32_16x16x32_bf16 v[100:103], v[164:167], a[156:159], v[100:103]
    buffer_load_dwordx4 v4, s[8:11], s75 offen offset:2112 lds
    v_mfma_f32_16x16x32_bf16 v[104:107], v[168:171], a[152:155], v[104:107]
    ds_read_b64_tr_b16 v[164:165], v7 offset:128
    ds_read_b64_tr_b16 v[166:167], v7 offset:640
    v_mfma_f32_16x16x32_bf16 v[108:111], v[168:171], a[156:159], v[108:111]
    s_waitcnt lgkmcnt(10)
    v_mfma_f32_16x16x32_bf16 v[112:115], v[172:175], a[152:155], v[112:115]
    ds_read_b64_tr_b16 v[168:169], v7 offset:160
    ds_read_b64_tr_b16 v[170:171], v7 offset:672
    v_mfma_f32_16x16x32_bf16 v[116:119], v[172:175], a[156:159], v[116:119]
    buffer_load_dwordx4 v5, s[8:11], s75 offen offset:3168 lds
    s_add_u32 s75, s75, s66
    buffer_load_dwordx4 v[252:255], v12, s[12:15], 0 offen sc1
    v_mfma_f32_16x16x32_bf16 v[120:123], v[176:179], a[152:155], v[120:123]
    ds_read_b64_tr_b16 v[172:173], v7 offset:192
    ds_read_b64_tr_b16 v[174:175], v7 offset:704
    v_mfma_f32_16x16x32_bf16 v[124:127], v[176:179], a[156:159], v[124:127]
    s_waitcnt lgkmcnt(10)
    v_mfma_f32_16x16x32_bf16 v[16:19], v[148:151], a[112:115], v[16:19]
    ds_read_b64_tr_b16 v[176:177], v7 offset:224
    ds_read_b64_tr_b16 v[178:179], v7 offset:736
    v_mfma_f32_16x16x32_bf16 v[20:23], v[148:151], a[116:119], v[20:23]
    buffer_load_dwordx4 a[144:147], v250, s[12:15], s40 offen offset:0 sc1
    v_mfma_f32_16x16x32_bf16 v[24:27], v[152:155], a[112:115], v[24:27]
    ds_read_b64_tr_b16 v[148:149], v7 offset:256
    ds_read_b64_tr_b16 v[150:151], v7 offset:768
    v_mfma_f32_16x16x32_bf16 v[28:31], v[152:155], a[116:119], v[28:31]
    s_waitcnt lgkmcnt(10)
    s_add_u32 m0, s74, 0
    v_mfma_f32_16x16x32_bf16 v[32:35], v[156:159], a[112:115], v[32:35]
    ds_read_b64_tr_b16 v[152:153], v7 offset:288
    ds_read_b64_tr_b16 v[154:155], v7 offset:800
    v_mfma_f32_16x16x32_bf16 v[36:39], v[156:159], a[116:119], v[36:39]
    buffer_load_dwordx4 v2, s[8:11], s75 offen offset:0 lds
    v_mfma_f32_16x16x32_bf16 v[40:43], v[160:163], a[112:115], v[40:43]
    ds_read_b64_tr_b16 v[156:157], v7 offset:320
    ds_read_b64_tr_b16 v[158:159], v7 offset:832
    v_mfma_f32_16x16x32_bf16 v[44:47], v[160:163], a[116:119], v[44:47]
    s_waitcnt lgkmcnt(10)
    v_mfma_f32_16x16x32_bf16 v[48:51], v[164:167], a[112:115], v[48:51]
    ds_read_b64_tr_b16 v[160:161], v7 offset:352
    ds_read_b64_tr_b16 v[162:163], v7 offset:864
    v_mfma_f32_16x16x32_bf16 v[52:55], v[164:167], a[116:119], v[52:55]
    buffer_load_dwordx4 v3, s[8:11], s75 offen offset:1056 lds
    v_mfma_f32_16x16x32_bf16 v[56:59], v[168:171], a[112:115], v[56:59]
    ds_read_b64_tr_b16 v[164:165], v7 offset:384
    ds_read_b64_tr_b16 v[166:167], v7 offset:896
    v_mfma_f32_16x16x32_bf16 v[60:63], v[168:171], a[116:119], v[60:63]
    s_waitcnt lgkmcnt(10)
    v_mfma_f32_16x16x32_bf16 v[64:67], v[172:175], a[112:115], v[64:67]
    ds_read_b64_tr_b16 v[168:169], v7 offset:416
    ds_read_b64_tr_b16 v[170:171], v7 offset:928
    v_mfma_f32_16x16x32_bf16 v[68:71], v[172:175], a[116:119], v[68:71]
    buffer_load_dwordx4 a[148:151], v250, s[12:15], s45 offen offset:0 sc1
    v_mfma_f32_16x16x32_bf16 v[72:75], v[176:179], a[112:115], v[72:75]
    ds_read_b64_tr_b16 v[172:173], v7 offset:16896
    ds_read_b64_tr_b16 v[174:175], v7 offset:17408
    v_mfma_f32_16x16x32_bf16 v[76:79], v[176:179], a[116:119], v[76:79]
    s_waitcnt lgkmcnt(10)
    v_mfma_f32_16x16x32_bf16 v[80:83], v[148:151], a[112:115], v[80:83]
    ds_read_b64_tr_b16 v[176:177], v7 offset:16928
    ds_read_b64_tr_b16 v[178:179], v7 offset:17440
    v_mfma_f32_16x16x32_bf16 v[84:87], v[148:151], a[116:119], v[84:87]
    buffer_load_dwordx4 v4, s[8:11], s75 offen offset:2112 lds
    v_mfma_f32_16x16x32_bf16 v[88:91], v[152:155], a[112:115], v[88:91]
    ds_read_b64_tr_b16 v[148:149], v7 offset:16960
    ds_read_b64_tr_b16 v[150:151], v7 offset:17472
    v_mfma_f32_16x16x32_bf16 v[92:95], v[152:155], a[116:119], v[92:95]
    s_waitcnt lgkmcnt(10)
    v_mfma_f32_16x16x32_bf16 v[96:99], v[156:159], a[112:115], v[96:99]
    ds_read_b64_tr_b16 v[152:153], v7 offset:16992
    ds_read_b64_tr_b16 v[154:155], v7 offset:17504
    v_mfma_f32_16x16x32_bf16 v[100:103], v[156:159], a[116:119], v[100:103]
    buffer_load_dwordx4 v5, s[8:11], s75 offen offset:3168 lds
    v_mfma_f32_16x16x32_bf16 v[104:107], v[160:163], a[112:115], v[104:107]
    ds_read_b64_tr_b16 v[156:157], v7 offset:17024
    ds_read_b64_tr_b16 v[158:159], v7 offset:17536
    v_mfma_f32_16x16x32_bf16 v[108:111], v[160:163], a[116:119], v[108:111]
    s_waitcnt lgkmcnt(10)
    s_add_u32 s75, s75, s66
    v_mfma_f32_16x16x32_bf16 v[112:115], v[164:167], a[112:115], v[112:115]
    ds_read_b64_tr_b16 v[160:161], v7 offset:17056
    ds_read_b64_tr_b16 v[162:163], v7 offset:17568
    v_mfma_f32_16x16x32_bf16 v[116:119], v[164:167], a[116:119], v[116:119]
    v_mfma_f32_16x16x32_bf16 v[120:123], v[168:171], a[112:115], v[120:123]
    ds_read_b64_tr_b16 v[164:165], v7 offset:17088
    ds_read_b64_tr_b16 v[166:167], v7 offset:17600
    v_mfma_f32_16x16x32_bf16 v[124:127], v[168:171], a[116:119], v[124:127]
    s_waitcnt lgkmcnt(10)
    v_mfma_f32_16x16x32_bf16 v[16:19], v[172:175], a[120:123], v[16:19]
    ds_read_b64_tr_b16 v[168:169], v7 offset:17120
    ds_read_b64_tr_b16 v[170:171], v7 offset:17632
    v_mfma_f32_16x16x32_bf16 v[20:23], v[172:175], a[124:127], v[20:23]
    buffer_load_dwordx4 a[152:155], v250, s[12:15], s40 offen offset:1024 sc1
    v_mfma_f32_16x16x32_bf16 v[24:27], v[176:179], a[120:123], v[24:27]
    ds_read_b64_tr_b16 v[172:173], v7 offset:17152
    ds_read_b64_tr_b16 v[174:175], v7 offset:17664
    v_mfma_f32_16x16x32_bf16 v[28:31], v[176:179], a[124:127], v[28:31]
    s_waitcnt lgkmcnt(10)
    s_add_u32 m0, s74, 16896
    v_mfma_f32_16x16x32_bf16 v[32:35], v[148:151], a[120:123], v[32:35]
    ds_read_b64_tr_b16 v[176:177], v7 offset:17184
    ds_read_b64_tr_b16 v[178:179], v7 offset:17696
    v_mfma_f32_16x16x32_bf16 v[36:39], v[148:151], a[124:127], v[36:39]
    buffer_load_dwordx4 v2, s[8:11], s75 offen offset:0 lds
    v_mfma_f32_16x16x32_bf16 v[40:43], v[152:155], a[120:123], v[40:43]
    ds_read_b64_tr_b16 v[148:149], v7 offset:17216
    ds_read_b64_tr_b16 v[150:151], v7 offset:17728
    v_mfma_f32_16x16x32_bf16 v[44:47], v[152:155], a[124:127], v[44:47]
    s_waitcnt lgkmcnt(10)
    v_mfma_f32_16x16x32_bf16 v[48:51], v[156:159], a[120:123], v[48:51]
    ds_read_b64_tr_b16 v[152:153], v7 offset:17248
    ds_read_b64_tr_b16 v[154:155], v7 offset:17760
    v_mfma_f32_16x16x32_bf16 v[52:55], v[156:159], a[124:127], v[52:55]
    buffer_load_dwordx4 v3, s[8:11], s75 offen offset:1056 lds
    v_mfma_f32_16x16x32_bf16 v[56:59], v[160:163], a[120:123], v[56:59]
    ds_read_b64_tr_b16 v[156:157], v7 offset:17280
    ds_read_b64_tr_b16 v[158:159], v7 offset:17792
    v_mfma_f32_16x16x32_bf16 v[60:63], v[160:163], a[124:127], v[60:63]
    s_waitcnt lgkmcnt(10)
    v_mfma_f32_16x16x32_bf16 v[64:67], v[164:167], a[120:123], v[64:67]
    ds_read_b64_tr_b16 v[160:161], v7 offset:17312
    ds_read_b64_tr_b16 v[162:163], v7 offset:17824
    v_mfma_f32_16x16x32_bf16 v[68:71], v[164:167], a[124:127], v[68:71]
    s_waitcnt vmcnt(10)
    s_waitcnt vmcnt(9)
    s_cmp_eq_u32 s60, 0
    s_cbranch_scc0 L_wtw_12
    v_xor_b32 v252, s79, v252
    v_xor_b32 v253, s79, v253
    v_xor_b32 v254, s79, v254
    v_xor_b32 v255, s79, v255
    v_or3_b32 v252, v252, v253, v254
    v_or_b32 v252, v252, v255
    v_cmp_ne_u32 vcc, 0, v252
    s_mov_b32 s78, 0
    s_nop 3
    s_cbranch_vccz L_polled_wt_14
L_poll_wt_13:
    s_sleep 8
    buffer_load_dwordx4 v[252:255], v12, s[12:15], 0 offen sc1
    s_waitcnt vmcnt(0)
    v_xor_b32 v252, s79, v252
    v_xor_b32 v253, s79, v253
    v_xor_b32 v254, s79, v254
    v_xor_b32 v255, s79, v255
    v_or3_b32 v252, v252, v253, v254
    v_or_b32 v252, v252, v255
    v_cmp_ne_u32 vcc, 0, v252
    s_add_u32 s78, s78, 1
    s_nop 3
    s_cbranch_vccz L_polled_wt_14
    s_cmp_lt_u32 s78, 0x40000
    s_cbranch_scc1 L_poll_wt_13
L_polled_wt_14:
L_wtw_12:
    s_barrier
    v_mfma_f32_16x16x32_bf16 v[72:75], v[168:171], a[120:123], v[72:75]
    ds_read_b64_tr_b16 v[164:165], v7 offset:33792
    ds_read_b64_tr_b16 v[166:167], v7 offset:34304
    v_mfma_f32_16x16x32_bf16 v[76:79], v[168:171], a[124:127], v[76:79]
    s_waitcnt lgkmcnt(10)
    v_mfma_f32_16x16x32_bf16 v[80:83], v[172:175], a[120:123], v[80:83]
    ds_read_b64_tr_b16 v[168:169], v7 offset:33824
    ds_read_b64_tr_b16 v[170:171], v7 offset:34336
    v_mfma_f32_16x16x32_bf16 v[84:87], v[172:175], a[124:127], v[84:87]
    buffer_load_dwordx4 a[156:159], v250, s[12:15], s45 offen offset:1024 sc1
    v_mfma_f32_16x16x32_bf16 v[88:91], v[176:179], a[120:123], v[88:91]
    ds_read_b64_tr_b16 v[172:173], v7 offset:33856
    ds_read_b64_tr_b16 v[174:175], v7 offset:34368
    v_mfma_f32_16x16x32_bf16 v[92:95], v[176:179], a[124:127], v[92:95]
    s_waitcnt lgkmcnt(10)
    v_mfma_f32_16x16x32_bf16 v[96:99], v[148:151], a[120:123], v[96:99]
    ds_read_b64_tr_b16 v[176:177], v7 offset:33888
    ds_read_b64_tr_b16 v[178:179], v7 offset:34400
    v_mfma_f32_16x16x32_bf16 v[100:103], v[148:151], a[124:127], v[100:103]
    buffer_load_dwordx4 v4, s[8:11], s75 offen offset:2112 lds
    v_mfma_f32_16x16x32_bf16 v[104:107], v[152:155], a[120:123], v[104:107]
    ds_read_b64_tr_b16 v[148:149], v7 offset:33920
    ds_read_b64_tr_b16 v[150:151], v7 offset:34432
    v_mfma_f32_16x16x32_bf16 v[108:111], v[152:155], a[124:127], v[108:111]
    s_waitcnt lgkmcnt(10)
    v_mfma_f32_16x16x32_bf16 v[112:115], v[156:159], a[120:123], v[112:115]
    ds_read_b64_tr_b16 v[152:153], v7 offset:33952
    ds_read_b64_tr_b16 v[154:155], v7 offset:34464
    v_mfma_f32_16x16x32_bf16 v[116:119], v[156:159], a[124:127], v[116:119]
    buffer_load_dwordx4 v5, s[8:11], s75 offen offset:3168 lds
    s_add_u32 s75, s75, s66
    v_mfma_f32_16x16x32_bf16 v[120:123], v[160:163], a[120:123], v[120:123]
    ds_read_b64_tr_b16 v[156:157], v7 offset:33984
    ds_read_b64_tr_b16 v[158:159], v7 offset:34496
    v_mfma_f32_16x16x32_bf16 v[124:127], v[160:163], a[124:127], v[124:127]
    s_waitcnt lgkmcnt(10)
    v_mfma_f32_16x16x32_bf16 v[16:19], v[164:167], a[128:131], v[16:19]
    ds_read_b64_tr_b16 v[160:161], v7 offset:34016
    ds_read_b64_tr_b16 v[162:163], v7 offset:34528
    v_mfma_f32_16x16x32_bf16 v[20:23], v[164:167], a[132:135], v[20:23]
    buffer_load_dwordx4 a[112:115], v250, s[12:15], s40 offen offset:2048 sc1
    v_mfma_f32_16x16x32_bf16 v[24:27], v[168:171], a[128:131], v[24:27]
    ds_read_b64_tr_b16 v[164:165], v7 offset:34048
    ds_read_b64_tr_b16 v[166:167], v7 offset:34560
    v_mfma_f32_16x16x32_bf16 v[28:31], v[168:171], a[132:135], v[28:31]
    s_waitcnt lgkmcnt(10)
    s_add_u32 m0, s74, 33792
    v_mfma_f32_16x16x32_bf16 v[32:35], v[172:175], a[128:131], v[32:35]
    ds_read_b64_tr_b16 v[168:169], v7 offset:34080
    ds_read_b64_tr_b16 v[170:171], v7 offset:34592
    v_mfma_f32_16x16x32_bf16 v[36:39], v[172:175], a[132:135], v[36:39]
    buffer_load_dwordx4 v2, s[8:11], s75 offen offset:0 lds
    v_mfma_f32_16x16x32_bf16 v[40:43], v[176:179], a[128:131], v[40:43]
    ds_read_b64_tr_b16 v[172:173], v7 offset:34112
    ds_read_b64_tr_b16 v[174:175], v7 offset:34624
    v_mfma_f32_16x16x32_bf16 v[44:47], v[176:179], a[132:135], v[44:47]
    s_waitcnt lgkmcnt(10)
    v_mfma_f32_16x16x32_bf16 v[48:51], v[148:151], a[128:131], v[48:51]
    ds_read_b64_tr_b16 v[176:177], v7 offset:34144
    ds_read_b64_tr_b16 v[178:179], v7 offset:34656
    v_mfma_f32_16x16x32_bf16 v[52:55], v[148:151], a[132:135], v[52:55]
    buffer_load_dwordx4 v3, s[8:11], s75 offen offset:1056 lds
    v_mfma_f32_16x16x32_bf16 v[56:59], v[152:155], a[128:131], v[56:59]
    ds_read_b64_tr_b16 v[148:149], v7 offset:34176
    ds_read_b64_tr_b16 v[150:151], v7 offset:34688
    v_mfma_f32_16x16x32_bf16 v[60:63], v[152:155], a[132:135], v[60:63]
    s_waitcnt lgkmcnt(10)
    v_mfma_f32_16x16x32_bf16 v[64:67], v[156:159], a[128:131], v[64:67]
    ds_read_b64_tr_b16 v[152:153], v7 offset:34208
    ds_read_b64_tr_b16 v[154:155], v7 offset:34720
    v_mfma_f32_16x16x32_bf16 v[68:71], v[156:159], a[132:135], v[68:71]
    buffer_load_dwordx4 a[116:119], v250, s[12:15], s45 offen offset:2048 sc1
    v_mfma_f32_16x16x32_bf16 v[72:75], v[160:163], a[128:131], v[72:75]
    ds_read_b64_tr_b16 v[156:157], v7 offset:50688
    ds_read_b64_tr_b16 v[158:159], v7 offset:51200
    v_mfma_f32_16x16x32_bf16 v[76:79], v[160:163], a[132:135], v[76:79]
    s_waitcnt lgkmcnt(10)
    v_mfma_f32_16x16x32_bf16 v[80:83], v[164:167], a[128:131], v[80:83]
    ds_read_b64_tr_b16 v[160:161], v7 offset:50720
    ds_read_b64_tr_b16 v[162:163], v7 offset:51232
    v_mfma_f32_16x16x32_bf16 v[84:87], v[164:167], a[132:135], v[84:87]
    buffer_load_dwordx4 v4, s[8:11], s75 offen offset:2112 lds
    v_mfma_f32_16x16x32_bf16 v[88:91], v[168:171], a[128:131], v[88:91]
    ds_read_b64_tr_b16 v[164:165], v7 offset:50752
    ds_read_b64_tr_b16 v[166:167], v7 offset:51264
    v_mfma_f32_16x16x32_bf16 v[92:95], v[168:171], a[132:135], v[92:95]
    s_waitcnt lgkmcnt(10)
    v_mfma_f32_16x16x32_bf16 v[96:99], v[172:175], a[128:131], v[96:99]
    ds_read_b64_tr_b16 v[168:169], v7 offset:50784
    ds_read_b64_tr_b16 v[170:171], v7 offset:51296
    v_mfma_f32_16x16x32_bf16 v[100:103], v[172:175], a[132:135], v[100:103]
    buffer_load_dwordx4 v5, s[8:11], s75 offen offset:3168 lds
    v_mfma_f32_16x16x32_bf16 v[104:107], v[176:179], a[128:131], v[104:107]
    ds_read_b64_tr_b16 v[172:173], v7 offset:50816
    ds_read_b64_tr_b16 v[174:175], v7 offset:51328
    v_mfma_f32_16x16x32_bf16 v[108:111], v[176:179], a[132:135], v[108:111]
    s_waitcnt lgkmcnt(10)
    s_add_u32 s75, s75, s66
    v_mfma_f32_16x16x32_bf16 v[112:115], v[148:151], a[128:131], v[112:115]
    ds_read_b64_tr_b16 v[176:177], v7 offset:50848
    ds_read_b64_tr_b16 v[178:179], v7 offset:51360
    v_mfma_f32_16x16x32_bf16 v[116:119], v[148:151], a[132:135], v[116:119]
    buffer_load_dwordx4 a[160:163], v10, s[12:15], s100 offen offset:0 sc1
    buffer_load_dwordx4 a[164:167], v10, s[12:15], s100 offen offset:1024 sc1
    buffer_load_dwordx4 a[168:171], v10, s[12:15], s100 offen offset:2048 sc1
    v_mfma_f32_16x16x32_bf16 v[120:123], v[152:155], a[128:131], v[120:123]
    ds_read_b64_tr_b16 v[148:149], v7 offset:50880
    ds_read_b64_tr_b16 v[150:151], v7 offset:51392
    v_mfma_f32_16x16x32_bf16 v[124:127], v[152:155], a[132:135], v[124:127]
    s_waitcnt lgkmcnt(10)
    v_mfma_f32_16x16x32_bf16 v[16:19], v[156:159], a[136:139], v[16:19]
    ds_read_b64_tr_b16 v[152:153], v7 offset:50912
    ds_read_b64_tr_b16 v[154:155], v7 offset:51424
    v_mfma_f32_16x16x32_bf16 v[20:23], v[156:159], a[140:143], v[20:23]
    buffer_load_dwordx4 a[120:123], v250, s[12:15], s40 offen offset:3072 sc1
    v_mfma_f32_16x16x32_bf16 v[24:27], v[160:163], a[136:139], v[24:27]
    ds_read_b64_tr_b16 v[156:157], v7 offset:50944
    ds_read_b64_tr_b16 v[158:159], v7 offset:51456
    v_mfma_f32_16x16x32_bf16 v[28:31], v[160:163], a[140:143], v[28:31]
    s_waitcnt lgkmcnt(10)
    s_add_u32 m0, s74, 50688
    v_mfma_f32_16x16x32_bf16 v[32:35], v[164:167], a[136:139], v[32:35]
    ds_read_b64_tr_b16 v[160:161], v7 offset:50976
    ds_read_b64_tr_b16 v[162:163], v7 offset:51488
    v_mfma_f32_16x16x32_bf16 v[36:39], v[164:167], a[140:143], v[36:39]
    buffer_load_dwordx4 v2, s[8:11], s75 offen offset:0 lds
    v_mfma_f32_16x16x32_bf16 v[40:43], v[168:171], a[136:139], v[40:43]
    ds_read_b64_tr_b16 v[164:165], v7 offset:51008
    ds_read_b64_tr_b16 v[166:167], v7 offset:51520
    v_mfma_f32_16x16x32_bf16 v[44:47], v[168:171], a[140:143], v[44:47]
    s_waitcnt lgkmcnt(10)
    v_mfma_f32_16x16x32_bf16 v[48:51], v[172:175], a[136:139], v[48:51]
    ds_read_b64_tr_b16 v[168:169], v7 offset:51040
    ds_read_b64_tr_b16 v[170:171], v7 offset:51552
    v_mfma_f32_16x16x32_bf16 v[52:55], v[172:175], a[140:143], v[52:55]
    buffer_load_dwordx4 v3, s[8:11], s75 offen offset:1056 lds
    v_mfma_f32_16x16x32_bf16 v[56:59], v[176:179], a[136:139], v[56:59]
    ds_read_b64_tr_b16 v[172:173], v7 offset:51072
    ds_read_b64_tr_b16 v[174:175], v7 offset:51584
    v_mfma_f32_16x16x32_bf16 v[60:63], v[176:179], a[140:143], v[60:63]
    s_waitcnt lgkmcnt(10)
    v_mfma_f32_16x16x32_bf16 v[64:67], v[148:151], a[136:139], v[64:67]
    ds_read_b64_tr_b16 v[176:177], v7 offset:51104
    ds_read_b64_tr_b16 v[178:179], v7 offset:51616
    v_mfma_f32_16x16x32_bf16 v[68:71], v[148:151], a[140:143], v[68:71]
    s_waitcnt vmcnt(12)
    s_barrier
    v_mfma_f32_16x16x32_bf16 v[72:75], v[152:155], a[136:139], v[72:75]
    ds_read_b64_tr_b16 v[148:149], v6 offset:0
    ds_read_b64_tr_b16 v[150:151], v6 offset:512
    v_mfma_f32_16x16x32_bf16 v[76:79], v[152:155], a[140:143], v[76:79]
    s_waitcnt lgkmcnt(10)
    v_mfma_f32_16x16x32_bf16 v[80:83], v[156:159], a[136:139], v[80:83]
    ds_read_b64_tr_b16 v[152:153], v6 offset:32
    ds_read_b64_tr_b16 v[154:155], v6 offset:544
    v_mfma_f32_16x16x32_bf16 v[84:87], v[156:159], a[140:143], v[84:87]
    buffer_load_dwordx4 a[124:127], v250, s[12:15], s45 offen offset:3072 sc1
    v_mfma_f32_16x16x32_bf16 v[88:91], v[160:163], a[136:139], v[88:91]
    ds_read_b64_tr_b16 v[156:157], v6 offset:64
    ds_read_b64_tr_b16 v[158:159], v6 offset:576
    v_mfma_f32_16x16x32_bf16 v[92:95], v[160:163], a[140:143], v[92:95]
    s_waitcnt lgkmcnt(10)
    v_mfma_f32_16x16x32_bf16 v[96:99], v[164:167], a[136:139], v[96:99]
    ds_read_b64_tr_b16 v[160:161], v6 offset:96
    ds_read_b64_tr_b16 v[162:163], v6 offset:608
    v_mfma_f32_16x16x32_bf16 v[100:103], v[164:167], a[140:143], v[100:103]
    buffer_load_dwordx4 v4, s[8:11], s75 offen offset:2112 lds
    v_mfma_f32_16x16x32_bf16 v[104:107], v[168:171], a[136:139], v[104:107]
    ds_read_b64_tr_b16 v[164:165], v6 offset:128
    ds_read_b64_tr_b16 v[166:167], v6 offset:640
    v_mfma_f32_16x16x32_bf16 v[108:111], v[168:171], a[140:143], v[108:111]
    s_waitcnt lgkmcnt(10)
    v_mfma_f32_16x16x32_bf16 v[112:115], v[172:175], a[136:139], v[112:115]
    ds_read_b64_tr_b16 v[168:169], v6 offset:160
    ds_read_b64_tr_b16 v[170:171], v6 offset:672
    v_mfma_f32_16x16x32_bf16 v[116:119], v[172:175], a[140:143], v[116:119]
    buffer_load_dwordx4 v5, s[8:11], s75 offen offset:3168 lds
    s_add_u32 s75, s75, s66
    buffer_load_dwordx4 a[172:175], v10, s[12:15], s100 offen offset:3072 sc1
    buffer_load_dwordx4 a[176:179], v11, s[12:15], s100 offen offset:0 sc1
    s_add_u32 s100, s100, 40960
    buffer_load_dwordx4 a[180:183], v10, s[12:15], s100 offen offset:0 sc1
    v_mfma_f32_16x16x32_bf16 v[120:123], v[176:179], a[136:139], v[120:123]
    ds_read_b64_tr_b16 v[172:173], v6 offset:192
    ds_read_b64_tr_b16 v[174:175], v6 offset:704
    v_mfma_f32_16x16x32_bf16 v[124:127], v[176:179], a[140:143], v[124:127]
    s_waitcnt lgkmcnt(10)
    v_mfma_f32_16x16x32_bf16 v[16:19], v[148:151], a[144:147], v[16:19]
    ds_read_b64_tr_b16 v[176:177], v6 offset:224
    ds_read_b64_tr_b16 v[178:179], v6 offset:736
    v_mfma_f32_16x16x32_bf16 v[20:23], v[148:151], a[148:151], v[20:23]
    buffer_load_dwordx4 a[184:187], v10, s[12:15], s100 offen offset:1024 sc1
    v_mfma_f32_16x16x32_bf16 v[24:27], v[152:155], a[144:147], v[24:27]
    ds_read_b64_tr_b16 v[148:149], v6 offset:256
    ds_read_b64_tr_b16 v[150:151], v6 offset:768
    v_mfma_f32_16x16x32_bf16 v[28:31], v[152:155], a[148:151], v[28:31]
    s_waitcnt lgkmcnt(10)
    v_mfma_f32_16x16x32_bf16 v[32:35], v[156:159], a[144:147], v[32:35]
    ds_read_b64_tr_b16 v[152:153], v6 offset:288
    ds_read_b64_tr_b16 v[154:155], v6 offset:800
    v_mfma_f32_16x16x32_bf16 v[36:39], v[156:159], a[148:151], v[36:39]
    buffer_load_dwordx4 a[188:191], v10, s[12:15], s100 offen offset:2048 sc1
    v_mfma_f32_16x16x32_bf16 v[40:43], v[160:163], a[144:147], v[40:43]
    ds_read_b64_tr_b16 v[156:157], v6 offset:320
    ds_read_b64_tr_b16 v[158:159], v6 offset:832
    v_mfma_f32_16x16x32_bf16 v[44:47], v[160:163], a[148:151], v[44:47]
    s_waitcnt lgkmcnt(10)
    v_mfma_f32_16x16x32_bf16 v[48:51], v[164:167], a[144:147], v[48:51]
    ds_read_b64_tr_b16 v[160:161], v6 offset:352
    ds_read_b64_tr_b16 v[162:163], v6 offset:864
    v_mfma_f32_16x16x32_bf16 v[52:55], v[164:167], a[148:151], v[52:55]
    buffer_load_dwordx4 a[192:195], v10, s[12:15], s100 offen offset:3072 sc1
    v_mfma_f32_16x16x32_bf16 v[56:59], v[168:171], a[144:147], v[56:59]
    ds_read_b64_tr_b16 v[164:165], v6 offset:384
    ds_read_b64_tr_b16 v[166:167], v6 offset:896
    v_mfma_f32_16x16x32_bf16 v[60:63], v[168:171], a[148:151], v[60:63]
    s_waitcnt lgkmcnt(10)
    v_mfma_f32_16x16x32_bf16 v[64:67], v[172:175], a[144:147], v[64:67]
    ds_read_b64_tr_b16 v[168:169], v6 offset:416
    ds_read_b64_tr_b16 v[170:171], v6 offset:928
    v_mfma_f32_16x16x32_bf16 v[68:71], v[172:175], a[148:151], v[68:71]
    buffer_load_dwordx4 a[196:199], v11, s[12:15], s100 offen offset:0 sc1
    v_mfma_f32_16x16x32_bf16 v[72:75], v[176:179], a[144:147], v[72:75]
    ds_read_b64_tr_b16 v[172:173], v6 offset:16896
    ds_read_b64_tr_b16 v[174:175], v6 offset:17408
    v_mfma_f32_16x16x32_bf16 v[76:79], v[176:179], a[148:151], v[76:79]
    s_waitcnt lgkmcnt(10)
    s_add_u32 s100, s100, 40960
    v_mfma_f32_16x16x32_bf16 v[80:83], v[148:151], a[144:147], v[80:83]
    ds_read_b64_tr_b16 v[176:177], v6 offset:16928
    ds_read_b64_tr_b16 v[178:179], v6 offset:17440
    v_mfma_f32_16x16x32_bf16 v[84:87], v[148:151], a[148:151], v[84:87]
    buffer_load_dwordx4 a[200:203], v10, s[12:15], s100 offen offset:0 sc1
    v_mfma_f32_16x16x32_bf16 v[88:91], v[152:155], a[144:147], v[88:91]
    ds_read_b64_tr_b16 v[148:149], v6 offset:16960
    ds_read_b64_tr_b16 v[150:151], v6 offset:17472
    v_mfma_f32_16x16x32_bf16 v[92:95], v[152:155], a[148:151], v[92:95]
    s_waitcnt lgkmcnt(10)
    v_mfma_f32_16x16x32_bf16 v[96:99], v[156:159], a[144:147], v[96:99]
    ds_read_b64_tr_b16 v[152:153], v6 offset:16992
    ds_read_b64_tr_b16 v[154:155], v6 offset:17504
    v_mfma_f32_16x16x32_bf16 v[100:103], v[156:159], a[148:151], v[100:103]
    buffer_load_dwordx4 a[204:207], v10, s[12:15], s100 offen offset:1024 sc1
    v_mfma_f32_16x16x32_bf16 v[104:107], v[160:163], a[144:147], v[104:107]
    ds_read_b64_tr_b16 v[156:157], v6 offset:17024
    ds_read_b64_tr_b16 v[158:159], v6 offset:17536
    v_mfma_f32_16x16x32_bf16 v[108:111], v[160:163], a[148:151], v[108:111]
    s_waitcnt lgkmcnt(10)
    v_mfma_f32_16x16x32_bf16 v[112:115], v[164:167], a[144:147], v[112:115]
    ds_read_b64_tr_b16 v[160:161], v6 offset:17056
    ds_read_b64_tr_b16 v[162:163], v6 offset:17568
    v_mfma_f32_16x16x32_bf16 v[116:119], v[164:167], a[148:151], v[116:119]
    buffer_load_dwordx4 a[208:211], v10, s[12:15], s100 offen offset:2048 sc1
    buffer_load_dwordx4 a[212:215], v10, s[12:15], s100 offen offset:3072 sc1
    v_mfma_f32_16x16x32_bf16 v[120:123], v[168:171], a[144:147], v[120:123]
    ds_read_b64_tr_b16 v[164:165], v6 offset:17088
    ds_read_b64_tr_b16 v[166:167], v6 offset:17600
    v_mfma_f32_16x16x32_bf16 v[124:127], v[168:171], a[148:151], v[124:127]
    s_waitcnt lgkmcnt(10)
    v_mfma_f32_16x16x32_bf16 v[16:19], v[172:175], a[152:155], v[16:19]
    ds_read_b64_tr_b16 v[168:169], v6 offset:17120
    ds_read_b64_tr_b16 v[170:171], v6 offset:17632
    v_mfma_f32_16x16x32_bf16 v[20:23], v[172:175], a[156:159], v[20:23]
    buffer_load_dwordx4 a[216:219], v11, s[12:15], s100 offen offset:0 sc1
    v_mfma_f32_16x16x32_bf16 v[24:27], v[176:179], a[152:155], v[24:27]
    ds_read_b64_tr_b16 v[172:173], v6 offset:17152
    ds_read_b64_tr_b16 v[174:175], v6 offset:17664
    v_mfma_f32_16x16x32_bf16 v[28:31], v[176:179], a[156:159], v[28:31]
    s_waitcnt lgkmcnt(10)
    s_add_u32 s100, s100, 40960
    v_mfma_f32_16x16x32_bf16 v[32:35], v[148:151], a[152:155], v[32:35]
    ds_read_b64_tr_b16 v[176:177], v6 offset:17184
    ds_read_b64_tr_b16 v[178:179], v6 offset:17696
    v_mfma_f32_16x16x32_bf16 v[36:39], v[148:151], a[156:159], v[36:39]
    buffer_load_dwordx4 a[220:223], v10, s[12:15], s100 offen offset:0 sc1
    v_mfma_f32_16x16x32_bf16 v[40:43], v[152:155], a[152:155], v[40:43]
    ds_read_b64_tr_b16 v[148:149], v6 offset:17216
    ds_read_b64_tr_b16 v[150:151], v6 offset:17728
    v_mfma_f32_16x16x32_bf16 v[44:47], v[152:155], a[156:159], v[44:47]
    s_waitcnt lgkmcnt(10)
    v_mfma_f32_16x16x32_bf16 v[48:51], v[156:159], a[152:155], v[48:51]
    ds_read_b64_tr_b16 v[152:153], v6 offset:17248
    ds_read_b64_tr_b16 v[154:155], v6 offset:17760
    v_mfma_f32_16x16x32_bf16 v[52:55], v[156:159], a[156:159], v[52:55]
    buffer_load_dwordx4 a[224:227], v10, s[12:15], s100 offen offset:1024 sc1
    v_mfma_f32_16x16x32_bf16 v[56:59], v[160:163], a[152:155], v[56:59]
    ds_read_b64_tr_b16 v[156:157], v6 offset:17280
    ds_read_b64_tr_b16 v[158:159], v6 offset:17792
    v_mfma_f32_16x16x32_bf16 v[60:63], v[160:163], a[156:159], v[60:63]
    s_waitcnt lgkmcnt(10)
    v_mfma_f32_16x16x32_bf16 v[64:67], v[164:167], a[152:155], v[64:67]
    ds_read_b64_tr_b16 v[160:161], v6 offset:17312
    ds_read_b64_tr_b16 v[162:163], v6 offset:17824
    v_mfma_f32_16x16x32_bf16 v[68:71], v[164:167], a[156:159], v[68:71]
    s_waitcnt vmcnt(14)
    s_barrier
    v_mfma_f32_16x16x32_bf16 v[72:75], v[168:171], a[152:155], v[72:75]
    ds_read_b64_tr_b16 v[164:165], v6 offset:33792
    ds_read_b64_tr_b16 v[166:167], v6 offset:34304
    v_mfma_f32_16x16x32_bf16 v[76:79], v[168:171], a[156:159], v[76:79]
    s_waitcnt lgkmcnt(10)
    v_mfma_f32_16x16x32_bf16 v[80:83], v[172:175], a[152:155], v[80:83]
    ds_read_b64_tr_b16 v[168:169], v6 offset:33824
    ds_read_b64_tr_b16 v[170:171], v6 offset:34336
    v_mfma_f32_16x16x32_bf16 v[84:87], v[172:175], a[156:159], v[84:87]
    buffer_load_dwordx4 a[228:231], v10, s[12:15], s100 offen offset:2048 sc1
    v_mfma_f32_16x16x32_bf16 v[88:91], v[176:179], a[152:155], v[88:91]
    ds_read_b64_tr_b16 v[172:173], v6 offset:33856
    ds_read_b64_tr_b16 v[174:175], v6 offset:34368
    v_mfma_f32_16x16x32_bf16 v[92:95], v[176:179], a[156:159], v[92:95]
    s_waitcnt lgkmcnt(10)
    v_mfma_f32_16x16x32_bf16 v[96:99], v[148:151], a[152:155], v[96:99]
    ds_read_b64_tr_b16 v[176:177], v6 offset:33888
    ds_read_b64_tr_b16 v[178:179], v6 offset:34400
    v_mfma_f32_16x16x32_bf16 v[100:103], v[148:151], a[156:159], v[100:103]
    buffer_load_dwordx4 a[232:235], v10, s[12:15], s100 offen offset:3072 sc1
    v_mfma_f32_16x16x32_bf16 v[104:107], v[152:155], a[152:155], v[104:107]
    ds_read_b64_tr_b16 v[148:149], v6 offset:33920
    ds_read_b64_tr_b16 v[150:151], v6 offset:34432
    v_mfma_f32_16x16x32_bf16 v[108:111], v[152:155], a[156:159], v[108:111]
    s_waitcnt lgkmcnt(10)
    v_mfma_f32_16x16x32_bf16 v[112:115], v[156:159], a[152:155], v[112:115]
    ds_read_b64_tr_b16 v[152:153], v6 offset:33952
    ds_read_b64_tr_b16 v[154:155], v6 offset:34464
    v_mfma_f32_16x16x32_bf16 v[116:119], v[156:159], a[156:159], v[116:119]
    buffer_load_dwordx4 a[236:239], v11, s[12:15], s100 offen offset:0 sc1
    s_add_u32 s100, s100, 40960
    buffer_load_dwordx4 a[240:243], v10, s[12:15], s101 offen offset:0 sc1
    buffer_load_dwordx4 a[244:247], v10, s[12:15], s101 offen offset:1024 sc1
    v_mfma_f32_16x16x32_bf16 v[120:123], v[160:163], a[152:155], v[120:123]
    ds_read_b64_tr_b16 v[156:157], v6 offset:33984
    ds_read_b64_tr_b16 v[158:159], v6 offset:34496
    v_mfma_f32_16x16x32_bf16 v[124:127], v[160:163], a[156:159], v[124:127]
    s_waitcnt lgkmcnt(10)
    v_mfma_f32_16x16x32_bf16 v[16:19], v[164:167], a[112:115], v[16:19]
    ds_read_b64_tr_b16 v[160:161], v6 offset:34016
    ds_read_b64_tr_b16 v[162:163], v6 offset:34528
    v_mfma_f32_16x16x32_bf16 v[20:23], v[164:167], a[116:119], v[20:23]
    buffer_load_dwordx4 a[248:251], v10, s[12:15], s101 offen offset:2048 sc1
    v_mfma_f32_16x16x32_bf16 v[24:27], v[168:171], a[112:115], v[24:27]
    ds_read_b64_tr_b16 v[164:165], v6 offset:34048
    ds_read_b64_tr_b16 v[166:167], v6 offset:34560
    v_mfma_f32_16x16x32_bf16 v[28:31], v[168:171], a[116:119], v[28:31]
    s_waitcnt lgkmcnt(10)
    v_mfma_f32_16x16x32_bf16 v[32:35], v[172:175], a[112:115], v[32:35]
    ds_read_b64_tr_b16 v[168:169], v6 offset:34080
    ds_read_b64_tr_b16 v[170:171], v6 offset:34592
    v_mfma_f32_16x16x32_bf16 v[36:39], v[172:175], a[116:119], v[36:39]
    buffer_load_dwordx4 a[252:255], v10, s[12:15], s101 offen offset:3072 sc1
    v_mfma_f32_16x16x32_bf16 v[40:43], v[176:179], a[112:115], v[40:43]
    ds_read_b64_tr_b16 v[172:173], v6 offset:34112
    ds_read_b64_tr_b16 v[174:175], v6 offset:34624
    v_mfma_f32_16x16x32_bf16 v[44:47], v[176:179], a[116:119], v[44:47]
    s_waitcnt lgkmcnt(10)
    v_mfma_f32_16x16x32_bf16 v[48:51], v[148:151], a[112:115], v[48:51]
    ds_read_b64_tr_b16 v[176:177], v6 offset:34144
    ds_read_b64_tr_b16 v[178:179], v6 offset:34656
    v_mfma_f32_16x16x32_bf16 v[52:55], v[148:151], a[116:119], v[52:55]
    buffer_load_dwordx4 a[0:3], v11, s[12:15], s101 offen offset:0 sc1
    v_mfma_f32_16x16x32_bf16 v[56:59], v[152:155], a[112:115], v[56:59]
    ds_read_b64_tr_b16 v[148:149], v6 offset:34176
    ds_read_b64_tr_b16 v[150:151], v6 offset:34688
    v_mfma_f32_16x16x32_bf16 v[60:63], v[152:155], a[116:119], v[60:63]
    s_waitcnt lgkmcnt(10)
    s_add_u32 s101, s101, 40960
    v_mfma_f32_16x16x32_bf16 v[64:67], v[156:159], a[112:115], v[64:67]
    ds_read_b64_tr_b16 v[152:153], v6 offset:34208
    ds_read_b64_tr_b16 v[154:155], v6 offset:34720
    v_mfma_f32_16x16x32_bf16 v[68:71], v[156:159], a[116:119], v[68:71]
    buffer_load_dwordx4 a[4:7], v10, s[12:15], s101 offen offset:0 sc1
    v_mfma_f32_16x16x32_bf16 v[72:75], v[160:163], a[112:115], v[72:75]
    ds_read_b64_tr_b16 v[156:157], v6 offset:50688
    ds_read_b64_tr_b16 v[158:159], v6 offset:51200
    v_mfma_f32_16x16x32_bf16 v[76:79], v[160:163], a[116:119], v[76:79]
    s_waitcnt lgkmcnt(10)
    v_mfma_f32_16x16x32_bf16 v[80:83], v[164:167], a[112:115], v[80:83]
    ds_read_b64_tr_b16 v[160:161], v6 offset:50720
    ds_read_b64_tr_b16 v[162:163], v6 offset:51232
    v_mfma_f32_16x16x32_bf16 v[84:87], v[164:167], a[116:119], v[84:87]
    buffer_load_dwordx4 a[8:11], v10, s[12:15], s101 offen offset:1024 sc1
    v_mfma_f32_16x16x32_bf16 v[88:91], v[168:171], a[112:115], v[88:91]
    ds_read_b64_tr_b16 v[164:165], v6 offset:50752
    ds_read_b64_tr_b16 v[166:167], v6 offset:51264
    v_mfma_f32_16x16x32_bf16 v[92:95], v[168:171], a[116:119], v[92:95]
    s_waitcnt lgkmcnt(10)
    v_mfma_f32_16x16x32_bf16 v[96:99], v[172:175], a[112:115], v[96:99]
    ds_read_b64_tr_b16 v[168:169], v6 offset:50784
    ds_read_b64_tr_b16 v[170:171], v6 offset:51296
    v_mfma_f32_16x16x32_bf16 v[100:103], v[172:175], a[116:119], v[100:103]
    buffer_load_dwordx4 a[12:15], v10, s[12:15], s101 offen offset:2048 sc1
    v_mfma_f32_16x16x32_bf16 v[104:107], v[176:179], a[112:115], v[104:107]
    ds_read_b64_tr_b16 v[172:173], v6 offset:50816
    ds_read_b64_tr_b16 v[174:175], v6 offset:51328
    v_mfma_f32_16x16x32_bf16 v[108:111], v[176:179], a[116:119], v[108:111]
    s_waitcnt lgkmcnt(10)
    v_mfma_f32_16x16x32_bf16 v[112:115], v[148:151], a[112:115], v[112:115]
    ds_read_b64_tr_b16 v[176:177], v6 offset:50848
    ds_read_b64_tr_b16 v[178:179], v6 offset:51360
    v_mfma_f32_16x16x32_bf16 v[116:119], v[148:151], a[116:119], v[116:119]
    buffer_load_dwordx4 a[16:19], v10, s[12:15], s101 offen offset:3072 sc1
    buffer_load_dwordx4 a[20:23], v11, s[12:15], s101 offen offset:0 sc1
    s_add_u32 s101, s101, 40960
    v_mfma_f32_16x16x32_bf16 v[120:123], v[152:155], a[112:115], v[120:123]
    ds_read_b64_tr_b16 v[148:149], v6 offset:50880
    ds_read_b64_tr_b16 v[150:151], v6 offset:51392
    v_mfma_f32_16x16x32_bf16 v[124:127], v[152:155], a[116:119], v[124:127]
    s_waitcnt lgkmcnt(10)
    v_mfma_f32_16x16x32_bf16 v[16:19], v[156:159], a[120:123], v[16:19]
    ds_read_b64_tr_b16 v[152:153], v6 offset:50912
    ds_read_b64_tr_b16 v[154:155], v6 offset:51424
    v_mfma_f32_16x16x32_bf16 v[20:23], v[156:159], a[124:127], v[20:23]
    buffer_load_dwordx4 a[24:27], v10, s[12:15], s101 offen offset:0 sc1
    v_mfma_f32_16x16x32_bf16 v[24:27], v[160:163], a[120:123], v[24:27]
    ds_read_b64_tr_b16 v[156:157], v6 offset:50944
    ds_read_b64_tr_b16 v[158:159], v6 offset:51456
    v_mfma_f32_16x16x32_bf16 v[28:31], v[160:163], a[124:127], v[28:31]
    s_waitcnt lgkmcnt(10)
    v_mfma_f32_16x16x32_bf16 v[32:35], v[164:167], a[120:123], v[32:35]
    ds_read_b64_tr_b16 v[160:161], v6 offset:50976
    ds_read_b64_tr_b16 v[162:163], v6 offset:51488
    v_mfma_f32_16x16x32_bf16 v[36:39], v[164:167], a[124:127], v[36:39]
    buffer_load_dwordx4 a[28:31], v10, s[12:15], s101 offen offset:1024 sc1
    v_mfma_f32_16x16x32_bf16 v[40:43], v[168:171], a[120:123], v[40:43]
    ds_read_b64_tr_b16 v[164:165], v6 offset:51008
    ds_read_b64_tr_b16 v[166:167], v6 offset:51520
    v_mfma_f32_16x16x32_bf16 v[44:47], v[168:171], a[124:127], v[44:47]
    s_waitcnt lgkmcnt(10)
    v_mfma_f32_16x16x32_bf16 v[48:51], v[172:175], a[120:123], v[48:51]
    ds_read_b64_tr_b16 v[168:169], v6 offset:51040
    ds_read_b64_tr_b16 v[170:171], v6 offset:51552
    v_mfma_f32_16x16x32_bf16 v[52:55], v[172:175], a[124:127], v[52:55]
    buffer_load_dwordx4 a[32:35], v10, s[12:15], s101 offen offset:2048 sc1
    v_mfma_f32_16x16x32_bf16 v[56:59], v[176:179], a[120:123], v[56:59]
    ds_read_b64_tr_b16 v[172:173], v6 offset:51072
    ds_read_b64_tr_b16 v[174:175], v6 offset:51584
    v_mfma_f32_16x16x32_bf16 v[60:63], v[176:179], a[124:127], v[60:63]
    s_waitcnt lgkmcnt(10)
    v_mfma_f32_16x16x32_bf16 v[64:67], v[148:151], a[120:123], v[64:67]
    ds_read_b64_tr_b16 v[176:177], v6 offset:51104
    ds_read_b64_tr_b16 v[178:179], v6 offset:51616
    v_mfma_f32_16x16x32_bf16 v[68:71], v[148:151], a[124:127], v[68:71]
    buffer_load_dwordx4 a[36:39], v10, s[12:15], s101 offen offset:3072 sc1
    v_mfma_f32_16x16x32_bf16 v[72:75], v[152:155], a[120:123], v[72:75]
    buffer_load_dwordx4 a[40:43], v11, s[12:15], s101 offen offset:0 sc1
    v_mfma_f32_16x16x32_bf16 v[76:79], v[152:155], a[124:127], v[76:79]
    s_waitcnt lgkmcnt(8)
    s_add_u32 s101, s101, 40960
    v_mfma_f32_16x16x32_bf16 v[80:83], v[156:159], a[120:123], v[80:83]
    buffer_load_dwordx4 a[44:47], v10, s[12:15], s101 offen offset:0 sc1
    v_mfma_f32_16x16x32_bf16 v[84:87], v[156:159], a[124:127], v[84:87]
    buffer_load_dwordx4 a[48:51], v10, s[12:15], s101 offen offset:1024 sc1
    v_mfma_f32_16x16x32_bf16 v[88:91], v[160:163], a[120:123], v[88:91]
    buffer_load_dwordx4 a[52:55], v10, s[12:15], s101 offen offset:2048 sc1
    v_mfma_f32_16x16x32_bf16 v[92:95], v[160:163], a[124:127], v[92:95]
    s_waitcnt lgkmcnt(4)
    v_mfma_f32_16x16x32_bf16 v[96:99], v[164:167], a[120:123], v[96:99]
    v_mfma_f32_16x16x32_bf16 v[100:103], v[164:167], a[124:127], v[100:103]
    v_mfma_f32_16x16x32_bf16 v[104:107], v[168:171], a[120:123], v[104:107]
    v_mfma_f32_16x16x32_bf16 v[108:111], v[168:171], a[124:127], v[108:111]
    s_waitcnt lgkmcnt(0)
    v_mfma_f32_16x16x32_bf16 v[112:115], v[172:175], a[120:123], v[112:115]
    v_mfma_f32_16x16x32_bf16 v[116:119], v[172:175], a[124:127], v[116:119]
    v_mfma_f32_16x16x32_bf16 v[120:123], v[176:179], a[120:123], v[120:123]
    v_mfma_f32_16x16x32_bf16 v[124:127], v[176:179], a[124:127], v[124:127]
    s_barrier
    v_pk_mul_f32 v[192:193], v[16:17], v[16:17]
    v_pk_mul_f32 v[194:195], v[18:19], v[18:19]
    v_pk_mul_f32 v[196:197], v[24:25], v[24:25]
    v_pk_mul_f32 v[198:199], v[26:27], v[26:27]
    v_pk_fma_f32 v[192:193], v[192:193], s[46:47], v[128:129]
    v_pk_fma_f32 v[194:195], v[194:195], s[46:47], v[128:129]
    v_pk_fma_f32 v[196:197], v[196:197], s[46:47], v[128:129]
    v_pk_fma_f32 v[198:199], v[198:199], s[46:47], v[128:129]
    buffer_load_dwordx4 a[56:59], v10, s[12:15], s101 offen offset:3072 sc1
    v_pk_mul_f32 v[192:193], v[192:193], v[16:17]
    v_pk_mul_f32 v[194:195], v[194:195], v[18:19]
    v_pk_mul_f32 v[196:197], v[196:197], v[24:25]
    v_pk_mul_f32 v[198:199], v[198:199], v[26:27]
    v_exp_f32 v192, v192
    v_exp_f32 v193, v193
    v_exp_f32 v194, v194
    v_pk_add_f32 v[192:193], v[192:193], v[130:131]
    v_exp_f32 v195, v195
    v_exp_f32 v196, v196
    v_pk_add_f32 v[194:195], v[194:195], v[130:131]
    v_exp_f32 v197, v197
    v_exp_f32 v198, v198
    v_pk_add_f32 v[196:197], v[196:197], v[130:131]
    v_exp_f32 v199, v199
    buffer_load_dwordx4 a[60:63], v11, s[12:15], s101 offen offset:0 sc1
    s_add_u32 s101, s101, 40960
    v_rcp_f32 v192, v192
    v_pk_add_f32 v[198:199], v[198:199], v[130:131]
    v_rcp_f32 v193, v193
    v_rcp_f32 v194, v194
    v_pk_mul_f32 v[192:193], v[192:193], v[16:17]
    v_rcp_f32 v195, v195
    v_rcp_f32 v196, v196
    v_pk_mul_f32 v[194:195], v[194:195], v[18:19]
    v_rcp_f32 v197, v197
    v_rcp_f32 v198, v198
    v_pk_mul_f32 v[196:197], v[196:197], v[24:25]
    v_rcp_f32 v199, v199
    buffer_load_dwordx4 a[64:67], v10, s[12:15], s100 offen offset:0 sc1
    v_cvt_pk_bf16_f32 v208, v192, v193
    v_pk_mul_f32 v[198:199], v[198:199], v[26:27]
    v_cvt_pk_bf16_f32 v209, v194, v195
    v_cvt_pk_bf16_f32 v210, v196, v197
    v_cvt_pk_bf16_f32 v211, v198, v199
    buffer_store_dwordx4 v[208:211], v10, s[12:15], s48 offen offset:0 sc1
    v_pk_mul_f32 v[200:201], v[20:21], v[20:21]
    v_pk_mul_f32 v[202:203], v[22:23], v[22:23]
    v_pk_mul_f32 v[204:205], v[28:29], v[28:29]
    v_pk_mul_f32 v[206:207], v[30:31], v[30:31]
    v_pk_fma_f32 v[200:201], v[200:201], s[46:47], v[128:129]
    v_pk_fma_f32 v[202:203], v[202:203], s[46:47], v[128:129]
    v_pk_fma_f32 v[204:205], v[204:205], s[46:47], v[128:129]
    v_pk_fma_f32 v[206:207], v[206:207], s[46:47], v[128:129]
    buffer_load_dwordx4 a[68:71], v10, s[12:15], s100 offen offset:1024 sc1
    v_pk_mul_f32 v[200:201], v[200:201], v[20:21]
    v_pk_mul_f32 v[202:203], v[202:203], v[22:23]
    v_pk_mul_f32 v[204:205], v[204:205], v[28:29]
    v_pk_mul_f32 v[206:207], v[206:207], v[30:31]
    v_exp_f32 v200, v200
    v_exp_f32 v201, v201
    v_exp_f32 v202, v202
    v_pk_add_f32 v[200:201], v[200:201], v[130:131]
    v_exp_f32 v203, v203
    v_exp_f32 v204, v204
    v_pk_add_f32 v[202:203], v[202:203], v[130:131]
    v_exp_f32 v205, v205
    v_exp_f32 v206, v206
    v_pk_add_f32 v[204:205], v[204:205], v[130:131]
    v_exp_f32 v207, v207
    buffer_load_dwordx4 a[72:75], v10, s[12:15], s100 offen offset:2048 sc1
    v_rcp_f32 v200, v200
    v_pk_add_f32 v[206:207], v[206:207], v[130:131]
    v_rcp_f32 v201, v201
    v_rcp_f32 v202, v202
    v_pk_mul_f32 v[200:201], v[200:201], v[20:21]
    v_rcp_f32 v203, v203
    v_rcp_f32 v204, v204
    v_pk_mul_f32 v[202:203], v[202:203], v[22:23]
    v_rcp_f32 v205, v205
    v_rcp_f32 v206, v206
    v_pk_mul_f32 v[204:205], v[204:205], v[28:29]
    v_rcp_f32 v207, v207
    buffer_load_dwordx4 a[76:79], v10, s[12:15], s100 offen offset:3072 sc1
    v_cvt_pk_bf16_f32 v212, v200, v201
    v_pk_mul_f32 v[206:207], v[206:207], v[30:31]
    v_cvt_pk_bf16_f32 v213, v202, v203
    v_cvt_pk_bf16_f32 v214, v204, v205
    v_cvt_pk_bf16_f32 v215, v206, v207
    buffer_store_dwordx4 v[212:215], v10, s[12:15], s49 offen offset:0 sc1
    v_pk_mul_f32 v[192:193], v[32:33], v[32:33]
    v_pk_mul_f32 v[194:195], v[34:35], v[34:35]
    v_pk_mul_f32 v[196:197], v[40:41], v[40:41]
    v_pk_mul_f32 v[198:199], v[42:43], v[42:43]
    v_pk_fma_f32 v[192:193], v[192:193], s[46:47], v[128:129]
    v_pk_fma_f32 v[194:195], v[194:195], s[46:47], v[128:129]
    v_pk_fma_f32 v[196:197], v[196:197], s[46:47], v[128:129]
    v_pk_fma_f32 v[198:199], v[198:199], s[46:47], v[128:129]
    buffer_load_dwordx4 a[80:83], v11, s[12:15], s100 offen offset:0 sc1
    s_add_u32 s100, s100, 40960
    v_pk_mul_f32 v[192:193], v[192:193], v[32:33]
    v_pk_mul_f32 v[194:195], v[194:195], v[34:35]
    v_pk_mul_f32 v[196:197], v[196:197], v[40:41]
    v_pk_mul_f32 v[198:199], v[198:199], v[42:43]
    v_exp_f32 v192, v192
    v_exp_f32 v193, v193
    v_exp_f32 v194, v194
    v_pk_add_f32 v[192:193], v[192:193], v[130:131]
    v_exp_f32 v195, v195
    v_exp_f32 v196, v196
    v_pk_add_f32 v[194:195], v[194:195], v[130:131]
    v_exp_f32 v197, v197
    v_exp_f32 v198, v198
    v_pk_add_f32 v[196:197], v[196:197], v[130:131]
    v_exp_f32 v199, v199
    s_add_u32 s100, s100, s18
    buffer_load_dwordx4 a[84:87], v10, s[12:15], s100 offen offset:0 sc1
    v_rcp_f32 v192, v192
    v_pk_add_f32 v[198:199], v[198:199], v[130:131]
    v_rcp_f32 v193, v193
    v_rcp_f32 v194, v194
    v_pk_mul_f32 v[192:193], v[192:193], v[32:33]
    v_rcp_f32 v195, v195
    v_rcp_f32 v196, v196
    v_pk_mul_f32 v[194:195], v[194:195], v[34:35]
    v_rcp_f32 v197, v197
    v_rcp_f32 v198, v198
    v_pk_mul_f32 v[196:197], v[196:197], v[40:41]
    v_rcp_f32 v199, v199
    buffer_load_dwordx4 a[88:91], v10, s[12:15], s100 offen offset:1024 sc1
    v_cvt_pk_bf16_f32 v216, v192, v193
    v_pk_mul_f32 v[198:199], v[198:199], v[42:43]
    v_cvt_pk_bf16_f32 v217, v194, v195
    v_cvt_pk_bf16_f32 v218, v196, v197
    v_cvt_pk_bf16_f32 v219, v198, v199
    buffer_store_dwordx4 v[216:219], v10, s[12:15], s48 offen offset:1024 sc1
    v_pk_mul_f32 v[200:201], v[36:37], v[36:37]
    v_pk_mul_f32 v[202:203], v[38:39], v[38:39]
    v_pk_mul_f32 v[204:205], v[44:45], v[44:45]
    v_pk_mul_f32 v[206:207], v[46:47], v[46:47]
    v_pk_fma_f32 v[200:201], v[200:201], s[46:47], v[128:129]
    v_pk_fma_f32 v[202:203], v[202:203], s[46:47], v[128:129]
    v_pk_fma_f32 v[204:205], v[204:205], s[46:47], v[128:129]
    v_pk_fma_f32 v[206:207], v[206:207], s[46:47], v[128:129]
    buffer_load_dwordx4 a[92:95], v10, s[12:15], s100 offen offset:2048 sc1
    v_pk_mul_f32 v[200:201], v[200:201], v[36:37]
    v_pk_mul_f32 v[202:203], v[202:203], v[38:39]
    v_pk_mul_f32 v[204:205], v[204:205], v[44:45]
    v_pk_mul_f32 v[206:207], v[206:207], v[46:47]
    v_exp_f32 v200, v200
    v_exp_f32 v201, v201
    v_exp_f32 v202, v202
    v_pk_add_f32 v[200:201], v[200:201], v[130:131]
    v_exp_f32 v203, v203
    v_exp_f32 v204, v204
    v_pk_add_f32 v[202:203], v[202:203], v[130:131]
    v_exp_f32 v205, v205
    v_exp_f32 v206, v206
    v_pk_add_f32 v[204:205], v[204:205], v[130:131]
    v_exp_f32 v207, v207
    buffer_load_dwordx4 a[96:99], v10, s[12:15], s100 offen offset:3072 sc1
    v_rcp_f32 v200, v200
    v_pk_add_f32 v[206:207], v[206:207], v[130:131]
    v_rcp_f32 v201, v201
    v_rcp_f32 v202, v202
    v_pk_mul_f32 v[200:201], v[200:201], v[36:37]
    v_rcp_f32 v203, v203
    v_rcp_f32 v204, v204
    v_pk_mul_f32 v[202:203], v[202:203], v[38:39]
    v_rcp_f32 v205, v205
    v_rcp_f32 v206, v206
    v_pk_mul_f32 v[204:205], v[204:205], v[44:45]
    v_rcp_f32 v207, v207
    buffer_load_dwordx4 a[100:103], v11, s[12:15], s100 offen offset:0 sc1
    s_add_u32 s100, s100, 40960
    v_cvt_pk_bf16_f32 v220, v200, v201
    v_pk_mul_f32 v[206:207], v[206:207], v[46:47]
    v_cvt_pk_bf16_f32 v221, v202, v203
    v_cvt_pk_bf16_f32 v222, v204, v205
    v_cvt_pk_bf16_f32 v223, v206, v207
    buffer_store_dwordx4 v[220:223], v10, s[12:15], s49 offen offset:1024 sc1
    v_pk_mul_f32 v[192:193], v[48:49], v[48:49]
    v_pk_mul_f32 v[194:195], v[50:51], v[50:51]
    v_pk_mul_f32 v[196:197], v[56:57], v[56:57]
    v_pk_mul_f32 v[198:199], v[58:59], v[58:59]
    v_pk_fma_f32 v[192:193], v[192:193], s[46:47], v[128:129]
    v_pk_fma_f32 v[194:195], v[194:195], s[46:47], v[128:129]
    v_pk_fma_f32 v[196:197], v[196:197], s[46:47], v[128:129]
    v_pk_fma_f32 v[198:199], v[198:199], s[46:47], v[128:129]
    buffer_load_dwordx4 a[104:107], v10, s[12:15], s100 offen offset:0 sc1
    v_pk_mul_f32 v[192:193], v[192:193], v[48:49]
    v_pk_mul_f32 v[194:195], v[194:195], v[50:51]
    v_pk_mul_f32 v[196:197], v[196:197], v[56:57]
    v_pk_mul_f32 v[198:199], v[198:199], v[58:59]
    v_exp_f32 v192, v192
    v_exp_f32 v193, v193
    v_exp_f32 v194, v194
    v_pk_add_f32 v[192:193], v[192:193], v[130:131]
    v_exp_f32 v195, v195
    v_exp_f32 v196, v196
    v_pk_add_f32 v[194:195], v[194:195], v[130:131]
    v_exp_f32 v197, v197
    v_exp_f32 v198, v198
    v_pk_add_f32 v[196:197], v[196:197], v[130:131]
    v_exp_f32 v199, v199
    buffer_load_dwordx4 a[108:111], v10, s[12:15], s100 offen offset:1024 sc1
    v_rcp_f32 v192, v192
    v_pk_add_f32 v[198:199], v[198:199], v[130:131]
    v_rcp_f32 v193, v193
    v_rcp_f32 v194, v194
    v_pk_mul_f32 v[192:193], v[192:193], v[48:49]
    v_rcp_f32 v195, v195
    v_rcp_f32 v196, v196
    v_pk_mul_f32 v[194:195], v[194:195], v[50:51]
    v_rcp_f32 v197, v197
    v_rcp_f32 v198, v198
    v_pk_mul_f32 v[196:197], v[196:197], v[56:57]
    v_rcp_f32 v199, v199
    buffer_load_dwordx4 a[112:115], v10, s[12:15], s100 offen offset:2048 sc1
    v_cvt_pk_bf16_f32 v208, v192, v193
    v_pk_mul_f32 v[198:199], v[198:199], v[58:59]
    v_cvt_pk_bf16_f32 v209, v194, v195
    v_cvt_pk_bf16_f32 v210, v196, v197
    v_cvt_pk_bf16_f32 v211, v198, v199
    buffer_store_dwordx4 v[208:211], v10, s[12:15], s48 offen offset:2048 sc1
    v_pk_mul_f32 v[200:201], v[52:53], v[52:53]
    v_pk_mul_f32 v[202:203], v[54:55], v[54:55]
    v_pk_mul_f32 v[204:205], v[60:61], v[60:61]
    v_pk_mul_f32 v[206:207], v[62:63], v[62:63]
    v_pk_fma_f32 v[200:201], v[200:201], s[46:47], v[128:129]
    v_pk_fma_f32 v[202:203], v[202:203], s[46:47], v[128:129]
    v_pk_fma_f32 v[204:205], v[204:205], s[46:47], v[128:129]
    v_pk_fma_f32 v[206:207], v[206:207], s[46:47], v[128:129]
    buffer_load_dwordx4 a[116:119], v10, s[12:15], s100 offen offset:3072 sc1
    v_pk_mul_f32 v[200:201], v[200:201], v[52:53]
    v_pk_mul_f32 v[202:203], v[202:203], v[54:55]
    v_pk_mul_f32 v[204:205], v[204:205], v[60:61]
    v_pk_mul_f32 v[206:207], v[206:207], v[62:63]
    v_exp_f32 v200, v200
    v_exp_f32 v201, v201
    v_exp_f32 v202, v202
    v_pk_add_f32 v[200:201], v[200:201], v[130:131]
    v_exp_f32 v203, v203
    v_exp_f32 v204, v204
    v_pk_add_f32 v[202:203], v[202:203], v[130:131]
    v_exp_f32 v205, v205
    v_exp_f32 v206, v206
    v_pk_add_f32 v[204:205], v[204:205], v[130:131]
    v_exp_f32 v207, v207
    buffer_load_dwordx4 a[120:123], v11, s[12:15], s100 offen offset:0 sc1
    s_add_u32 s100, s100, 40960
    v_rcp_f32 v200, v200
    v_pk_add_f32 v[206:207], v[206:207], v[130:131]
    v_rcp_f32 v201, v201
    v_rcp_f32 v202, v202
    v_pk_mul_f32 v[200:201], v[200:201], v[52:53]
    v_rcp_f32 v203, v203
    v_rcp_f32 v204, v204
    v_pk_mul_f32 v[202:203], v[202:203], v[54:55]
    v_rcp_f32 v205, v205
    v_rcp_f32 v206, v206
    v_pk_mul_f32 v[204:205], v[204:205], v[60:61]
    v_rcp_f32 v207, v207
    buffer_load_dwordx4 a[124:127], v10, s[12:15], s101 offen offset:0 sc1
    v_cvt_pk_bf16_f32 v212, v200, v201
    v_pk_mul_f32 v[206:207], v[206:207], v[62:63]
    v_cvt_pk_bf16_f32 v213, v202, v203
    v_cvt_pk_bf16_f32 v214, v204, v205
    v_cvt_pk_bf16_f32 v215, v206, v207
    buffer_store_dwordx4 v[212:215], v10, s[12:15], s49 offen offset:2048 sc1
    v_pk_mul_f32 v[192:193], v[64:65], v[64:65]
    v_pk_mul_f32 v[194:195], v[66:67], v[66:67]
    v_pk_mul_f32 v[196:197], v[72:73], v[72:73]
    v_pk_mul_f32 v[198:199], v[74:75], v[74:75]
    v_pk_fma_f32 v[192:193], v[192:193], s[46:47], v[128:129]
    v_pk_fma_f32 v[194:195], v[194:195], s[46:47], v[128:129]
    v_pk_fma_f32 v[196:197], v[196:197], s[46:47], v[128:129]
    v_pk_fma_f32 v[198:199], v[198:199], s[46:47], v[128:129]
    buffer_load_dwordx4 a[128:131], v10, s[12:15], s101 offen offset:1024 sc1
    v_pk_mul_f32 v[192:193], v[192:193], v[64:65]
    v_pk_mul_f32 v[194:195], v[194:195], v[66:67]
    v_pk_mul_f32 v[196:197], v[196:197], v[72:73]
    v_pk_mul_f32 v[198:199], v[198:199], v[74:75]
    v_exp_f32 v192, v192
    v_exp_f32 v193, v193
    v_exp_f32 v194, v194
    v_pk_add_f32 v[192:193], v[192:193], v[130:131]
    v_exp_f32 v195, v195
    v_exp_f32 v196, v196
    v_pk_add_f32 v[194:195], v[194:195], v[130:131]
    v_exp_f32 v197, v197
    v_exp_f32 v198, v198
    v_pk_add_f32 v[196:197], v[196:197], v[130:131]
    v_exp_f32 v199, v199
    buffer_load_dwordx4 a[132:135], v10, s[12:15], s101 offen offset:2048 sc1
    v_rcp_f32 v192, v192
    v_pk_add_f32 v[198:199], v[198:199], v[130:131]
    v_rcp_f32 v193, v193
    v_rcp_f32 v194, v194
    v_pk_mul_f32 v[192:193], v[192:193], v[64:65]
    v_rcp_f32 v195, v195
    v_rcp_f32 v196, v196
    v_pk_mul_f32 v[194:195], v[194:195], v[66:67]
    v_rcp_f32 v197, v197
    v_rcp_f32 v198, v198
    v_pk_mul_f32 v[196:197], v[196:197], v[72:73]
    v_rcp_f32 v199, v199
    buffer_load_dwordx4 a[136:139], v10, s[12:15], s101 offen offset:3072 sc1
    v_cvt_pk_bf16_f32 v216, v192, v193
    v_pk_mul_f32 v[198:199], v[198:199], v[74:75]
    v_cvt_pk_bf16_f32 v217, v194, v195
    v_cvt_pk_bf16_f32 v218, v196, v197
    v_cvt_pk_bf16_f32 v219, v198, v199
    buffer_store_dwordx4 v[216:219], v10, s[12:15], s48 offen offset:3072 sc1
    v_pk_mul_f32 v[200:201], v[68:69], v[68:69]
    v_pk_mul_f32 v[202:203], v[70:71], v[70:71]
    v_pk_mul_f32 v[204:205], v[76:77], v[76:77]
    v_pk_mul_f32 v[206:207], v[78:79], v[78:79]
    v_pk_fma_f32 v[200:201], v[200:201], s[46:47], v[128:129]
    v_pk_fma_f32 v[202:203], v[202:203], s[46:47], v[128:129]
    v_pk_fma_f32 v[204:205], v[204:205], s[46:47], v[128:129]
    v_pk_fma_f32 v[206:207], v[206:207], s[46:47], v[128:129]
    buffer_load_dwordx4 a[140:143], v11, s[12:15], s101 offen offset:0 sc1
    s_add_u32 s101, s101, 40960
    v_pk_mul_f32 v[200:201], v[200:201], v[68:69]
    v_pk_mul_f32 v[202:203], v[202:203], v[70:71]
    v_pk_mul_f32 v[204:205], v[204:205], v[76:77]
    v_pk_mul_f32 v[206:207], v[206:207], v[78:79]
    v_exp_f32 v200, v200
    v_exp_f32 v201, v201
    v_exp_f32 v202, v202
    v_pk_add_f32 v[200:201], v[200:201], v[130:131]
    v_exp_f32 v203, v203
    v_exp_f32 v204, v204
    v_pk_add_f32 v[202:203], v[202:203], v[130:131]
    v_exp_f32 v205, v205
    v_exp_f32 v206, v206
    v_pk_add_f32 v[204:205], v[204:205], v[130:131]
    v_exp_f32 v207, v207
    buffer_load_dwordx4 a[144:147], v10, s[12:15], s101 offen offset:0 sc1
    v_rcp_f32 v200, v200
    v_pk_add_f32 v[206:207], v[206:207], v[130:131]
    v_rcp_f32 v201, v201
    v_rcp_f32 v202, v202
    v_pk_mul_f32 v[200:201], v[200:201], v[68:69]
    v_rcp_f32 v203, v203
    v_rcp_f32 v204, v204
    v_pk_mul_f32 v[202:203], v[202:203], v[70:71]
    v_rcp_f32 v205, v205
    v_rcp_f32 v206, v206
    v_pk_mul_f32 v[204:205], v[204:205], v[76:77]
    v_rcp_f32 v207, v207
    buffer_load_dwordx4 a[148:151], v10, s[12:15], s101 offen offset:1024 sc1
    v_cvt_pk_bf16_f32 v220, v200, v201
    v_pk_mul_f32 v[206:207], v[206:207], v[78:79]
    v_cvt_pk_bf16_f32 v221, v202, v203
    v_cvt_pk_bf16_f32 v222, v204, v205
    v_cvt_pk_bf16_f32 v223, v206, v207
    buffer_store_dwordx4 v[220:223], v10, s[12:15], s49 offen offset:3072 sc1
    v_pk_mul_f32 v[192:193], v[80:81], v[80:81]
    v_pk_mul_f32 v[194:195], v[82:83], v[82:83]
    v_pk_mul_f32 v[196:197], v[88:89], v[88:89]
    v_pk_mul_f32 v[198:199], v[90:91], v[90:91]
    v_pk_fma_f32 v[192:193], v[192:193], s[46:47], v[128:129]
    v_pk_fma_f32 v[194:195], v[194:195], s[46:47], v[128:129]
    v_pk_fma_f32 v[196:197], v[196:197], s[46:47], v[128:129]
    v_pk_fma_f32 v[198:199], v[198:199], s[46:47], v[128:129]
    buffer_load_dwordx4 a[152:155], v10, s[12:15], s101 offen offset:2048 sc1
    v_pk_mul_f32 v[192:193], v[192:193], v[80:81]
    v_pk_mul_f32 v[194:195], v[194:195], v[82:83]
    v_pk_mul_f32 v[196:197], v[196:197], v[88:89]
    v_pk_mul_f32 v[198:199], v[198:199], v[90:91]
    v_exp_f32 v192, v192
    v_exp_f32 v193, v193
    v_exp_f32 v194, v194
    v_pk_add_f32 v[192:193], v[192:193], v[130:131]
    v_exp_f32 v195, v195
    v_exp_f32 v196, v196
    v_pk_add_f32 v[194:195], v[194:195], v[130:131]
    v_exp_f32 v197, v197
    v_exp_f32 v198, v198
    v_pk_add_f32 v[196:197], v[196:197], v[130:131]
    v_exp_f32 v199, v199
    buffer_load_dwordx4 a[156:159], v10, s[12:15], s101 offen offset:3072 sc1
    v_rcp_f32 v192, v192
    v_pk_add_f32 v[198:199], v[198:199], v[130:131]
    v_rcp_f32 v193, v193
    v_rcp_f32 v194, v194
    v_pk_mul_f32 v[192:193], v[192:193], v[80:81]
    v_rcp_f32 v195, v195
    v_rcp_f32 v196, v196
    v_pk_mul_f32 v[194:195], v[194:195], v[82:83]
    v_rcp_f32 v197, v197
    v_rcp_f32 v198, v198
    v_pk_mul_f32 v[196:197], v[196:197], v[88:89]
    v_rcp_f32 v199, v199
    buffer_load_dwordx4 v[228:231], v11, s[12:15], s101 offen offset:0 sc1
    s_add_u32 s101, s101, 40960
    v_cvt_pk_bf16_f32 v208, v192, v193
    v_pk_mul_f32 v[198:199], v[198:199], v[90:91]
    v_cvt_pk_bf16_f32 v209, v194, v195
    v_cvt_pk_bf16_f32 v210, v196, v197
    v_cvt_pk_bf16_f32 v211, v198, v199
    buffer_store_dwordx4 v[208:211], v11, s[12:15], s48 offen offset:0 sc1
    v_pk_mul_f32 v[200:201], v[84:85], v[84:85]
    v_pk_mul_f32 v[202:203], v[86:87], v[86:87]
    v_pk_mul_f32 v[204:205], v[92:93], v[92:93]
    v_pk_mul_f32 v[206:207], v[94:95], v[94:95]
    v_pk_fma_f32 v[200:201], v[200:201], s[46:47], v[128:129]
    v_pk_fma_f32 v[202:203], v[202:203], s[46:47], v[128:129]
    v_pk_fma_f32 v[204:205], v[204:205], s[46:47], v[128:129]
    v_pk_fma_f32 v[206:207], v[206:207], s[46:47], v[128:129]
    buffer_load_dwordx4 v[232:235], v10, s[12:15], s101 offen offset:0 sc1
    v_pk_mul_f32 v[200:201], v[200:201], v[84:85]
    v_pk_mul_f32 v[202:203], v[202:203], v[86:87]
    v_pk_mul_f32 v[204:205], v[204:205], v[92:93]
    v_pk_mul_f32 v[206:207], v[206:207], v[94:95]
    v_exp_f32 v200, v200
    v_exp_f32 v201, v201
    v_exp_f32 v202, v202
    v_pk_add_f32 v[200:201], v[200:201], v[130:131]
    v_exp_f32 v203, v203
    v_exp_f32 v204, v204
    v_pk_add_f32 v[202:203], v[202:203], v[130:131]
    v_exp_f32 v205, v205
    v_exp_f32 v206, v206
    v_pk_add_f32 v[204:205], v[204:205], v[130:131]
    v_exp_f32 v207, v207
    buffer_load_dwordx4 v[236:239], v10, s[12:15], s101 offen offset:1024 sc1
    v_rcp_f32 v200, v200
    v_pk_add_f32 v[206:207], v[206:207], v[130:131]
    v_rcp_f32 v201, v201
    v_rcp_f32 v202, v202
    v_pk_mul_f32 v[200:201], v[200:201], v[84:85]
    v_rcp_f32 v203, v203
    v_rcp_f32 v204, v204
    v_pk_mul_f32 v[202:203], v[202:203], v[86:87]
    v_rcp_f32 v205, v205
    v_rcp_f32 v206, v206
    v_pk_mul_f32 v[204:205], v[204:205], v[92:93]
    v_rcp_f32 v207, v207
    buffer_load_dwordx4 v[240:243], v10, s[12:15], s101 offen offset:2048 sc1
    v_cvt_pk_bf16_f32 v212, v200, v201
    v_pk_mul_f32 v[206:207], v[206:207], v[94:95]
    v_cvt_pk_bf16_f32 v213, v202, v203
    v_cvt_pk_bf16_f32 v214, v204, v205
    v_cvt_pk_bf16_f32 v215, v206, v207
    buffer_store_dwordx4 v[212:215], v11, s[12:15], s49 offen offset:0 sc1
    s_waitcnt vmcnt(8)
    s_barrier
    s_cmp_eq_u32 s60, 0
    s_cbranch_scc0 L_nh_15
    v_mov_b32 v224, s79
    v_mov_b32 v225, 15384576
    s_mov_b64 exec, 1
    buffer_store_dword v224, v225, s[12:15], s3 offen sc1
    s_mov_b64 exec, -1
L_nh_15:
    v_pk_mul_f32 v[192:193], v[96:97], v[96:97]
    v_pk_mul_f32 v[194:195], v[98:99], v[98:99]
    v_pk_mul_f32 v[196:197], v[104:105], v[104:105]
    v_pk_mul_f32 v[198:199], v[106:107], v[106:107]
    v_pk_fma_f32 v[192:193], v[192:193], s[46:47], v[128:129]
    v_pk_fma_f32 v[194:195], v[194:195], s[46:47], v[128:129]
    v_pk_fma_f32 v[196:197], v[196:197], s[46:47], v[128:129]
    v_pk_fma_f32 v[198:199], v[198:199], s[46:47], v[128:129]
    buffer_load_dwordx4 v[244:247], v10, s[12:15], s101 offen offset:3072 sc1
    v_pk_mul_f32 v[192:193], v[192:193], v[96:97]
    v_pk_mul_f32 v[194:195], v[194:195], v[98:99]
    v_pk_mul_f32 v[196:197], v[196:197], v[104:105]
    v_pk_mul_f32 v[198:199], v[198:199], v[106:107]
    v_exp_f32 v192, v192
    v_exp_f32 v193, v193
    v_exp_f32 v194, v194
    v_pk_add_f32 v[192:193], v[192:193], v[130:131]
    v_exp_f32 v195, v195
    v_exp_f32 v196, v196
    v_pk_add_f32 v[194:195], v[194:195], v[130:131]
    v_exp_f32 v197, v197
    v_exp_f32 v198, v198
    v_pk_add_f32 v[196:197], v[196:197], v[130:131]
    v_exp_f32 v199, v199
    s_add_u32 s73, s16, 0
    s_add_u32 m0, s17, 0
    s_nop 0
    buffer_load_dwordx4 v10, s[12:15], s73 offen offset:0 sc1 lds
    v_rcp_f32 v192, v192
    v_pk_add_f32 v[198:199], v[198:199], v[130:131]
    v_rcp_f32 v193, v193
    v_rcp_f32 v194, v194
    v_pk_mul_f32 v[192:193], v[192:193], v[96:97]
    v_rcp_f32 v195, v195
    v_rcp_f32 v196, v196
    v_pk_mul_f32 v[194:195], v[194:195], v[98:99]
    v_rcp_f32 v197, v197
    v_rcp_f32 v198, v198
    v_pk_mul_f32 v[196:197], v[196:197], v[104:105]
    v_rcp_f32 v199, v199
    buffer_load_dwordx4 v10, s[12:15], s73 offen offset:1024 sc1 lds
    v_cvt_pk_bf16_f32 v216, v192, v193
    v_pk_mul_f32 v[198:199], v[198:199], v[106:107]
    v_cvt_pk_bf16_f32 v217, v194, v195
    v_cvt_pk_bf16_f32 v218, v196, v197
    v_cvt_pk_bf16_f32 v219, v198, v199
    buffer_store_dwordx4 v[216:219], v11, s[12:15], s48 offen offset:1024 sc1
    v_pk_mul_f32 v[200:201], v[100:101], v[100:101]
    v_pk_mul_f32 v[202:203], v[102:103], v[102:103]
    v_pk_mul_f32 v[204:205], v[108:109], v[108:109]
    v_pk_mul_f32 v[206:207], v[110:111], v[110:111]
    v_pk_fma_f32 v[200:201], v[200:201], s[46:47], v[128:129]
    v_pk_fma_f32 v[202:203], v[202:203], s[46:47], v[128:129]
    v_pk_fma_f32 v[204:205], v[204:205], s[46:47], v[128:129]
    v_pk_fma_f32 v[206:207], v[206:207], s[46:47], v[128:129]
    buffer_load_dwordx4 v10, s[12:15], s73 offen offset:2048 sc1 lds
    v_pk_mul_f32 v[200:201], v[200:201], v[100:101]
    v_pk_mul_f32 v[202:203], v[202:203], v[102:103]
    v_pk_mul_f32 v[204:205], v[204:205], v[108:109]
    v_pk_mul_f32 v[206:207], v[206:207], v[110:111]
    v_exp_f32 v200, v200
    v_exp_f32 v201, v201
    v_exp_f32 v202, v202
    v_pk_add_f32 v[200:201], v[200:201], v[130:131]
    v_exp_f32 v203, v203
    v_exp_f32 v204, v204
    v_pk_add_f32 v[202:203], v[202:203], v[130:131]
    v_exp_f32 v205, v205
    v_exp_f32 v206, v206
    v_pk_add_f32 v[204:205], v[204:205], v[130:131]
    v_exp_f32 v207, v207
    buffer_load_dwordx4 v10, s[12:15], s73 offen offset:3072 sc1 lds
    v_rcp_f32 v200, v200
    v_pk_add_f32 v[206:207], v[206:207], v[130:131]
    v_rcp_f32 v201, v201
    v_rcp_f32 v202, v202
    v_pk_mul_f32 v[200:201], v[200:201], v[100:101]
    v_rcp_f32 v203, v203
    v_rcp_f32 v204, v204
    v_pk_mul_f32 v[202:203], v[202:203], v[102:103]
    v_rcp_f32 v205, v205
    v_rcp_f32 v206, v206
    v_pk_mul_f32 v[204:205], v[204:205], v[108:109]
    v_rcp_f32 v207, v207
    s_add_u32 m0, s17, 4096
    s_nop 0
    buffer_load_dwordx4 v11, s[12:15], s73 offen offset:0 sc1 lds
    v_cvt_pk_bf16_f32 v220, v200, v201
    v_pk_mul_f32 v[206:207], v[206:207], v[110:111]
    v_cvt_pk_bf16_f32 v221, v202, v203
    v_cvt_pk_bf16_f32 v222, v204, v205
    v_cvt_pk_bf16_f32 v223, v206, v207
    buffer_store_dwordx4 v[220:223], v11, s[12:15], s49 offen offset:1024 sc1
    v_pk_mul_f32 v[192:193], v[112:113], v[112:113]
    v_pk_mul_f32 v[194:195], v[114:115], v[114:115]
    v_pk_mul_f32 v[196:197], v[120:121], v[120:121]
    v_pk_mul_f32 v[198:199], v[122:123], v[122:123]
    v_pk_fma_f32 v[192:193], v[192:193], s[46:47], v[128:129]
    v_pk_fma_f32 v[194:195], v[194:195], s[46:47], v[128:129]
    v_pk_fma_f32 v[196:197], v[196:197], s[46:47], v[128:129]
    v_pk_fma_f32 v[198:199], v[198:199], s[46:47], v[128:129]
    s_add_u32 s73, s16, 163840
    s_add_u32 m0, s17, 20480
    s_nop 0
    buffer_load_dwordx4 v10, s[12:15], s73 offen offset:0 sc1 lds
    v_pk_mul_f32 v[192:193], v[192:193], v[112:113]
    v_pk_mul_f32 v[194:195], v[194:195], v[114:115]
    v_pk_mul_f32 v[196:197], v[196:197], v[120:121]
    v_pk_mul_f32 v[198:199], v[198:199], v[122:123]
    v_exp_f32 v192, v192
    v_exp_f32 v193, v193
    v_exp_f32 v194, v194
    v_pk_add_f32 v[192:193], v[192:193], v[130:131]
    v_exp_f32 v195, v195
    v_exp_f32 v196, v196
    v_pk_add_f32 v[194:195], v[194:195], v[130:131]
    v_exp_f32 v197, v197
    v_exp_f32 v198, v198
    v_pk_add_f32 v[196:197], v[196:197], v[130:131]
    v_exp_f32 v199, v199
    buffer_load_dwordx4 v10, s[12:15], s73 offen offset:1024 sc1 lds
    v_rcp_f32 v192, v192
    v_pk_add_f32 v[198:199], v[198:199], v[130:131]
    v_rcp_f32 v193, v193
    v_rcp_f32 v194, v194
    v_pk_mul_f32 v[192:193], v[192:193], v[112:113]
    v_rcp_f32 v195, v195
    v_rcp_f32 v196, v196
    v_pk_mul_f32 v[194:195], v[194:195], v[114:115]
    v_rcp_f32 v197, v197
    v_rcp_f32 v198, v198
    v_pk_mul_f32 v[196:197], v[196:197], v[120:121]
    v_rcp_f32 v199, v199
    buffer_load_dwordx4 v10, s[12:15], s73 offen offset:2048 sc1 lds
    v_cvt_pk_bf16_f32 v208, v192, v193
    v_pk_mul_f32 v[198:199], v[198:199], v[122:123]
    v_cvt_pk_bf16_f32 v209, v194, v195
    v_cvt_pk_bf16_f32 v210, v196, v197
    v_cvt_pk_bf16_f32 v211, v198, v199
    buffer_store_dwordx4 v[208:211], v11, s[12:15], s48 offen offset:2048 sc1
    buffer_load_dwordx4 v10, s[12:15], s73 offen offset:3072 sc1 lds
    s_add_u32 m0, s17, 24576
    s_nop 0
    buffer_load_dwordx4 v11, s[12:15], s73 offen offset:0 sc1 lds
    s_add_u32 s73, s16, 327680
    s_add_u32 m0, s17, 40960
    s_nop 0
    buffer_load_dwordx4 v10, s[12:15], s73 offen offset:0 sc1 lds
    buffer_load_dwordx4 v10, s[12:15], s73 offen offset:1024 sc1 lds
    buffer_load_dwordx4 v10, s[12:15], s73 offen offset:2048 sc1 lds
    buffer_load_dwordx4 v10, s[12:15], s73 offen offset:3072 sc1 lds
    s_add_u32 m0, s17, 45056
    s_nop 0
    buffer_load_dwordx4 v11, s[12:15], s73 offen offset:0 sc1 lds
    buffer_load_dword v13, v15, s[12:15], 0 offen sc1
    v_pk_mul_f32 v[200:201], v[116:117], v[116:117]
    v_pk_mul_f32 v[202:203], v[118:119], v[118:119]
    v_pk_mul_f32 v[204:205], v[124:125], v[124:125]
    v_pk_mul_f32 v[206:207], v[126:127], v[126:127]
    v_pk_fma_f32 v[200:201], v[200:201], s[46:47], v[128:129]
    v_pk_fma_f32 v[202:203], v[202:203], s[46:47], v[128:129]
    v_pk_fma_f32 v[204:205], v[204:205], s[46:47], v[128:129]
    v_pk_fma_f32 v[206:207], v[206:207], s[46:47], v[128:129]
    v_pk_mul_f32 v[200:201], v[200:201], v[116:117]
    v_pk_mul_f32 v[202:203], v[202:203], v[118:119]
    v_pk_mul_f32 v[204:205], v[204:205], v[124:125]
    v_pk_mul_f32 v[206:207], v[206:207], v[126:127]
    v_exp_f32 v200, v200
    v_exp_f32 v201, v201
    v_exp_f32 v202, v202
    v_pk_add_f32 v[200:201], v[200:201], v[130:131]
    v_exp_f32 v203, v203
    v_exp_f32 v204, v204
    v_pk_add_f32 v[202:203], v[202:203], v[130:131]
    v_exp_f32 v205, v205
    v_exp_f32 v206, v206
    v_pk_add_f32 v[204:205], v[204:205], v[130:131]
    v_exp_f32 v207, v207
    v_rcp_f32 v200, v200
    v_pk_add_f32 v[206:207], v[206:207], v[130:131]
    v_rcp_f32 v201, v201
    v_rcp_f32 v202, v202
    v_pk_mul_f32 v[200:201], v[200:201], v[116:117]
    v_rcp_f32 v203, v203
    v_rcp_f32 v204, v204
    v_pk_mul_f32 v[202:203], v[202:203], v[118:119]
    v_rcp_f32 v205, v205
    v_rcp_f32 v206, v206
    v_pk_mul_f32 v[204:205], v[204:205], v[124:125]
    v_rcp_f32 v207, v207
    v_cvt_pk_bf16_f32 v212, v200, v201
    v_pk_mul_f32 v[206:207], v[206:207], v[126:127]
    v_cvt_pk_bf16_f32 v213, v202, v203
    v_cvt_pk_bf16_f32 v214, v204, v205
    v_cvt_pk_bf16_f32 v215, v206, v207
    buffer_store_dwordx4 v[212:215], v11, s[12:15], s49 offen offset:2048 sc1
    s_waitcnt vmcnt(1)
    v_cmp_ne_u32 vcc, s79, v13
    s_nop 0
    s_cmp_eq_u64 vcc, 0
    s_cselect_b32 s19, 1, 0
    s_cselect_b32 s68, 0, 1073741824
    v_add_u32 v6, s68, v10
L_phase2:
    buffer_load_dwordx4 v[116:119], v6, s[12:15], s24 offen offset:0 sc1
    buffer_load_dwordx4 v[120:123], v6, s[12:15], s25 offen offset:0 sc1
    buffer_load_dwordx4 v[124:127], v6, s[12:15], s26 offen offset:0 sc1
    buffer_load_dwordx4 v[128:131], v6, s[12:15], s27 offen offset:0 sc1
    buffer_load_dwordx4 v[132:135], v6, s[12:15], s24 offen offset:1024 sc1
    buffer_load_dwordx4 v[136:139], v6, s[12:15], s25 offen offset:1024 sc1
    buffer_load_dwordx4 v[140:143], v6, s[12:15], s26 offen offset:1024 sc1
    buffer_load_dwordx4 v[144:147], v6, s[12:15], s27 offen offset:1024 sc1
    s_waitcnt vmcnt(8)
    s_waitcnt lgkmcnt(0)
    s_barrier
    s_cmp_eq_u32 s60, 0
    s_cbranch_scc0 L_np_16
    v_mov_b32 v218, s79
    v_mov_b32 v219, 15368192
    s_mov_b64 exec, 1
    buffer_store_dword v218, v219, s[12:15], s3 offen sc1
    s_mov_b64 exec, -1
L_np_16:
    s_cmp_eq_u32 s19, 1
    s_cbranch_scc1 L_haveh_17
    s_waitcnt vmcnt(0) lgkmcnt(0)
    buffer_load_dword v13, v15, s[12:15], 0 offen sc1
    s_waitcnt vmcnt(0)
    v_cmp_ne_u32 vcc, s79, v13
    s_mov_b32 s78, 0
    s_nop 3
    s_cbranch_vccz L_polled_ffn_19
L_poll_ffn_18:
    s_sleep 1
    buffer_load_dword v13, v15, s[12:15], 0 offen sc1
    s_waitcnt vmcnt(0)
    v_cmp_ne_u32 vcc, s79, v13
    s_add_u32 s78, s78, 1
    s_nop 3
    s_cbranch_vccz L_polled_ffn_19
    s_cmp_lt_u32 s78, 0x40000
    s_cbranch_scc1 L_poll_ffn_18
L_polled_ffn_19:
    buffer_load_dwordx4 v[116:119], v10, s[12:15], s24 offen offset:0 sc1
    buffer_load_dwordx4 v[120:123], v10, s[12:15], s25 offen offset:0 sc1
    buffer_load_dwordx4 v[124:127], v10, s[12:15], s26 offen offset:0 sc1
    buffer_load_dwordx4 v[128:131], v10, s[12:15], s27 offen offset:0 sc1
    buffer_load_dwordx4 v[132:135], v10, s[12:15], s24 offen offset:1024 sc1
    buffer_load_dwordx4 v[136:139], v10, s[12:15], s25 offen offset:1024 sc1
    buffer_load_dwordx4 v[140:143], v10, s[12:15], s26 offen offset:1024 sc1
    buffer_load_dwordx4 v[144:147], v10, s[12:15], s27 offen offset:1024 sc1
L_haveh_17:
    buffer_load_dwordx4 v[148:151], v10, s[12:15], s24 offen offset:2048 sc1
    buffer_load_dwordx4 v[152:155], v10, s[12:15], s25 offen offset:2048 sc1
    buffer_load_dwordx4 v[156:159], v10, s[12:15], s26 offen offset:2048 sc1
    buffer_load_dwordx4 v[160:163], v10, s[12:15], s27 offen offset:2048 sc1
    buffer_load_dwordx4 v[164:167], v10, s[12:15], s24 offen offset:3072 sc1
    buffer_load_dwordx4 v[168:171], v10, s[12:15], s25 offen offset:3072 sc1
    buffer_load_dwordx4 v[172:175], v10, s[12:15], s26 offen offset:3072 sc1
    buffer_load_dwordx4 v[176:179], v10, s[12:15], s27 offen offset:3072 sc1
    s_mov_b32 s39, 1
    s_waitcnt vmcnt(15)
    v_mfma_f32_16x16x32_bf16 v[16:19], a[160:163], v[116:119], 0
    buffer_load_dwordx4 v[180:183], v10, s[12:15], s28 offen offset:0 sc1
    v_mfma_f32_16x16x32_bf16 v[20:23], a[164:167], v[116:119], 0
    buffer_load_dwordx4 v[184:187], v10, s[12:15], s29 offen offset:0 sc1
    v_mfma_f32_16x16x32_bf16 v[24:27], a[168:171], v[116:119], 0
    buffer_load_dwordx4 v[188:191], v10, s[12:15], s30 offen offset:0 sc1
    v_mfma_f32_16x16x32_bf16 v[28:31], a[172:175], v[116:119], 0
    buffer_load_dwordx4 v[192:195], v10, s[12:15], s31 offen offset:0 sc1
    v_mfma_f32_16x16x32_bf16 v[32:35], a[176:179], v[116:119], 0
    buffer_load_dwordx4 v[116:119], v10, s[12:15], s28 offen offset:1024 sc1
    s_waitcnt vmcnt(19)
    v_mfma_f32_16x16x32_bf16 v[36:39], a[160:163], v[120:123], 0
    v_subrev_u32 v15, 16384, v15
    s_lshr_b32 s71, s76, 1
    v_mfma_f32_16x16x32_bf16 v[40:43], a[164:167], v[120:123], 0
    s_lshl_b32 s71, s71, 10
    s_add_u32 s71, s71, 15368192
    v_mfma_f32_16x16x32_bf16 v[44:47], a[168:171], v[120:123], 0
    v_and_b32 v222, 7, v1
    v_lshl_add_u32 v222, v222, 6, s71
    v_mfma_f32_16x16x32_bf16 v[48:51], a[172:175], v[120:123], 0
    s_mul_i32 s71, s60, 15360
    v_add_u32 v224, 102400, v10
    v_mfma_f32_16x16x32_bf16 v[52:55], a[176:179], v[120:123], 0
    buffer_load_dwordx4 v[120:123], v10, s[12:15], s29 offen offset:1024 sc1
    s_waitcnt vmcnt(19)
    v_mfma_f32_16x16x32_bf16 v[56:59], a[160:163], v[124:127], 0
    v_add_u32 v223, s71, v224
    v_add_u32 v225, 65536, v10
    v_mfma_f32_16x16x32_bf16 v[60:63], a[164:167], v[124:127], 0
    s_add_u32 s71, s60, 1
    s_and_b32 s71, s71, 3
    v_mfma_f32_16x16x32_bf16 v[64:67], a[168:171], v[124:127], 0
    s_mul_i32 s71, s71, 15360
    v_add_u32 v5, s71, v224
    v_mfma_f32_16x16x32_bf16 v[68:71], a[172:175], v[124:127], 0
    s_add_u32 s71, s60, 2
    s_and_b32 s71, s71, 3
    v_mfma_f32_16x16x32_bf16 v[72:75], a[176:179], v[124:127], 0
    buffer_load_dwordx4 v[124:127], v10, s[12:15], s30 offen offset:1024 sc1
    s_waitcnt vmcnt(19)
    v_mfma_f32_16x16x32_bf16 v[76:79], a[160:163], v[128:131], 0
    s_mul_i32 s71, s71, 15360
    v_add_u32 v8, s71, v224
    v_mfma_f32_16x16x32_bf16 v[80:83], a[164:167], v[128:131], 0
    s_add_u32 s71, s60, 3
    s_and_b32 s71, s71, 3
    v_mfma_f32_16x16x32_bf16 v[84:87], a[168:171], v[128:131], 0
    s_mul_i32 s71, s71, 15360
    v_add_u32 v9, s71, v224
    v_mfma_f32_16x16x32_bf16 v[88:91], a[172:175], v[128:131], 0
    v_mfma_f32_16x16x32_bf16 v[92:95], a[176:179], v[128:131], 0
    buffer_load_dwordx4 v[128:131], v10, s[12:15], s31 offen offset:1024 sc1
    s_waitcnt vmcnt(19)
    v_mfma_f32_16x16x32_bf16 v[16:19], a[180:183], v[132:135], v[16:19]
    buffer_load_dword v13, v15, s[12:15], 0 offen sc1
    v_mfma_f32_16x16x32_bf16 v[20:23], a[184:187], v[132:135], v[20:23]
    s_lshl_b32 s71, s76, 2
    s_add_u32 s71, s71, s60
    v_mfma_f32_16x16x32_bf16 v[24:27], a[188:191], v[132:135], v[24:27]
    s_mul_i32 s36, s71, 75776
    s_add_u32 s36, s36, 2621440
    v_mfma_f32_16x16x32_bf16 v[28:31], a[192:195], v[132:135], v[28:31]
    s_mov_b32 s40, 0xffff0000
    s_mov_b32 s41, 0xbfb8aa3b
    v_mfma_f32_16x16x32_bf16 v[32:35], a[196:199], v[132:135], v[32:35]
    buffer_load_dwordx4 v[132:135], v10, s[12:15], s28 offen offset:2048 sc1
    s_waitcnt vmcnt(20)
    v_mfma_f32_16x16x32_bf16 v[36:39], a[180:183], v[136:139], v[36:39]
    s_mul_i32 s71, s71, 20480
    s_mul_i32 s72, s77, 160
    v_mfma_f32_16x16x32_bf16 v[40:43], a[184:187], v[136:139], v[40:43]
    s_add_u32 s71, s71, s72
    v_add_u32 v221, 0, v1
    v_mfma_f32_16x16x32_bf16 v[44:47], a[188:191], v[136:139], v[44:47]
    v_mul_u32_u24 v220, 205, v221
    v_lshrrev_b32 v220, 11, v220
    v_mfma_f32_16x16x32_bf16 v[48:51], a[192:195], v[136:139], v[48:51]
    v_mul_u32_u24 v220, 1120, v220
    v_lshl_add_u32 v220, v221, 4, v220
    v_mfma_f32_16x16x32_bf16 v[52:55], a[196:199], v[136:139], v[52:55]
    buffer_load_dwordx4 v[136:139], v10, s[12:15], s29 offen offset:2048 sc1
    s_waitcnt vmcnt(20)
    v_mfma_f32_16x16x32_bf16 v[56:59], a[180:183], v[140:143], v[56:59]
    v_add_u32 v2, s71, v220
    v_add_u32 v221, 64, v1
    v_mfma_f32_16x16x32_bf16 v[60:63], a[184:187], v[140:143], v[60:63]
    v_mfma_f32_16x16x32_bf16 v[64:67], a[188:191], v[140:143], v[64:67]
    v_mul_u32_u24 v220, 205, v221
    v_lshrrev_b32 v220, 11, v220
    v_mfma_f32_16x16x32_bf16 v[68:71], a[192:195], v[140:143], v[68:71]
    v_mfma_f32_16x16x32_bf16 v[72:75], a[196:199], v[140:143], v[72:75]
    buffer_load_dwordx4 v[140:143], v10, s[12:15], s30 offen offset:2048 sc1
    s_waitcnt vmcnt(20)
    v_mfma_f32_16x16x32_bf16 v[76:79], a[180:183], v[144:147], v[76:79]
    v_mul_u32_u24 v220, 1120, v220
    v_lshl_add_u32 v220, v221, 4, v220
    v_mfma_f32_16x16x32_bf16 v[80:83], a[184:187], v[144:147], v[80:83]
    v_mfma_f32_16x16x32_bf16 v[84:87], a[188:191], v[144:147], v[84:87]
    v_mfma_f32_16x16x32_bf16 v[88:91], a[192:195], v[144:147], v[88:91]
    v_mfma_f32_16x16x32_bf16 v[92:95], a[196:199], v[144:147], v[92:95]
    buffer_load_dwordx4 v[144:147], v10, s[12:15], s31 offen offset:2048 sc1
    s_waitcnt vmcnt(20)
    v_mfma_f32_16x16x32_bf16 v[16:19], a[200:203], v[148:151], v[16:19]
    buffer_load_dwordx4 a[160:163], v11, s[12:15], s101 offen offset:0 sc1
    v_mfma_f32_16x16x32_bf16 v[20:23], a[204:207], v[148:151], v[20:23]
    s_add_u32 s101, s101, 40960
    v_add_u32 v3, s71, v220
    v_mfma_f32_16x16x32_bf16 v[24:27], a[208:211], v[148:151], v[24:27]
    v_add_u32 v221, 128, v1
    v_mul_u32_u24 v220, 205, v221
    v_mfma_f32_16x16x32_bf16 v[28:31], a[212:215], v[148:151], v[28:31]
    v_lshrrev_b32 v220, 11, v220
    v_mul_u32_u24 v220, 1120, v220
    v_mfma_f32_16x16x32_bf16 v[32:35], a[216:219], v[148:151], v[32:35]
    buffer_load_dwordx4 v[148:151], v10, s[12:15], s28 offen offset:3072 sc1
    s_waitcnt vmcnt(21)
    v_mfma_f32_16x16x32_bf16 v[36:39], a[200:203], v[152:155], v[36:39]
    v_lshl_add_u32 v220, v221, 4, v220
    v_add_u32 v4, s71, v220
    v_mfma_f32_16x16x32_bf16 v[40:43], a[204:207], v[152:155], v[40:43]
    v_lshrrev_b32 v221, 5, v1
    v_lshl_or_b32 v4, v221, 30, v4
    v_mfma_f32_16x16x32_bf16 v[44:47], a[208:211], v[152:155], v[44:47]
    v_and_b32 v221, 8, v1
    v_bfe_u32 v220, v1, 2, 1
    v_mfma_f32_16x16x32_bf16 v[48:51], a[212:215], v[152:155], v[48:51]
    v_add_u32 v221, v221, v220
    v_and_b32 v220, 3, v1
    v_mfma_f32_16x16x32_bf16 v[52:55], a[216:219], v[152:155], v[52:55]
    buffer_load_dwordx4 v[152:155], v10, s[12:15], s29 offen offset:3072 sc1
    s_waitcnt vmcnt(21)
    v_mfma_f32_16x16x32_bf16 v[56:59], a[200:203], v[156:159], v[56:59]
    v_lshl_add_u32 v221, v220, 1, v221
    v_mul_u32_u24 v220, 160, v221
    v_mfma_f32_16x16x32_bf16 v[60:63], a[204:207], v[156:159], v[60:63]
    v_lshrrev_b32 v221, 4, v1
    v_lshl_add_u32 v220, v221, 3, v220
    v_mfma_f32_16x16x32_bf16 v[64:67], a[208:211], v[156:159], v[64:67]
    v_lshl_add_u32 v221, v221, 3, s72
    s_mul_i32 s71, s60, 15360
    v_mfma_f32_16x16x32_bf16 v[68:71], a[212:215], v[156:159], v[68:71]
    v_mfma_f32_16x16x32_bf16 v[72:75], a[216:219], v[156:159], v[72:75]
    buffer_load_dwordx4 v[156:159], v10, s[12:15], s30 offen offset:3072 sc1
    s_waitcnt vmcnt(21)
    v_mfma_f32_16x16x32_bf16 v[76:79], a[200:203], v[160:163], v[76:79]
    s_add_u32 s71, s71, 102400
    v_add_u32 v220, s71, v220
    v_mfma_f32_16x16x32_bf16 v[80:83], a[204:207], v[160:163], v[80:83]
    v_mfma_f32_16x16x32_bf16 v[84:87], a[208:211], v[160:163], v[84:87]
    v_mfma_f32_16x16x32_bf16 v[88:91], a[212:215], v[160:163], v[88:91]
    v_mfma_f32_16x16x32_bf16 v[92:95], a[216:219], v[160:163], v[92:95]
    buffer_load_dwordx4 v[160:163], v10, s[12:15], s31 offen offset:3072 sc1
    s_waitcnt vmcnt(9)
    v_cmp_ne_u32 vcc, s79, v13
    s_mov_b32 s78, 0
    s_nop 3
    s_cbranch_vccz L_polled_ffn2_21
L_poll_ffn2_20:
    s_sleep 1
    buffer_load_dword v13, v15, s[12:15], 0 offen sc1
    s_waitcnt vmcnt(0)
    v_cmp_ne_u32 vcc, s79, v13
    s_add_u32 s78, s78, 1
    s_nop 3
    s_cbranch_vccz L_polled_ffn2_21
    s_cmp_lt_u32 s78, 0x40000
    s_cbranch_scc1 L_poll_ffn2_20
L_polled_ffn2_21:
    v_mfma_f32_16x16x32_bf16 v[16:19], a[220:223], v[164:167], v[16:19]
    v_mfma_f32_16x16x32_bf16 v[20:23], a[224:227], v[164:167], v[20:23]
    v_mfma_f32_16x16x32_bf16 v[24:27], a[228:231], v[164:167], v[24:27]
    v_mfma_f32_16x16x32_bf16 v[28:31], a[232:235], v[164:167], v[28:31]
    v_mfma_f32_16x16x32_bf16 v[32:35], a[236:239], v[164:167], v[32:35]
    buffer_load_dwordx4 v[164:167], v11, s[12:15], s24 offen offset:0 sc1
    v_mfma_f32_16x16x32_bf16 v[36:39], a[220:223], v[168:171], v[36:39]
    v_mfma_f32_16x16x32_bf16 v[40:43], a[224:227], v[168:171], v[40:43]
    v_mfma_f32_16x16x32_bf16 v[44:47], a[228:231], v[168:171], v[44:47]
    v_mfma_f32_16x16x32_bf16 v[48:51], a[232:235], v[168:171], v[48:51]
    v_mfma_f32_16x16x32_bf16 v[52:55], a[236:239], v[168:171], v[52:55]
    buffer_load_dwordx4 v[168:171], v11, s[12:15], s25 offen offset:0 sc1
    v_mfma_f32_16x16x32_bf16 v[56:59], a[220:223], v[172:175], v[56:59]
    v_mfma_f32_16x16x32_bf16 v[60:63], a[224:227], v[172:175], v[60:63]
    v_mfma_f32_16x16x32_bf16 v[64:67], a[228:231], v[172:175], v[64:67]
    v_mfma_f32_16x16x32_bf16 v[68:71], a[232:235], v[172:175], v[68:71]
    v_mfma_f32_16x16x32_bf16 v[72:75], a[236:239], v[172:175], v[72:75]
    buffer_load_dwordx4 v[172:175], v11, s[12:15], s26 offen offset:0 sc1
    v_mfma_f32_16x16x32_bf16 v[76:79], a[220:223], v[176:179], v[76:79]
    v_mfma_f32_16x16x32_bf16 v[80:83], a[224:227], v[176:179], v[80:83]
    v_mfma_f32_16x16x32_bf16 v[84:87], a[228:231], v[176:179], v[84:87]
    v_mfma_f32_16x16x32_bf16 v[88:91], a[232:235], v[176:179], v[88:91]
    v_mfma_f32_16x16x32_bf16 v[92:95], a[236:239], v[176:179], v[92:95]
    buffer_load_dwordx4 v[176:179], v11, s[12:15], s27 offen offset:0 sc1
    v_mfma_f32_16x16x32_bf16 v[16:19], a[240:243], v[180:183], v[16:19]
    s_add_u32 s73, s16, 491520
    s_add_u32 m0, s17, 61440
    v_mfma_f32_16x16x32_bf16 v[20:23], a[244:247], v[180:183], v[20:23]
    v_mfma_f32_16x16x32_bf16 v[24:27], a[248:251], v[180:183], v[24:27]
    buffer_load_dwordx4 v10, s[12:15], s73 offen offset:0 sc1 lds
    v_mfma_f32_16x16x32_bf16 v[28:31], a[252:255], v[180:183], v[28:31]
    v_mfma_f32_16x16x32_bf16 v[32:35], a[0:3], v[180:183], v[32:35]
    s_add_u32 s24, s24, s18
    buffer_load_dwordx4 v[180:183], v11, s[12:15], s24 offen offset:1024 sc1
    v_mfma_f32_16x16x32_bf16 v[36:39], a[240:243], v[184:187], v[36:39]
    buffer_load_dwordx4 v10, s[12:15], s73 offen offset:1024 sc1 lds
    v_mfma_f32_16x16x32_bf16 v[40:43], a[244:247], v[184:187], v[40:43]
    v_mfma_f32_16x16x32_bf16 v[44:47], a[248:251], v[184:187], v[44:47]
    buffer_load_dwordx4 v10, s[12:15], s73 offen offset:2048 sc1 lds
    v_mfma_f32_16x16x32_bf16 v[48:51], a[252:255], v[184:187], v[48:51]
    v_mfma_f32_16x16x32_bf16 v[52:55], a[0:3], v[184:187], v[52:55]
    s_add_u32 s25, s25, s18
    buffer_load_dwordx4 v[184:187], v11, s[12:15], s25 offen offset:1024 sc1
    v_mfma_f32_16x16x32_bf16 v[56:59], a[240:243], v[188:191], v[56:59]
    ds_read_b128 a[164:167], v10 offset:0
    ds_read_b128 a[168:171], v10 offset:1024
    v_mfma_f32_16x16x32_bf16 v[60:63], a[244:247], v[188:191], v[60:63]
    v_mfma_f32_16x16x32_bf16 v[64:67], a[248:251], v[188:191], v[64:67]
    ds_read_b128 a[172:175], v10 offset:2048
    v_mfma_f32_16x16x32_bf16 v[68:71], a[252:255], v[188:191], v[68:71]
    v_mfma_f32_16x16x32_bf16 v[72:75], a[0:3], v[188:191], v[72:75]
    s_add_u32 s26, s26, s18
    buffer_load_dwordx4 v[188:191], v11, s[12:15], s26 offen offset:1024 sc1
    v_mfma_f32_16x16x32_bf16 v[76:79], a[240:243], v[192:195], v[76:79]
    v_mfma_f32_16x16x32_bf16 v[80:83], a[244:247], v[192:195], v[80:83]
    v_mfma_f32_16x16x32_bf16 v[84:87], a[248:251], v[192:195], v[84:87]
    v_mfma_f32_16x16x32_bf16 v[88:91], a[252:255], v[192:195], v[88:91]
    v_mfma_f32_16x16x32_bf16 v[92:95], a[0:3], v[192:195], v[92:95]
    s_add_u32 s27, s27, s18
    buffer_load_dwordx4 v[192:195], v11, s[12:15], s27 offen offset:1024 sc1
    v_mfma_f32_16x16x32_bf16 v[16:19], a[4:7], v[116:119], v[16:19]
    buffer_load_dwordx4 v10, s[12:15], s73 offen offset:3072 sc1 lds
    v_mfma_f32_16x16x32_bf16 v[20:23], a[8:11], v[116:119], v[20:23]
    v_mfma_f32_16x16x32_bf16 v[24:27], a[12:15], v[116:119], v[24:27]
    s_add_u32 m0, s17, 65536
    v_mfma_f32_16x16x32_bf16 v[28:31], a[16:19], v[116:119], v[28:31]
    v_mfma_f32_16x16x32_bf16 v[32:35], a[20:23], v[116:119], v[32:35]
    buffer_load_dwordx4 v[116:119], v11, s[12:15], s24 offen offset:2048 sc1
    v_mfma_f32_16x16x32_bf16 v[36:39], a[4:7], v[120:123], v[36:39]
    buffer_load_dwordx4 v11, s[12:15], s73 offen offset:0 sc1 lds
    v_mfma_f32_16x16x32_bf16 v[40:43], a[8:11], v[120:123], v[40:43]
    v_mfma_f32_16x16x32_bf16 v[44:47], a[12:15], v[120:123], v[44:47]
    ds_read_b128 a[176:179], v10 offset:3072
    ds_read_b128 a[180:183], v10 offset:4096
    v_mfma_f32_16x16x32_bf16 v[48:51], a[16:19], v[120:123], v[48:51]
    v_mfma_f32_16x16x32_bf16 v[52:55], a[20:23], v[120:123], v[52:55]
    buffer_load_dwordx4 v[120:123], v11, s[12:15], s25 offen offset:2048 sc1
    v_mfma_f32_16x16x32_bf16 v[56:59], a[4:7], v[124:127], v[56:59]
    ds_read_b128 a[184:187], v10 offset:5120
    v_mfma_f32_16x16x32_bf16 v[60:63], a[8:11], v[124:127], v[60:63]
    v_mfma_f32_16x16x32_bf16 v[64:67], a[12:15], v[124:127], v[64:67]
    v_mfma_f32_16x16x32_bf16 v[68:71], a[16:19], v[124:127], v[68:71]
    v_mfma_f32_16x16x32_bf16 v[72:75], a[20:23], v[124:127], v[72:75]
    buffer_load_dwordx4 v[124:127], v11, s[12:15], s26 offen offset:2048 sc1
    v_mfma_f32_16x16x32_bf16 v[76:79], a[4:7], v[128:131], v[76:79]
    v_mfma_f32_16x16x32_bf16 v[80:83], a[8:11], v[128:131], v[80:83]
    v_mfma_f32_16x16x32_bf16 v[84:87], a[12:15], v[128:131], v[84:87]
    v_mfma_f32_16x16x32_bf16 v[88:91], a[16:19], v[128:131], v[88:91]
    v_mfma_f32_16x16x32_bf16 v[92:95], a[20:23], v[128:131], v[92:95]
    buffer_load_dwordx4 v[128:131], v11, s[12:15], s27 offen offset:2048 sc1
    s_waitcnt vmcnt(25)
    v_mfma_f32_16x16x32_bf16 v[16:19], a[24:27], v[132:135], v[16:19]
    s_add_u32 s73, s16, 655360
    s_add_u32 m0, s17, 81920
    v_mfma_f32_16x16x32_bf16 v[20:23], a[28:31], v[132:135], v[20:23]
    v_mfma_f32_16x16x32_bf16 v[24:27], a[32:35], v[132:135], v[24:27]
    buffer_load_dwordx4 v10, s[12:15], s73 offen offset:0 sc1 lds
    v_mfma_f32_16x16x32_bf16 v[28:31], a[36:39], v[132:135], v[28:31]
    v_mfma_f32_16x16x32_bf16 v[32:35], a[40:43], v[132:135], v[32:35]
    buffer_load_dwordx4 v[132:135], v11, s[12:15], s28 offen offset:0 sc1
    s_waitcnt vmcnt(26)
    v_mfma_f32_16x16x32_bf16 v[36:39], a[24:27], v[136:139], v[36:39]
    buffer_load_dwordx4 v10, s[12:15], s73 offen offset:1024 sc1 lds
    v_mfma_f32_16x16x32_bf16 v[40:43], a[28:31], v[136:139], v[40:43]
    v_mfma_f32_16x16x32_bf16 v[44:47], a[32:35], v[136:139], v[44:47]
    buffer_load_dwordx4 v10, s[12:15], s73 offen offset:2048 sc1 lds
    v_mfma_f32_16x16x32_bf16 v[48:51], a[36:39], v[136:139], v[48:51]
    v_mfma_f32_16x16x32_bf16 v[52:55], a[40:43], v[136:139], v[52:55]
    buffer_load_dwordx4 v[136:139], v11, s[12:15], s29 offen offset:0 sc1
    s_waitcnt vmcnt(28)
    v_mfma_f32_16x16x32_bf16 v[56:59], a[24:27], v[140:143], v[56:59]
    ds_read_b128 a[188:191], v10 offset:6144
    ds_read_b128 a[192:195], v10 offset:7168
    v_mfma_f32_16x16x32_bf16 v[60:63], a[28:31], v[140:143], v[60:63]
    v_mfma_f32_16x16x32_bf16 v[64:67], a[32:35], v[140:143], v[64:67]
    ds_read_b128 a[196:199], v10 offset:8192
    v_mfma_f32_16x16x32_bf16 v[68:71], a[36:39], v[140:143], v[68:71]
    v_mfma_f32_16x16x32_bf16 v[72:75], a[40:43], v[140:143], v[72:75]
    buffer_load_dwordx4 v[140:143], v11, s[12:15], s30 offen offset:0 sc1
    s_waitcnt vmcnt(28)
    v_mfma_f32_16x16x32_bf16 v[76:79], a[24:27], v[144:147], v[76:79]
    v_mfma_f32_16x16x32_bf16 v[80:83], a[28:31], v[144:147], v[80:83]
    v_mfma_f32_16x16x32_bf16 v[84:87], a[32:35], v[144:147], v[84:87]
    v_mfma_f32_16x16x32_bf16 v[88:91], a[36:39], v[144:147], v[88:91]
    v_mfma_f32_16x16x32_bf16 v[92:95], a[40:43], v[144:147], v[92:95]
    buffer_load_dwordx4 v[144:147], v11, s[12:15], s31 offen offset:0 sc1
    s_waitcnt vmcnt(27)
    v_mfma_f32_16x16x32_bf16 v[16:19], a[44:47], v[148:151], v[16:19]
    buffer_load_dwordx4 v10, s[12:15], s73 offen offset:3072 sc1 lds
    v_mfma_f32_16x16x32_bf16 v[20:23], a[48:51], v[148:151], v[20:23]
    v_mfma_f32_16x16x32_bf16 v[24:27], a[52:55], v[148:151], v[24:27]
    s_add_u32 m0, s17, 86016
    v_mfma_f32_16x16x32_bf16 v[28:31], a[56:59], v[148:151], v[28:31]
    v_mfma_f32_16x16x32_bf16 v[32:35], a[60:63], v[148:151], v[32:35]
    buffer_load_dwordx4 v[148:151], v11, s[12:15], s28 offen offset:1024 sc1
    s_waitcnt vmcnt(28)
    v_mfma_f32_16x16x32_bf16 v[36:39], a[44:47], v[152:155], v[36:39]
    buffer_load_dwordx4 v11, s[12:15], s73 offen offset:0 sc1 lds
    v_mfma_f32_16x16x32_bf16 v[40:43], a[48:51], v[152:155], v[40:43]
    v_mfma_f32_16x16x32_bf16 v[44:47], a[52:55], v[152:155], v[44:47]
    buffer_load_dword v13, v222, s[12:15], 0 offen sc1
    v_mfma_f32_16x16x32_bf16 v[48:51], a[56:59], v[152:155], v[48:51]
    v_mfma_f32_16x16x32_bf16 v[52:55], a[60:63], v[152:155], v[52:55]
    buffer_load_dwordx4 v[152:155], v11, s[12:15], s29 offen offset:1024 sc1
    s_waitcnt vmcnt(30)
    v_mfma_f32_16x16x32_bf16 v[56:59], a[44:47], v[156:159], v[56:59]
    ds_read_b128 a[200:203], v10 offset:9216
    ds_read_b128 a[204:207], v10 offset:10240
    v_mfma_f32_16x16x32_bf16 v[60:63], a[48:51], v[156:159], v[60:63]
    v_mfma_f32_16x16x32_bf16 v[64:67], a[52:55], v[156:159], v[64:67]
    ds_read_b128 a[208:211], v10 offset:11264
    v_mfma_f32_16x16x32_bf16 v[68:71], a[56:59], v[156:159], v[68:71]
    v_mfma_f32_16x16x32_bf16 v[72:75], a[60:63], v[156:159], v[72:75]
    buffer_load_dwordx4 v[156:159], v11, s[12:15], s30 offen offset:1024 sc1
    s_waitcnt vmcnt(30)
    v_mfma_f32_16x16x32_bf16 v[76:79], a[44:47], v[160:163], v[76:79]
    v_mfma_f32_16x16x32_bf16 v[80:83], a[48:51], v[160:163], v[80:83]
    v_mfma_f32_16x16x32_bf16 v[84:87], a[52:55], v[160:163], v[84:87]
    v_mfma_f32_16x16x32_bf16 v[88:91], a[56:59], v[160:163], v[88:91]
    v_mfma_f32_16x16x32_bf16 v[92:95], a[60:63], v[160:163], v[92:95]
    buffer_load_dwordx4 v[160:163], v11, s[12:15], s31 offen offset:1024 sc1
    s_waitcnt vmcnt(30)
    v_mfma_f32_16x16x32_bf16 v[16:19], a[64:67], v[164:167], v[16:19]
    ds_read_b128 a[212:215], v10 offset:12288
    ds_read_b128 a[216:219], v10 offset:13312
    v_mfma_f32_16x16x32_bf16 v[20:23], a[68:71], v[164:167], v[20:23]
    v_mfma_f32_16x16x32_bf16 v[24:27], a[72:75], v[164:167], v[24:27]
    ds_read_b128 a[220:223], v10 offset:14336
    v_mfma_f32_16x16x32_bf16 v[28:31], a[76:79], v[164:167], v[28:31]
    v_mfma_f32_16x16x32_bf16 v[32:35], a[80:83], v[164:167], v[32:35]
    buffer_load_dwordx4 v[164:167], v11, s[12:15], s28 offen offset:2048 sc1
    s_waitcnt vmcnt(30)
    v_mfma_f32_16x16x32_bf16 v[36:39], a[64:67], v[168:171], v[36:39]
    v_mfma_f32_16x16x32_bf16 v[40:43], a[68:71], v[168:171], v[40:43]
    v_mfma_f32_16x16x32_bf16 v[44:47], a[72:75], v[168:171], v[44:47]
    v_mfma_f32_16x16x32_bf16 v[48:51], a[76:79], v[168:171], v[48:51]
    v_mfma_f32_16x16x32_bf16 v[52:55], a[80:83], v[168:171], v[52:55]
    buffer_load_dwordx4 v[168:171], v11, s[12:15], s29 offen offset:2048 sc1
    s_waitcnt vmcnt(30)
    v_mfma_f32_16x16x32_bf16 v[56:59], a[64:67], v[172:175], v[56:59]
    v_mfma_f32_16x16x32_bf16 v[60:63], a[68:71], v[172:175], v[60:63]
    v_mfma_f32_16x16x32_bf16 v[64:67], a[72:75], v[172:175], v[64:67]
    v_mfma_f32_16x16x32_bf16 v[68:71], a[76:79], v[172:175], v[68:71]
    v_mfma_f32_16x16x32_bf16 v[72:75], a[80:83], v[172:175], v[72:75]
    buffer_load_dwordx4 v[172:175], v11, s[12:15], s30 offen offset:2048 sc1
    s_waitcnt vmcnt(30)
    v_mfma_f32_16x16x32_bf16 v[76:79], a[64:67], v[176:179], v[76:79]
    v_mfma_f32_16x16x32_bf16 v[80:83], a[68:71], v[176:179], v[80:83]
    v_mfma_f32_16x16x32_bf16 v[84:87], a[72:75], v[176:179], v[84:87]
    v_mfma_f32_16x16x32_bf16 v[88:91], a[76:79], v[176:179], v[88:91]
    v_mfma_f32_16x16x32_bf16 v[92:95], a[80:83], v[176:179], v[92:95]
    buffer_load_dwordx4 v[176:179], v11, s[12:15], s31 offen offset:2048 sc1
    s_waitcnt vmcnt(7)
    v_cmp_ne_u32 vcc, s79, v13
    s_mov_b32 s78, 0
    s_nop 3
    s_cbranch_vccz L_polled_att_23
L_poll_att_22:
    s_sleep 1
    buffer_load_dword v13, v222, s[12:15], 0 offen sc1
    s_waitcnt vmcnt(0)
    v_cmp_ne_u32 vcc, s79, v13
    s_add_u32 s78, s78, 1
    s_nop 3
    s_cbranch_vccz L_polled_att_23
    s_cmp_lt_u32 s78, 0x40000
    s_cbranch_scc1 L_poll_att_22
L_polled_att_23:
    v_mfma_f32_16x16x32_bf16 v[16:19], a[84:87], v[180:183], v[16:19]
    ds_read_b128 a[224:227], v10 offset:15360
    ds_read_b128 a[228:231], v10 offset:16384
    v_mfma_f32_16x16x32_bf16 v[20:23], a[88:91], v[180:183], v[20:23]
    v_mfma_f32_16x16x32_bf16 v[24:27], a[92:95], v[180:183], v[24:27]
    ds_read_b128 a[232:235], v10 offset:17408
    v_mfma_f32_16x16x32_bf16 v[28:31], a[96:99], v[180:183], v[28:31]
    v_mfma_f32_16x16x32_bf16 v[32:35], a[100:103], v[180:183], v[32:35]
    v_mfma_f32_16x16x32_bf16 v[36:39], a[84:87], v[184:187], v[36:39]
    buffer_load_dwordx4 a[240:243], v10, s[12:15], s36 offen offset:0 sc1
    v_mfma_f32_16x16x32_bf16 v[40:43], a[88:91], v[184:187], v[40:43]
    v_mfma_f32_16x16x32_bf16 v[44:47], a[92:95], v[184:187], v[44:47]
    buffer_load_dwordx4 a[244:247], v10, s[12:15], s36 offen offset:1024 sc1
    v_mfma_f32_16x16x32_bf16 v[48:51], a[96:99], v[184:187], v[48:51]
    v_mfma_f32_16x16x32_bf16 v[52:55], a[100:103], v[184:187], v[52:55]
    v_mfma_f32_16x16x32_bf16 v[56:59], a[84:87], v[188:191], v[56:59]
    buffer_load_dwordx4 a[248:251], v10, s[12:15], s36 offen offset:2048 sc1
    v_mfma_f32_16x16x32_bf16 v[60:63], a[88:91], v[188:191], v[60:63]
    v_mfma_f32_16x16x32_bf16 v[64:67], a[92:95], v[188:191], v[64:67]
    v_mfma_f32_16x16x32_bf16 v[68:71], a[96:99], v[188:191], v[68:71]
    v_mfma_f32_16x16x32_bf16 v[72:75], a[100:103], v[188:191], v[72:75]
    v_mfma_f32_16x16x32_bf16 v[76:79], a[84:87], v[192:195], v[76:79]
    v_mfma_f32_16x16x32_bf16 v[80:83], a[88:91], v[192:195], v[80:83]
    v_mfma_f32_16x16x32_bf16 v[84:87], a[92:95], v[192:195], v[84:87]
    v_mfma_f32_16x16x32_bf16 v[88:91], a[96:99], v[192:195], v[88:91]
    v_mfma_f32_16x16x32_bf16 v[92:95], a[100:103], v[192:195], v[92:95]
    v_mfma_f32_16x16x32_bf16 v[16:19], a[104:107], v[116:119], v[16:19]
    ds_read_b128 a[236:239], v10 offset:18432
    v_mfma_f32_16x16x32_bf16 v[20:23], a[108:111], v[116:119], v[20:23]
    v_mfma_f32_16x16x32_bf16 v[24:27], a[112:115], v[116:119], v[24:27]
    buffer_load_dwordx4 a[252:255], v10, s[12:15], s36 offen offset:3072 sc1
    v_mfma_f32_16x16x32_bf16 v[28:31], a[116:119], v[116:119], v[28:31]
    v_mfma_f32_16x16x32_bf16 v[32:35], a[120:123], v[116:119], v[32:35]
    v_mfma_f32_16x16x32_bf16 v[36:39], a[104:107], v[120:123], v[36:39]
    buffer_load_dwordx2 v[208:209], v221, s[56:59], 0 offen offset:0
    v_mfma_f32_16x16x32_bf16 v[40:43], a[108:111], v[120:123], v[40:43]
    v_mfma_f32_16x16x32_bf16 v[44:47], a[112:115], v[120:123], v[44:47]
    buffer_load_dwordx2 v[210:211], v221, s[56:59], 0 offen offset:32
    v_mfma_f32_16x16x32_bf16 v[48:51], a[116:119], v[120:123], v[48:51]
    v_mfma_f32_16x16x32_bf16 v[52:55], a[120:123], v[120:123], v[52:55]
    v_mfma_f32_16x16x32_bf16 v[56:59], a[104:107], v[124:127], v[56:59]
    buffer_load_dwordx2 v[212:213], v221, s[56:59], 0 offen offset:64
    v_mfma_f32_16x16x32_bf16 v[60:63], a[108:111], v[124:127], v[60:63]
    v_mfma_f32_16x16x32_bf16 v[64:67], a[112:115], v[124:127], v[64:67]
    v_mfma_f32_16x16x32_bf16 v[68:71], a[116:119], v[124:127], v[68:71]
    v_mfma_f32_16x16x32_bf16 v[72:75], a[120:123], v[124:127], v[72:75]
    v_mfma_f32_16x16x32_bf16 v[76:79], a[104:107], v[128:131], v[76:79]
    v_mfma_f32_16x16x32_bf16 v[80:83], a[108:111], v[128:131], v[80:83]
    v_mfma_f32_16x16x32_bf16 v[84:87], a[112:115], v[128:131], v[84:87]
    v_mfma_f32_16x16x32_bf16 v[88:91], a[116:119], v[128:131], v[88:91]
    v_mfma_f32_16x16x32_bf16 v[92:95], a[120:123], v[128:131], v[92:95]
    v_mfma_f32_16x16x32_bf16 v[16:19], a[124:127], v[132:135], v[16:19]
    buffer_load_dwordx2 v[214:215], v221, s[56:59], 0 offen offset:96
    v_mfma_f32_16x16x32_bf16 v[20:23], a[128:131], v[132:135], v[20:23]
    v_mfma_f32_16x16x32_bf16 v[24:27], a[132:135], v[132:135], v[24:27]
    ds_read_b128 a[64:67], v10 offset:19456
    v_mfma_f32_16x16x32_bf16 v[28:31], a[136:139], v[132:135], v[28:31]
    v_mfma_f32_16x16x32_bf16 v[32:35], a[140:143], v[132:135], v[32:35]
    buffer_load_dwordx2 v[216:217], v221, s[56:59], 0 offen offset:128
    v_mfma_f32_16x16x32_bf16 v[16:19], a[144:147], v[148:151], v[16:19]
    v_mfma_f32_16x16x32_bf16 v[20:23], a[148:151], v[148:151], v[20:23]
    ds_read_b128 a[68:71], v10 offset:20480
    v_mfma_f32_16x16x32_bf16 v[24:27], a[152:155], v[148:151], v[24:27]
    v_mfma_f32_16x16x32_bf16 v[28:31], a[156:159], v[148:151], v[28:31]
    buffer_load_dwordx4 a[0:3], v11, s[12:15], s36 offen offset:0 sc1
    v_mfma_f32_16x16x32_bf16 v[32:35], v[228:231], v[148:151], v[32:35]
    s_waitcnt vmcnt(13)
    v_mfma_f32_16x16x32_bf16 v[16:19], v[232:235], v[164:167], v[16:19]
    ds_read_b128 a[72:75], v10 offset:21504
    v_mfma_f32_16x16x32_bf16 v[20:23], v[236:239], v[164:167], v[20:23]
    v_mfma_f32_16x16x32_bf16 v[24:27], v[240:243], v[164:167], v[24:27]
    buffer_load_dwordx4 a[4:7], v11, s[12:15], s36 offen offset:1024 sc1
    v_mfma_f32_16x16x32_bf16 v[28:31], v[244:247], v[164:167], v[28:31]
    v_mfma_f32_16x16x32_bf16 v[32:35], a[160:163], v[164:167], v[32:35]
    ds_read_b128 a[76:79], v10 offset:22528
    v_mfma_f32_16x16x32_bf16 v[36:39], a[124:127], v[136:139], v[36:39]
    v_mfma_f32_16x16x32_bf16 v[40:43], a[128:131], v[136:139], v[40:43]
    buffer_load_dwordx4 a[8:11], v11, s[12:15], s36 offen offset:2048 sc1
    v_mfma_f32_16x16x32_bf16 v[44:47], a[132:135], v[136:139], v[44:47]
    v_mfma_f32_16x16x32_bf16 v[48:51], a[136:139], v[136:139], v[48:51]
    ds_write_b128 v5, v[16:19] offset:0
    v_mfma_f32_16x16x32_bf16 v[52:55], a[140:143], v[136:139], v[52:55]
    v_mfma_f32_16x16x32_bf16 v[36:39], a[144:147], v[152:155], v[36:39]
    ds_write_b128 v5, v[20:23] offset:1024
    v_mfma_f32_16x16x32_bf16 v[40:43], a[148:151], v[152:155], v[40:43]
    v_mfma_f32_16x16x32_bf16 v[44:47], a[152:155], v[152:155], v[44:47]
    ds_write_b128 v5, v[24:27] offset:2048
    v_mfma_f32_16x16x32_bf16 v[48:51], a[156:159], v[152:155], v[48:51]
    v_mfma_f32_16x16x32_bf16 v[52:55], v[228:231], v[152:155], v[52:55]
    ds_write_b128 v5, v[28:31] offset:3072
    s_waitcnt vmcnt(14)
    v_mfma_f32_16x16x32_bf16 v[36:39], v[232:235], v[168:171], v[36:39]
    v_mfma_f32_16x16x32_bf16 v[40:43], v[236:239], v[168:171], v[40:43]
    ds_write_b128 v5, v[32:35] offset:4096
    v_mfma_f32_16x16x32_bf16 v[44:47], v[240:243], v[168:171], v[44:47]
    v_mfma_f32_16x16x32_bf16 v[48:51], v[244:247], v[168:171], v[48:51]
    buffer_load_dwordx4 a[12:15], v11, s[12:15], s36 offen offset:3072 sc1
    v_mfma_f32_16x16x32_bf16 v[52:55], a[160:163], v[168:171], v[52:55]
    v_mfma_f32_16x16x32_bf16 v[56:59], a[124:127], v[140:143], v[56:59]
    ds_read_b128 a[80:83], v10 offset:23552
    v_mfma_f32_16x16x32_bf16 v[60:63], a[128:131], v[140:143], v[60:63]
    v_mfma_f32_16x16x32_bf16 v[64:67], a[132:135], v[140:143], v[64:67]
    s_add_u32 s36, s36, 8192
    v_mfma_f32_16x16x32_bf16 v[68:71], a[136:139], v[140:143], v[68:71]
    ds_write_b128 v8, v[36:39] offset:5120
    v_mfma_f32_16x16x32_bf16 v[72:75], a[140:143], v[140:143], v[72:75]
    ds_read_b128 a[84:87], v10 offset:24576
    v_mfma_f32_16x16x32_bf16 v[56:59], a[144:147], v[156:159], v[56:59]
    ds_write_b128 v8, v[40:43] offset:6144
    v_mfma_f32_16x16x32_bf16 v[60:63], a[148:151], v[156:159], v[60:63]
    buffer_load_dwordx4 a[16:19], v10, s[12:15], s36 offen offset:0 sc1
    v_mfma_f32_16x16x32_bf16 v[64:67], a[152:155], v[156:159], v[64:67]
    ds_write_b128 v8, v[44:47] offset:7168
    v_mfma_f32_16x16x32_bf16 v[68:71], a[156:159], v[156:159], v[68:71]
    ds_read_b128 a[88:91], v10 offset:25600
    v_mfma_f32_16x16x32_bf16 v[72:75], v[228:231], v[156:159], v[72:75]
    ds_write_b128 v8, v[48:51] offset:8192
    s_waitcnt vmcnt(15)
    v_mfma_f32_16x16x32_bf16 v[56:59], v[232:235], v[172:175], v[56:59]
    buffer_load_dwordx4 a[20:23], v10, s[12:15], s36 offen offset:1024 sc1
    v_mfma_f32_16x16x32_bf16 v[60:63], v[236:239], v[172:175], v[60:63]
    ds_write_b128 v8, v[52:55] offset:9216
    v_mfma_f32_16x16x32_bf16 v[64:67], v[240:243], v[172:175], v[64:67]
    ds_read_b128 a[92:95], v10 offset:26624
    v_mfma_f32_16x16x32_bf16 v[68:71], v[244:247], v[172:175], v[68:71]
    v_mfma_f32_16x16x32_bf16 v[72:75], a[160:163], v[172:175], v[72:75]
    buffer_load_dwordx4 a[24:27], v10, s[12:15], s36 offen offset:2048 sc1
    v_mfma_f32_16x16x32_bf16 v[76:79], a[124:127], v[144:147], v[76:79]
    v_mfma_f32_16x16x32_bf16 v[80:83], a[128:131], v[144:147], v[80:83]
    ds_read_b128 a[96:99], v10 offset:27648
    v_mfma_f32_16x16x32_bf16 v[84:87], a[132:135], v[144:147], v[84:87]
    v_mfma_f32_16x16x32_bf16 v[88:91], a[136:139], v[144:147], v[88:91]
    ds_write_b128 v9, v[56:59] offset:10240
    v_mfma_f32_16x16x32_bf16 v[92:95], a[140:143], v[144:147], v[92:95]
    v_mfma_f32_16x16x32_bf16 v[76:79], a[144:147], v[160:163], v[76:79]
    ds_write_b128 v9, v[60:63] offset:11264
    v_mfma_f32_16x16x32_bf16 v[80:83], a[148:151], v[160:163], v[80:83]
    v_mfma_f32_16x16x32_bf16 v[84:87], a[152:155], v[160:163], v[84:87]
    ds_write_b128 v9, v[64:67] offset:12288
    v_mfma_f32_16x16x32_bf16 v[88:91], a[156:159], v[160:163], v[88:91]
    v_mfma_f32_16x16x32_bf16 v[92:95], v[228:231], v[160:163], v[92:95]
    ds_write_b128 v9, v[68:71] offset:13312
    s_waitcnt vmcnt(16)
    v_mfma_f32_16x16x32_bf16 v[76:79], v[232:235], v[176:179], v[76:79]
    v_mfma_f32_16x16x32_bf16 v[80:83], v[236:239], v[176:179], v[80:83]
    ds_write_b128 v9, v[72:75] offset:14336
    v_mfma_f32_16x16x32_bf16 v[84:87], v[240:243], v[176:179], v[84:87]
    v_mfma_f32_16x16x32_bf16 v[88:91], v[244:247], v[176:179], v[88:91]
    v_mfma_f32_16x16x32_bf16 v[92:95], a[160:163], v[176:179], v[92:95]
    buffer_load_dwordx4 a[28:31], v10, s[12:15], s36 offen offset:3072 sc1
    s_waitcnt lgkmcnt(0)
    s_barrier
    ds_read_b128 v[136:139], v223 offset:0
    ds_read_b128 v[140:143], v223 offset:1024
    ds_read_b128 v[144:147], v223 offset:2048
    ds_read_b128 v[148:151], v223 offset:3072
    ds_read_b128 v[152:155], v223 offset:4096
    ds_read_b128 v[156:159], v223 offset:5120
    ds_read_b128 v[160:163], v223 offset:6144
    ds_read_b128 v[164:167], v223 offset:7168
    ds_read_b128 v[168:171], v223 offset:8192
    ds_read_b128 v[172:175], v223 offset:9216
    ds_read_b128 v[176:179], v223 offset:10240
    ds_read_b128 v[180:183], v223 offset:11264
    ds_read_b128 v[184:187], v223 offset:12288
    ds_read_b128 v[188:191], v223 offset:13312
    ds_read_b128 v[192:195], v223 offset:14336
    s_waitcnt vmcnt(16)
    v_mfma_f32_16x16x32_bf16 v[96:99], a[164:167], a[240:243], 0
    s_waitcnt lgkmcnt(14)
    v_pk_add_f32 v[76:77], v[76:77], v[136:137]
    v_pk_add_f32 v[78:79], v[78:79], v[138:139]
    s_waitcnt lgkmcnt(13)
    v_pk_add_f32 v[80:81], v[80:81], v[140:141]
    v_mfma_f32_16x16x32_bf16 v[100:103], a[168:171], a[240:243], 0
    buffer_load_dwordx4 a[32:35], v11, s[12:15], s36 offen offset:0 sc1
    v_pk_add_f32 v[82:83], v[82:83], v[142:143]
    s_waitcnt lgkmcnt(12)
    v_pk_add_f32 v[84:85], v[84:85], v[144:145]
    v_pk_add_f32 v[86:87], v[86:87], v[146:147]
    v_mfma_f32_16x16x32_bf16 v[104:107], a[172:175], a[240:243], 0
    s_waitcnt lgkmcnt(11)
    v_pk_add_f32 v[88:89], v[88:89], v[148:149]
    v_pk_add_f32 v[90:91], v[90:91], v[150:151]
    v_mfma_f32_16x16x32_bf16 v[108:111], a[176:179], a[240:243], 0
    buffer_load_dwordx4 a[36:39], v11, s[12:15], s36 offen offset:1024 sc1
    s_waitcnt lgkmcnt(10)
    v_pk_add_f32 v[92:93], v[92:93], v[152:153]
    v_pk_add_f32 v[94:95], v[94:95], v[154:155]
    s_waitcnt lgkmcnt(9)
    v_pk_add_f32 v[76:77], v[76:77], v[156:157]
    v_mfma_f32_16x16x32_bf16 v[112:115], a[180:183], a[240:243], 0
    v_pk_add_f32 v[78:79], v[78:79], v[158:159]
    s_waitcnt lgkmcnt(8)
    v_pk_add_f32 v[80:81], v[80:81], v[160:161]
    v_pk_add_f32 v[82:83], v[82:83], v[162:163]
    s_waitcnt vmcnt(17)
    v_mfma_f32_16x16x32_bf16 v[96:99], a[184:187], a[244:247], v[96:99]
    buffer_load_dwordx4 a[40:43], v11, s[12:15], s36 offen offset:2048 sc1
    s_waitcnt lgkmcnt(7)
    v_pk_add_f32 v[84:85], v[84:85], v[164:165]
    v_pk_add_f32 v[86:87], v[86:87], v[166:167]
    v_mfma_f32_16x16x32_bf16 v[100:103], a[188:191], a[244:247], v[100:103]
    s_waitcnt lgkmcnt(6)
    v_pk_add_f32 v[88:89], v[88:89], v[168:169]
    v_pk_add_f32 v[90:91], v[90:91], v[170:171]
    s_waitcnt lgkmcnt(5)
    v_pk_add_f32 v[92:93], v[92:93], v[172:173]
    v_mfma_f32_16x16x32_bf16 v[104:107], a[192:195], a[244:247], v[104:107]
    buffer_load_dwordx4 a[44:47], v11, s[12:15], s36 offen offset:3072 sc1
    v_pk_add_f32 v[94:95], v[94:95], v[174:175]
    s_waitcnt lgkmcnt(4)
    v_pk_add_f32 v[76:77], v[76:77], v[176:177]
    v_pk_add_f32 v[78:79], v[78:79], v[178:179]
    v_mfma_f32_16x16x32_bf16 v[108:111], a[196:199], a[244:247], v[108:111]
    s_waitcnt lgkmcnt(3)
    v_pk_add_f32 v[80:81], v[80:81], v[180:181]
    v_pk_add_f32 v[82:83], v[82:83], v[182:183]
    v_mfma_f32_16x16x32_bf16 v[112:115], a[200:203], a[244:247], v[112:115]
    s_add_u32 s36, s36, 8192
    s_waitcnt lgkmcnt(2)
    v_pk_add_f32 v[84:85], v[84:85], v[184:185]
    v_pk_add_f32 v[86:87], v[86:87], v[186:187]
    s_waitcnt lgkmcnt(1)
    v_pk_add_f32 v[88:89], v[88:89], v[188:189]
    s_waitcnt vmcnt(18)
    v_mfma_f32_16x16x32_bf16 v[96:99], a[204:207], a[248:251], v[96:99]
    v_pk_add_f32 v[90:91], v[90:91], v[190:191]
    s_waitcnt lgkmcnt(0)
    v_pk_add_f32 v[92:93], v[92:93], v[192:193]
    v_pk_add_f32 v[94:95], v[94:95], v[194:195]
    v_mfma_f32_16x16x32_bf16 v[100:103], a[208:211], a[248:251], v[100:103]
    buffer_load_dwordx4 a[48:51], v10, s[12:15], s36 offen offset:0 sc1
    v_cvt_pk_bf16_f32 v136, v76, v77
    v_cvt_pk_bf16_f32 v138, v78, v79
    v_mfma_f32_16x16x32_bf16 v[104:107], a[212:215], a[248:251], v[104:107]
    v_cvt_pk_bf16_f32 v140, v80, v81
    v_cvt_pk_bf16_f32 v142, v82, v83
    v_cvt_pk_bf16_f32 v144, v84, v85
    v_mfma_f32_16x16x32_bf16 v[108:111], a[216:219], a[248:251], v[108:111]
    buffer_load_dwordx4 a[52:55], v10, s[12:15], s36 offen offset:1024 sc1
    v_cvt_pk_bf16_f32 v146, v86, v87
    v_cvt_pk_bf16_f32 v148, v88, v89
    v_mfma_f32_16x16x32_bf16 v[112:115], a[220:223], a[248:251], v[112:115]
    v_cvt_pk_bf16_f32 v150, v90, v91
    v_cvt_pk_bf16_f32 v152, v92, v93
    v_cvt_pk_bf16_f32 v154, v94, v95
    s_waitcnt vmcnt(19)
    v_mfma_f32_16x16x32_bf16 v[96:99], a[224:227], a[252:255], v[96:99]
    buffer_load_dwordx4 a[56:59], v10, s[12:15], s36 offen offset:2048 sc1
    v_lshlrev_b32 v76, 16, v136
    v_lshlrev_b32 v78, 16, v138
    v_lshlrev_b32 v80, 16, v140
    v_mfma_f32_16x16x32_bf16 v[100:103], a[228:231], a[252:255], v[100:103]
    v_lshlrev_b32 v82, 16, v142
    v_lshlrev_b32 v84, 16, v144
    v_mfma_f32_16x16x32_bf16 v[104:107], a[232:235], a[252:255], v[104:107]
    ds_read_b128 v[16:19], v10 offset:28672
    buffer_load_dwordx4 a[60:63], v10, s[12:15], s36 offen offset:3072 sc1
    v_lshlrev_b32 v86, 16, v146
    v_lshlrev_b32 v88, 16, v148
    v_lshlrev_b32 v90, 16, v150
    v_mfma_f32_16x16x32_bf16 v[108:111], a[236:239], a[252:255], v[108:111]
    ds_read_b128 v[20:23], v10 offset:29696
    v_lshlrev_b32 v92, 16, v152
    v_lshlrev_b32 v94, 16, v154
    v_and_b32 v77, s40, v136
    v_mfma_f32_16x16x32_bf16 v[112:115], a[64:67], a[252:255], v[112:115]
    ds_read_b128 v[24:27], v10 offset:30720
    buffer_load_dwordx4 v[196:199], v2, s[4:7], 0 offen
    v_and_b32 v79, s40, v138
    v_and_b32 v81, s40, v140
    s_waitcnt vmcnt(16)
    v_mfma_f32_16x16x32_bf16 v[96:99], a[68:71], a[0:3], v[96:99]
    ds_read_b128 v[28:31], v10 offset:31744
    v_and_b32 v83, s40, v142
    v_and_b32 v85, s40, v144
    v_and_b32 v87, s40, v146
    v_mfma_f32_16x16x32_bf16 v[100:103], a[72:75], a[0:3], v[100:103]
    ds_read_b128 v[32:35], v10 offset:32768
    buffer_load_dwordx4 v[200:203], v3, s[4:7], 0 offen
    v_and_b32 v89, s40, v148
    v_and_b32 v91, s40, v150
    v_and_b32 v93, s40, v152
    v_mfma_f32_16x16x32_bf16 v[104:107], a[76:79], a[0:3], v[104:107]
    ds_read_b128 v[36:39], v10 offset:33792
    v_and_b32 v95, s40, v154
    v_lshlrev_b32 v136, 16, v208
    v_mfma_f32_16x16x32_bf16 v[108:111], a[80:83], a[0:3], v[108:111]
    ds_read_b128 v[40:43], v10 offset:34816
    buffer_load_dwordx4 v[204:207], v4, s[4:7], 0 offen
    v_lshlrev_b32 v138, 16, v209
    v_lshlrev_b32 v140, 16, v210
    v_lshlrev_b32 v142, 16, v211
    v_mfma_f32_16x16x32_bf16 v[112:115], a[84:87], a[0:3], v[112:115]
    ds_read_b128 v[44:47], v10 offset:35840
    v_lshlrev_b32 v144, 16, v212
    v_lshlrev_b32 v146, 16, v213
    s_waitcnt vmcnt(17)
    v_mfma_f32_16x16x32_bf16 v[96:99], a[88:91], a[4:7], v[96:99]
    ds_read_b128 v[48:51], v10 offset:36864
    v_lshlrev_b32 v148, 16, v214
    v_lshlrev_b32 v150, 16, v215
    v_lshlrev_b32 v152, 16, v216
    v_mfma_f32_16x16x32_bf16 v[100:103], a[92:95], a[4:7], v[100:103]
    ds_read_b128 v[52:55], v10 offset:37888
    v_lshlrev_b32 v154, 16, v217
    v_and_b32 v137, s40, v208
    v_and_b32 v139, s40, v209
    s_waitcnt lgkmcnt(8)
    v_mfma_f32_16x16x32_bf16 v[104:107], a[96:99], a[4:7], v[104:107]
    ds_read_b128 v[56:59], v10 offset:38912
    v_and_b32 v141, s40, v210
    v_and_b32 v143, s40, v211
    v_mfma_f32_16x16x32_bf16 v[108:111], v[16:19], a[4:7], v[108:111]
    ds_read_b128 v[60:63], v10 offset:39936
    v_and_b32 v145, s40, v212
    v_and_b32 v147, s40, v213
    v_and_b32 v149, s40, v214
    v_mfma_f32_16x16x32_bf16 v[112:115], v[20:23], a[4:7], v[112:115]
    ds_read_b128 v[64:67], v10 offset:40960
    v_and_b32 v151, s40, v215
    v_and_b32 v153, s40, v216
    v_and_b32 v155, s40, v217
    s_waitcnt lgkmcnt(8)
    s_waitcnt vmcnt(16)
    v_mfma_f32_16x16x32_bf16 v[96:99], v[24:27], a[8:11], v[96:99]
    ds_read_b128 v[68:71], v10 offset:41984
    v_pk_add_f32 v[76:77], v[76:77], v[136:137]
    v_pk_add_f32 v[78:79], v[78:79], v[138:139]
    v_mfma_f32_16x16x32_bf16 v[100:103], v[28:31], a[8:11], v[100:103]
    ds_read_b128 v[16:19], v10 offset:43008
    v_pk_add_f32 v[80:81], v[80:81], v[140:141]
    v_pk_add_f32 v[82:83], v[82:83], v[142:143]
    v_pk_add_f32 v[84:85], v[84:85], v[144:145]
    v_mfma_f32_16x16x32_bf16 v[104:107], v[32:35], a[8:11], v[104:107]
    ds_read_b128 v[20:23], v10 offset:44032
    v_pk_add_f32 v[86:87], v[86:87], v[146:147]
    v_pk_add_f32 v[88:89], v[88:89], v[148:149]
    v_pk_add_f32 v[90:91], v[90:91], v[150:151]
    s_waitcnt lgkmcnt(8)
    v_mfma_f32_16x16x32_bf16 v[108:111], v[36:39], a[8:11], v[108:111]
    ds_read_b128 v[24:27], v10 offset:45056
    v_pk_add_f32 v[92:93], v[92:93], v[152:153]
    v_pk_add_f32 v[94:95], v[94:95], v[154:155]
    v_mfma_f32_16x16x32_bf16 v[112:115], v[40:43], a[8:11], v[112:115]
    ds_read_b128 v[28:31], v10 offset:46080
    v_cvt_pk_bf16_f32 v136, v76, v77
    v_cvt_pk_bf16_f32 v138, v78, v79
    v_cvt_pk_bf16_f32 v140, v80, v81
    s_waitcnt vmcnt(15)
    v_mfma_f32_16x16x32_bf16 v[96:99], v[44:47], a[12:15], v[96:99]
    ds_read_b128 v[32:35], v10 offset:47104
    v_cvt_pk_bf16_f32 v142, v82, v83
    v_cvt_pk_bf16_f32 v144, v84, v85
    v_cvt_pk_bf16_f32 v146, v86, v87
    s_waitcnt lgkmcnt(8)
    v_mfma_f32_16x16x32_bf16 v[100:103], v[48:51], a[12:15], v[100:103]
    ds_read_b128 v[36:39], v10 offset:48128
    v_cvt_pk_bf16_f32 v148, v88, v89
    v_cvt_pk_bf16_f32 v150, v90, v91
    v_mfma_f32_16x16x32_bf16 v[104:107], v[52:55], a[12:15], v[104:107]
    ds_read_b128 v[40:43], v10 offset:49152
    v_cvt_pk_bf16_f32 v152, v92, v93
    v_cvt_pk_bf16_f32 v154, v94, v95
    v_lshlrev_b32 v76, 16, v136
    v_mfma_f32_16x16x32_bf16 v[108:111], v[56:59], a[12:15], v[108:111]
    ds_read_b128 v[44:47], v10 offset:50176
    v_lshlrev_b32 v78, 16, v138
    v_lshlrev_b32 v80, 16, v140
    s_waitcnt lgkmcnt(8)
    v_mfma_f32_16x16x32_bf16 v[112:115], v[60:63], a[12:15], v[112:115]
    ds_read_b128 v[48:51], v10 offset:51200
    v_lshlrev_b32 v82, 16, v142
    v_lshlrev_b32 v84, 16, v144
    v_lshlrev_b32 v86, 16, v146
    s_waitcnt vmcnt(14)
    v_mfma_f32_16x16x32_bf16 v[96:99], v[64:67], a[16:19], v[96:99]
    ds_read_b128 v[52:55], v10 offset:52224
    v_lshlrev_b32 v88, 16, v148
    v_lshlrev_b32 v90, 16, v150
    v_lshlrev_b32 v92, 16, v152
    v_mfma_f32_16x16x32_bf16 v[100:103], v[68:71], a[16:19], v[100:103]
    ds_read_b128 v[56:59], v10 offset:53248
    v_lshlrev_b32 v94, 16, v154
    v_and_b32 v77, s40, v136
    s_waitcnt lgkmcnt(8)
    v_mfma_f32_16x16x32_bf16 v[104:107], v[16:19], a[16:19], v[104:107]
    ds_read_b128 v[60:63], v10 offset:54272
    v_and_b32 v79, s40, v138
    v_and_b32 v81, s40, v140
    v_and_b32 v83, s40, v142
    v_mfma_f32_16x16x32_bf16 v[108:111], v[20:23], a[16:19], v[108:111]
    ds_read_b128 v[64:67], v10 offset:55296
    v_and_b32 v85, s40, v144
    v_and_b32 v87, s40, v146
    v_and_b32 v89, s40, v148
    v_mfma_f32_16x16x32_bf16 v[112:115], v[24:27], a[16:19], v[112:115]
    ds_read_b128 v[68:71], v10 offset:56320
    v_and_b32 v91, s40, v150
    v_and_b32 v93, s40, v152
    s_waitcnt lgkmcnt(8)
    s_waitcnt vmcnt(13)
    v_mfma_f32_16x16x32_bf16 v[96:99], v[28:31], a[20:23], v[96:99]
    ds_read_b128 v[16:19], v10 offset:57344
    v_and_b32 v95, s40, v154
    v_mul_f32 v136, s41, v76
    v_mul_f32 v138, s41, v78
    v_mfma_f32_16x16x32_bf16 v[100:103], v[32:35], a[20:23], v[100:103]
    ds_read_b128 v[20:23], v10 offset:58368
    v_mul_f32 v140, s41, v80
    v_mul_f32 v142, s41, v82
    v_mul_f32 v144, s41, v84
    v_mfma_f32_16x16x32_bf16 v[104:107], v[36:39], a[20:23], v[104:107]
    ds_read_b128 v[24:27], v10 offset:59392
    v_mul_f32 v146, s41, v86
    v_mul_f32 v148, s41, v88
    s_waitcnt lgkmcnt(8)
    v_mfma_f32_16x16x32_bf16 v[108:111], v[40:43], a[20:23], v[108:111]
    ds_read_b128 v[28:31], v10 offset:60416
    v_mul_f32 v150, s41, v90
    v_mul_f32 v152, s41, v92
    v_mul_f32 v154, s41, v94
    v_mfma_f32_16x16x32_bf16 v[112:115], v[44:47], a[20:23], v[112:115]
    ds_read_b128 v[32:35], v10 offset:61440
    v_mul_f32 v137, s41, v77
    v_mul_f32 v139, s41, v79
    s_waitcnt vmcnt(12)
    v_mfma_f32_16x16x32_bf16 v[96:99], v[48:51], a[24:27], v[96:99]
    ds_read_b128 v[36:39], v10 offset:62464
    v_mul_f32 v141, s41, v81
    v_mul_f32 v143, s41, v83
    v_mul_f32 v145, s41, v85
    s_waitcnt lgkmcnt(8)
    v_mfma_f32_16x16x32_bf16 v[100:103], v[52:55], a[24:27], v[100:103]
    ds_read_b128 v[40:43], v10 offset:63488
    v_mul_f32 v147, s41, v87
    v_mul_f32 v149, s41, v89
    v_mul_f32 v151, s41, v91
    v_mfma_f32_16x16x32_bf16 v[104:107], v[56:59], a[24:27], v[104:107]
    ds_read_b128 v[44:47], v10 offset:64512
    v_mul_f32 v153, s41, v93
    v_mul_f32 v155, s41, v95
    v_mfma_f32_16x16x32_bf16 v[108:111], v[60:63], a[24:27], v[108:111]
    ds_read_b128 v[48:51], v225 offset:0
    v_exp_f32 v136, v136
    v_exp_f32 v138, v138
    v_exp_f32 v140, v140
    s_waitcnt lgkmcnt(8)
    v_mfma_f32_16x16x32_bf16 v[112:115], v[64:67], a[24:27], v[112:115]
    ds_read_b128 v[52:55], v225 offset:1024
    v_exp_f32 v142, v142
    v_exp_f32 v144, v144
    v_exp_f32 v146, v146
    s_waitcnt vmcnt(11)
    v_mfma_f32_16x16x32_bf16 v[96:99], v[68:71], a[28:31], v[96:99]
    ds_read_b128 v[56:59], v225 offset:2048
    v_exp_f32 v148, v148
    v_exp_f32 v150, v150
    v_mfma_f32_16x16x32_bf16 v[100:103], v[16:19], a[28:31], v[100:103]
    ds_read_b128 v[60:63], v225 offset:3072
    v_exp_f32 v152, v152
    v_exp_f32 v154, v154
    v_exp_f32 v137, v137
    s_waitcnt lgkmcnt(8)
    v_mfma_f32_16x16x32_bf16 v[104:107], v[20:23], a[28:31], v[104:107]
    ds_read_b128 v[64:67], v225 offset:4096
    v_exp_f32 v139, v139
    v_exp_f32 v141, v141
    v_exp_f32 v143, v143
    v_mfma_f32_16x16x32_bf16 v[108:111], v[24:27], a[28:31], v[108:111]
    ds_read_b128 v[68:71], v225 offset:5120
    v_exp_f32 v145, v145
    v_exp_f32 v147, v147
    v_mfma_f32_16x16x32_bf16 v[112:115], v[28:31], a[28:31], v[112:115]
    ds_read_b128 v[16:19], v225 offset:6144
    v_exp_f32 v149, v149
    v_exp_f32 v151, v151
    v_exp_f32 v153, v153
    s_waitcnt lgkmcnt(8)
    s_waitcnt vmcnt(10)
    v_mfma_f32_16x16x32_bf16 v[96:99], v[32:35], a[32:35], v[96:99]
    ds_read_b128 v[20:23], v225 offset:7168
    v_exp_f32 v155, v155
    v_add_f32 v136, 1.0, v136
    v_add_f32 v138, 1.0, v138
    v_mfma_f32_16x16x32_bf16 v[100:103], v[36:39], a[32:35], v[100:103]
    ds_read_b128 v[24:27], v225 offset:8192
    v_add_f32 v140, 1.0, v140
    v_add_f32 v142, 1.0, v142
    v_mfma_f32_16x16x32_bf16 v[104:107], v[40:43], a[32:35], v[104:107]
    ds_read_b128 v[28:31], v225 offset:9216
    v_add_f32 v144, 1.0, v144
    v_add_f32 v146, 1.0, v146
    v_add_f32 v148, 1.0, v148
    s_waitcnt lgkmcnt(8)
    v_mfma_f32_16x16x32_bf16 v[108:111], v[44:47], a[32:35], v[108:111]
    ds_read_b128 v[32:35], v225 offset:10240
    v_add_f32 v150, 1.0, v150
    v_add_f32 v152, 1.0, v152
    v_mfma_f32_16x16x32_bf16 v[112:115], v[48:51], a[32:35], v[112:115]
    ds_read_b128 v[36:39], v225 offset:11264
    v_add_f32 v154, 1.0, v154
    v_add_f32 v137, 1.0, v137
    v_add_f32 v139, 1.0, v139
    s_waitcnt vmcnt(9)
    v_mfma_f32_16x16x32_bf16 v[96:99], v[52:55], a[36:39], v[96:99]
    ds_read_b128 v[40:43], v225 offset:12288
    v_add_f32 v141, 1.0, v141
    v_add_f32 v143, 1.0, v143
    v_add_f32 v145, 1.0, v145
    s_waitcnt lgkmcnt(8)
    v_mfma_f32_16x16x32_bf16 v[100:103], v[56:59], a[36:39], v[100:103]
    ds_read_b128 v[44:47], v225 offset:13312
    v_add_f32 v147, 1.0, v147
    v_add_f32 v149, 1.0, v149
    v_mfma_f32_16x16x32_bf16 v[104:107], v[60:63], a[36:39], v[104:107]
    ds_read_b128 v[48:51], v225 offset:14336
    v_add_f32 v151, 1.0, v151
    v_add_f32 v153, 1.0, v153
    v_add_f32 v155, 1.0, v155
    v_mfma_f32_16x16x32_bf16 v[108:111], v[64:67], a[36:39], v[108:111]
    ds_read_b128 v[52:55], v225 offset:15360
    v_rcp_f32 v136, v136
    v_rcp_f32 v138, v138
    v_rcp_f32 v140, v140
    s_waitcnt lgkmcnt(8)
    v_mfma_f32_16x16x32_bf16 v[112:115], v[68:71], a[36:39], v[112:115]
    ds_read_b128 v[56:59], v225 offset:16384
    v_rcp_f32 v142, v142
    v_rcp_f32 v144, v144
    s_waitcnt vmcnt(8)
    v_mfma_f32_16x16x32_bf16 v[96:99], v[16:19], a[40:43], v[96:99]
    ds_read_b128 v[60:63], v225 offset:17408
    v_rcp_f32 v146, v146
    v_rcp_f32 v148, v148
    v_rcp_f32 v150, v150
    v_mfma_f32_16x16x32_bf16 v[100:103], v[20:23], a[40:43], v[100:103]
    ds_read_b128 v[64:67], v225 offset:18432
    v_rcp_f32 v152, v152
    v_rcp_f32 v154, v154
    v_rcp_f32 v137, v137
    s_waitcnt lgkmcnt(8)
    v_mfma_f32_16x16x32_bf16 v[104:107], v[24:27], a[40:43], v[104:107]
    ds_read_b128 v[68:71], v225 offset:19456
    v_rcp_f32 v139, v139
    v_rcp_f32 v141, v141
    v_mfma_f32_16x16x32_bf16 v[108:111], v[28:31], a[40:43], v[108:111]
    ds_read_b128 v[16:19], v225 offset:20480
    v_rcp_f32 v143, v143
    v_rcp_f32 v145, v145
    v_rcp_f32 v147, v147
    v_mfma_f32_16x16x32_bf16 v[112:115], v[32:35], a[40:43], v[112:115]
    ds_read_b128 v[20:23], v225 offset:21504
    v_rcp_f32 v149, v149
    v_rcp_f32 v151, v151
    s_waitcnt lgkmcnt(8)
    s_waitcnt vmcnt(7)
    v_mfma_f32_16x16x32_bf16 v[96:99], v[36:39], a[44:47], v[96:99]
    ds_read_b128 v[24:27], v225 offset:22528
    v_rcp_f32 v153, v153
    v_rcp_f32 v155, v155
    v_pk_mul_f32 v[76:77], v[76:77], v[136:137]
    v_mfma_f32_16x16x32_bf16 v[100:103], v[40:43], a[44:47], v[100:103]
    ds_read_b128 v[28:31], v225 offset:23552
    v_pk_mul_f32 v[78:79], v[78:79], v[138:139]
    v_pk_mul_f32 v[80:81], v[80:81], v[140:141]
    v_pk_mul_f32 v[82:83], v[82:83], v[142:143]
    v_mfma_f32_16x16x32_bf16 v[104:107], v[44:47], a[44:47], v[104:107]
    ds_read_b128 v[32:35], v225 offset:24576
    v_pk_mul_f32 v[84:85], v[84:85], v[144:145]
    v_pk_mul_f32 v[86:87], v[86:87], v[146:147]
    s_waitcnt lgkmcnt(8)
    v_mfma_f32_16x16x32_bf16 v[108:111], v[48:51], a[44:47], v[108:111]
    ds_read_b128 v[36:39], v225 offset:25600
    v_pk_mul_f32 v[88:89], v[88:89], v[148:149]
    v_pk_mul_f32 v[90:91], v[90:91], v[150:151]
    v_pk_mul_f32 v[92:93], v[92:93], v[152:153]
    v_mfma_f32_16x16x32_bf16 v[112:115], v[52:55], a[44:47], v[112:115]
    ds_read_b128 v[40:43], v225 offset:26624
    v_pk_mul_f32 v[94:95], v[94:95], v[154:155]
    v_cvt_pk_bf16_f32 v136, v76, v77
    v_cvt_pk_bf16_f32 v138, v78, v79
    s_waitcnt vmcnt(6)
    v_mfma_f32_16x16x32_bf16 v[96:99], v[56:59], a[48:51], v[96:99]
    ds_read_b128 v[44:47], v225 offset:27648
    v_cvt_pk_bf16_f32 v140, v80, v81
    v_cvt_pk_bf16_f32 v142, v82, v83
    s_waitcnt lgkmcnt(8)
    v_mfma_f32_16x16x32_bf16 v[100:103], v[60:63], a[48:51], v[100:103]
    ds_read_b128 v[48:51], v225 offset:28672
    v_cvt_pk_bf16_f32 v144, v84, v85
    v_cvt_pk_bf16_f32 v146, v86, v87
    v_cvt_pk_bf16_f32 v148, v88, v89
    v_mfma_f32_16x16x32_bf16 v[104:107], v[64:67], a[48:51], v[104:107]
    ds_read_b128 v[52:55], v225 offset:29696
    v_cvt_pk_bf16_f32 v150, v90, v91
    v_cvt_pk_bf16_f32 v152, v92, v93
    v_cvt_pk_bf16_f32 v154, v94, v95
    v_mfma_f32_16x16x32_bf16 v[108:111], v[68:71], a[48:51], v[108:111]
    ds_read_b128 v[56:59], v225 offset:30720
    v_lshlrev_b32 v76, 16, v136
    v_lshlrev_b32 v78, 16, v138
    s_waitcnt lgkmcnt(8)
    v_mfma_f32_16x16x32_bf16 v[112:115], v[16:19], a[48:51], v[112:115]
    ds_read_b128 v[60:63], v225 offset:31744
    v_lshlrev_b32 v80, 16, v140
    v_lshlrev_b32 v82, 16, v142
    v_lshlrev_b32 v84, 16, v144
    s_waitcnt vmcnt(5)
    v_mfma_f32_16x16x32_bf16 v[96:99], v[20:23], a[52:55], v[96:99]
    ds_read_b128 v[64:67], v225 offset:32768
    v_lshlrev_b32 v86, 16, v146
    v_lshlrev_b32 v88, 16, v148
    v_lshlrev_b32 v90, 16, v150
    v_mfma_f32_16x16x32_bf16 v[100:103], v[24:27], a[52:55], v[100:103]
    ds_read_b128 v[68:71], v225 offset:33792
    v_lshlrev_b32 v92, 16, v152
    v_lshlrev_b32 v94, 16, v154
    s_waitcnt lgkmcnt(8)
    v_mfma_f32_16x16x32_bf16 v[104:107], v[28:31], a[52:55], v[104:107]
    ds_read_b128 v[16:19], v225 offset:34816
    v_and_b32 v77, s40, v136
    v_and_b32 v79, s40, v138
    v_and_b32 v81, s40, v140
    v_mfma_f32_16x16x32_bf16 v[108:111], v[32:35], a[52:55], v[108:111]
    ds_read_b128 v[20:23], v225 offset:35840
    v_and_b32 v83, s40, v142
    v_and_b32 v85, s40, v144
    v_mfma_f32_16x16x32_bf16 v[112:115], v[36:39], a[52:55], v[112:115]
    v_and_b32 v87, s40, v146
    v_and_b32 v89, s40, v148
    v_and_b32 v91, s40, v150
    s_waitcnt lgkmcnt(7)
    s_waitcnt vmcnt(4)
    v_mfma_f32_16x16x32_bf16 v[96:99], v[40:43], a[56:59], v[96:99]
    v_and_b32 v93, s40, v152
    v_and_b32 v95, s40, v154
    s_waitcnt vmcnt(2)
    v_lshlrev_b32 v136, 16, v196
    v_mfma_f32_16x16x32_bf16 v[100:103], v[44:47], a[56:59], v[100:103]
    v_and_b32 v137, s40, v196
    v_lshlrev_b32 v138, 16, v197
    v_mfma_f32_16x16x32_bf16 v[104:107], v[48:51], a[56:59], v[104:107]
    v_and_b32 v139, s40, v197
    v_lshlrev_b32 v140, 16, v198
    v_and_b32 v141, s40, v198
    s_waitcnt lgkmcnt(4)
    v_mfma_f32_16x16x32_bf16 v[108:111], v[52:55], a[56:59], v[108:111]
    v_lshlrev_b32 v142, 16, v199
    v_and_b32 v143, s40, v199
    s_waitcnt vmcnt(1)
    v_lshlrev_b32 v144, 16, v200
    v_mfma_f32_16x16x32_bf16 v[112:115], v[56:59], a[56:59], v[112:115]
    v_and_b32 v145, s40, v200
    v_lshlrev_b32 v146, 16, v201
    v_mfma_f32_16x16x32_bf16 v[96:99], v[60:63], a[60:63], v[96:99]
    v_and_b32 v147, s40, v201
    v_lshlrev_b32 v148, 16, v202
    v_and_b32 v149, s40, v202
    s_waitcnt lgkmcnt(1)
    v_mfma_f32_16x16x32_bf16 v[100:103], v[64:67], a[60:63], v[100:103]
    v_lshlrev_b32 v150, 16, v203
    v_and_b32 v151, s40, v203
    s_waitcnt vmcnt(0)
    v_lshlrev_b32 v152, 16, v204
    v_mfma_f32_16x16x32_bf16 v[104:107], v[68:71], a[60:63], v[104:107]
    v_and_b32 v153, s40, v204
    v_lshlrev_b32 v154, 16, v205
    v_mfma_f32_16x16x32_bf16 v[108:111], v[16:19], a[60:63], v[108:111]
    v_and_b32 v155, s40, v205
    v_lshlrev_b32 v156, 16, v206
    v_and_b32 v157, s40, v206
    s_waitcnt lgkmcnt(0)
    v_mfma_f32_16x16x32_bf16 v[112:115], v[20:23], a[60:63], v[112:115]
    v_lshlrev_b32 v158, 16, v207
    v_and_b32 v159, s40, v207
    v_cvt_pk_bf16_f32 v160, v96, v97
    v_cvt_pk_bf16_f32 v161, v98, v99
    v_lshlrev_b32 v96, 16, v160
    v_lshlrev_b32 v98, 16, v161
    v_and_b32 v97, s40, v160
    v_and_b32 v99, s40, v161
    v_pk_mul_f32 v[96:97], v[96:97], v[76:77]
    v_pk_mul_f32 v[98:99], v[98:99], v[78:79]
    v_cvt_pk_bf16_f32 v160, v96, v97
    v_cvt_pk_bf16_f32 v161, v98, v99
    ds_write_b64 v220, v[160:161] offset:0
    v_cvt_pk_bf16_f32 v162, v100, v101
    v_cvt_pk_bf16_f32 v163, v102, v103
    v_lshlrev_b32 v100, 16, v162
    v_lshlrev_b32 v102, 16, v163
    v_and_b32 v101, s40, v162
    v_and_b32 v103, s40, v163
    v_pk_mul_f32 v[100:101], v[100:101], v[80:81]
    v_pk_mul_f32 v[102:103], v[102:103], v[82:83]
    v_cvt_pk_bf16_f32 v162, v100, v101
    v_cvt_pk_bf16_f32 v163, v102, v103
    ds_write_b64 v220, v[162:163] offset:32
    v_cvt_pk_bf16_f32 v164, v104, v105
    v_cvt_pk_bf16_f32 v165, v106, v107
    v_lshlrev_b32 v104, 16, v164
    v_lshlrev_b32 v106, 16, v165
    v_and_b32 v105, s40, v164
    v_and_b32 v107, s40, v165
    v_pk_mul_f32 v[104:105], v[104:105], v[84:85]
    v_pk_mul_f32 v[106:107], v[106:107], v[86:87]
    v_cvt_pk_bf16_f32 v164, v104, v105
    v_cvt_pk_bf16_f32 v165, v106, v107
    ds_write_b64 v220, v[164:165] offset:64
    v_cvt_pk_bf16_f32 v166, v108, v109
    v_cvt_pk_bf16_f32 v167, v110, v111
    v_lshlrev_b32 v108, 16, v166
    v_lshlrev_b32 v110, 16, v167
    v_and_b32 v109, s40, v166
    v_and_b32 v111, s40, v167
    v_pk_mul_f32 v[108:109], v[108:109], v[88:89]
    v_pk_mul_f32 v[110:111], v[110:111], v[90:91]
    v_cvt_pk_bf16_f32 v166, v108, v109
    v_cvt_pk_bf16_f32 v167, v110, v111
    ds_write_b64 v220, v[166:167] offset:96
    v_cvt_pk_bf16_f32 v168, v112, v113
    v_cvt_pk_bf16_f32 v169, v114, v115
    v_lshlrev_b32 v112, 16, v168
    v_lshlrev_b32 v114, 16, v169
    v_and_b32 v113, s40, v168
    v_and_b32 v115, s40, v169
    v_pk_mul_f32 v[112:113], v[112:113], v[92:93]
    v_pk_mul_f32 v[114:115], v[114:115], v[94:95]
    v_cvt_pk_bf16_f32 v168, v112, v113
    v_cvt_pk_bf16_f32 v169, v114, v115
    ds_write_b64 v220, v[168:169] offset:128
    ds_read_b128 v[196:199], v223 offset:0
    ds_read_b128 v[200:203], v223 offset:1024
    ds_read_b128 v[204:207], v223 offset:2048
    s_waitcnt lgkmcnt(2)
    v_lshlrev_b32 v16, 16, v196
    v_and_b32 v17, s40, v196
    v_lshlrev_b32 v18, 16, v197
    v_and_b32 v19, s40, v197
    v_lshlrev_b32 v20, 16, v198
    v_and_b32 v21, s40, v198
    v_lshlrev_b32 v22, 16, v199
    v_and_b32 v23, s40, v199
    v_pk_add_f32 v[16:17], v[16:17], v[136:137]
    v_pk_add_f32 v[18:19], v[18:19], v[138:139]
    v_pk_add_f32 v[20:21], v[20:21], v[140:141]
    v_pk_add_f32 v[22:23], v[22:23], v[142:143]
    v_cvt_pk_bf16_f32 v196, v16, v17
    v_cvt_pk_bf16_f32 v197, v18, v19
    v_cvt_pk_bf16_f32 v198, v20, v21
    v_cvt_pk_bf16_f32 v199, v22, v23
    buffer_store_dwordx4 v[196:199], v2, s[20:23], 0 offen
    s_waitcnt lgkmcnt(1)
    v_lshlrev_b32 v24, 16, v200
    v_and_b32 v25, s40, v200
    v_lshlrev_b32 v26, 16, v201
    v_and_b32 v27, s40, v201
    v_lshlrev_b32 v28, 16, v202
    v_and_b32 v29, s40, v202
    v_lshlrev_b32 v30, 16, v203
    v_and_b32 v31, s40, v203
    v_pk_add_f32 v[24:25], v[24:25], v[144:145]
    v_pk_add_f32 v[26:27], v[26:27], v[146:147]
    v_pk_add_f32 v[28:29], v[28:29], v[148:149]
    v_pk_add_f32 v[30:31], v[30:31], v[150:151]
    v_cvt_pk_bf16_f32 v200, v24, v25
    v_cvt_pk_bf16_f32 v201, v26, v27
    v_cvt_pk_bf16_f32 v202, v28, v29
    v_cvt_pk_bf16_f32 v203, v30, v31
    buffer_store_dwordx4 v[200:203], v3, s[20:23], 0 offen
    s_waitcnt lgkmcnt(0)
    v_lshlrev_b32 v32, 16, v204
    v_and_b32 v33, s40, v204
    v_lshlrev_b32 v34, 16, v205
    v_and_b32 v35, s40, v205
    v_lshlrev_b32 v36, 16, v206
    v_and_b32 v37, s40, v206
    v_lshlrev_b32 v38, 16, v207
    v_and_b32 v39, s40, v207
    v_pk_add_f32 v[32:33], v[32:33], v[152:153]
    v_pk_add_f32 v[34:35], v[34:35], v[154:155]
    v_pk_add_f32 v[36:37], v[36:37], v[156:157]
    v_pk_add_f32 v[38:39], v[38:39], v[158:159]
    v_cvt_pk_bf16_f32 v204, v32, v33
    v_cvt_pk_bf16_f32 v205, v34, v35
    v_cvt_pk_bf16_f32 v206, v36, v37
    v_cvt_pk_bf16_f32 v207, v38, v39
    buffer_store_dwordx4 v[204:207], v4, s[20:23], 0 offen
L_end:
    s_endpgm
.section .rodata,"a"
.p2align 6
.amdhsa_kernel recurrent_scan__sliding_local_dilated__dense_activation_gelu__prompt_kernel
  .amdhsa_next_free_vgpr 512
  .amdhsa_next_free_sgpr 102
  .amdhsa_accum_offset 256
  .amdhsa_group_segment_fixed_size 0
  .amdhsa_kernarg_size 88
  .amdhsa_user_sgpr_count 2
  .amdhsa_user_sgpr_kernarg_segment_ptr 1
  .amdhsa_system_sgpr_workgroup_id_x 1
  .amdhsa_float_denorm_mode_32 3
.end_amdhsa_kernel
```
